```python
import torch

def _softmax(x, axis=-1):
    return torch.softmax(x, dim=axis)
def _gelu(x):
    return torch.nn.functional.gelu(x, approximate="tanh")
def _silu(x):
    return torch.nn.functional.silu(x)
def _sigmoid(x):
    return torch.sigmoid(x)
def _layernorm(x, axis=-1, eps=1e-5):
    m = x.mean(dim=axis, keepdim=True)
    v = x.var(dim=axis, keepdim=True, unbiased=False)
    return (x - m) / torch.sqrt(v + eps)
def _scatter_add(tgt, idx, src, axis=0):
    return tgt.clone().index_add_(axis, idx, src)
def _segment_sum(src, seg, n):
    out = torch.zeros((n,) + src.shape[1:], dtype=src.dtype)
    return out.index_add_(0, seg, src)
def _pad(x, pw):
    flat = tuple(v for pair in reversed(pw) for v in pair)
    return torch.nn.functional.pad(x, flat)

kernel_name = 'interleave_layers__ssm_conv_h3__geglu_ffn__prompt'

def setup_inputs():

    _w = (lambda a: (lambda t: t.to(torch.bfloat16) if t.is_floating_point() else t)(torch.as_tensor(a)))
    def _A_setup():
        B, S, D = 1, 2048, 576
        ks = 4
        return {
            "q": _w((lambda *s: torch.randn(*s, dtype=torch.bfloat16) * 0.05)(B, S, D)),
            "k": _w((lambda *s: torch.randn(*s, dtype=torch.bfloat16) * 0.8)(B, S, D)),
            "v": _w((lambda *s: torch.randn(*s, dtype=torch.bfloat16) * 0.8)(B, S, D)),
            "shift_k": _w((lambda *s: torch.randn(*s, dtype=torch.bfloat16) * 0.8)(D, ks) * 0.5),
            "ssm_k": _w((lambda *s: torch.randn(*s, dtype=torch.bfloat16) * 0.8)(D, S) * (1.0 / S ** 0.5)),
            "ssm_D": _w((lambda *s: torch.randn(*s, dtype=torch.bfloat16) * 0.8)(D)),
        }
    _A_in = _A_setup()

    def _B_setup():
        B, S, D, F = 1, 2048, 576, 4608
        return {
            "x": _w((lambda *s: torch.randn(*s, dtype=torch.bfloat16) * 0.05)(B, S, D)),
            "w_gate": _w((lambda *s: torch.randn(*s, dtype=torch.bfloat16) * 0.05)(D, F)),
            "w_up": _w((lambda *s: torch.randn(*s, dtype=torch.bfloat16) * 0.05)(D, F)),
            "w_down": _w((lambda *s: torch.randn(*s, dtype=torch.bfloat16) * 0.05)(F, D)),
        }
    _B_in = _B_setup()

    return {
        "A_q": _A_in["q"],
        "A_k": _A_in["k"],
        "A_v": _A_in["v"],
        "A_shift_k": _A_in["shift_k"],
        "A_ssm_k": _A_in["ssm_k"],
        "A_ssm_D": _A_in["ssm_D"],
        "B_x": _B_in["x"],
        "B_w_gate": _B_in["w_gate"],
        "B_w_up": _B_in["w_up"],
        "B_w_down": _B_in["w_down"],
    }

def reference(A_q, A_k, A_v, A_shift_k, A_ssm_k, A_ssm_D, B_x, B_w_gate, B_w_up, B_w_down):
    def _A_ref(q, k, v, shift_k, ssm_k, ssm_D):
        B, S, D = q.shape
        ks = shift_k.shape[-1]
        k_pad = _pad(k, ((0, 0), (ks - 1, 0), (0, 0)))
        k_shift = torch.zeros_like(k)
        for t in range(ks):
            k_shift = k_shift + k_pad[:, t:t + S, :] * shift_k[:, ks - 1 - t][None, None, :]
        kv = k_shift * v
        L = 2 * S
        kv_pad = _pad(kv, ((0, 0), (0, S), (0, 0)))
        kf_pad = _pad(ssm_k, ((0, 0), (0, S)))
        kv_f = (lambda x, axes=(-2,-1): torch.fft.rfft2(x.float(), dim=axes))(kv_pad[:, None, :, :], axes=(1, 2))
        kf_f = (lambda x, axes=(-2,-1): torch.fft.rfft2(x.float(), dim=axes))(kf_pad[:, None, :], axes=(1, 2))
        kf_f = (lambda x, *d: x.permute(*d))(kf_f, 1, 2, 0)
        y_f = kv_f * kf_f[None, :, :, :]
        y = (lambda x, s, axes=(-2,-1): torch.fft.irfft2(x, s=s, dim=axes).to(torch.bfloat16))(y_f, (1, L), axes=(1, 2))[:, 0, :S, :]
        y = y + kv * ssm_D[None, None, :]
        return q * y

    def _B_ref(x, w_gate, w_up, w_down):
        return (_gelu(x @ w_gate) * (x @ w_up)) @ w_down

    x = A_q
    x = x + _A_ref(_layernorm(x, axis=-1), A_k, A_v, A_shift_k, A_ssm_k, A_ssm_D)
    x = x + _B_ref(_layernorm(x, axis=-1), B_w_gate, B_w_up, B_w_down)
    x = x + _A_ref(_layernorm(x, axis=-1), A_k, A_v, A_shift_k, A_ssm_k, A_ssm_D)
    x = x + _B_ref(_layernorm(x, axis=-1), B_w_gate, B_w_up, B_w_down)
    return x
```

```asm
; @launch grid=(256,1,1) block=(256,1,1) lds=157824
.amdgcn_target "amdgcn-amd-amdhsa--gfx950"
.text
.p2align 12
.globl interleave_layers__ssm_conv_h3__geglu_ffn__prompt_kernel
.p2align 8
.type interleave_layers__ssm_conv_h3__geglu_ffn__prompt_kernel,@function
interleave_layers__ssm_conv_h3__geglu_ffn__prompt_kernel:
    s_cmp_ge_u32 s2, 256
    s_cbranch_scc1 L_front_end
    s_and_b32 s4, s2, 7
    s_lshr_b32 s5, s2, 3
    s_mul_i32 s3, s4, 18
    s_add_u32 s3, s3, s5
    s_cmp_lt_u32 s5, 18
    s_cbranch_scc0 L_conv_end
L_front_conv:
    s_load_dwordx4 s[36:39], s[0:1], 8
    s_load_dwordx2 s[8:9], s[0:1], 24
    s_load_dwordx4 s[4:7], s[0:1], 32
    s_load_dwordx2 s[10:11], s[0:1], 96
    s_load_dwordx2 s[52:53], s[0:1], 72
    s_load_dwordx2 s[96:97], s[0:1], 88
    s_getpc_b64 s[98:99]
L_cpf:
    v_lshlrev_b32 v20, 6, v0
    v_min_u32 v20, L_conv_last-L_cpf, v20
    global_load_dword v21, v20, s[98:99]
    s_load_dwordx2 s[54:55], s[0:1], 0
    s_memrealtime s[100:101]
    v_lshrrev_b32 v1, 6, v0
    v_and_b32 v2, 63, v0
    v_and_b32 v3, 15, v0
    v_readfirstlane_b32 s28, v1
    v_bfe_u32 v4, v0, 4, 2
    s_lshl_b32 s29, s3, 2
    v_lshlrev_b32 v5, 4, v2
    s_add_u32 s29, s29, s28
    s_mul_i32 s30, s28, 21760
    s_lshl_b32 s31, s29, 12
    s_lshr_b32 s32, s29, 6
    s_and_b32 s33, s29, 63
    s_mul_i32 s34, s33, 36864
    s_lshl_b32 s35, s32, 7
    s_add_u32 s34, s34, s35
    v_mul_u32_u24 v6, 9216, v4
    v_lshl_add_u32 v6, v3, 3, v6
    v_add_u32 v6, s34, v6
    s_lshl_b32 s34, s32, 9
    v_lshl_add_u32 v7, v3, 5, s34
    v_subrev_u32 v10, 3456, v6
    v_subrev_u32 v11, 2304, v6
    v_subrev_u32 v12, 1152, v6
    v_add_u32 v13, 4608, v6
    s_waitcnt lgkmcnt(0)
    s_or_b32 s34, s2, s28
    s_cbranch_scc1 L_conv_notag
    s_mov_b32 s56, s96
    s_mov_b32 s57, s97
    s_mov_b32 s58, 256
    s_mov_b32 s59, 0x20000
    v_mov_b32 v224, s100
    v_mov_b32 v225, s101
    v_mov_b32 v226, 0
    s_mov_b64 exec, 1
    buffer_store_dwordx2 v[224:225], v226, s[56:59], 0 offen sc1
    s_mov_b64 exec, -1
L_conv_notag:
    s_mov_b32 s16, s36
    s_mov_b32 s17, s37
    s_mov_b32 s18, 2359296
    s_mov_b32 s19, 0x20000
    s_mov_b32 s20, s38
    s_mov_b32 s21, s39
    s_mov_b32 s22, 2359296
    s_mov_b32 s23, 0x20000
    s_mov_b32 s24, s8
    s_mov_b32 s25, s9
    s_mov_b32 s26, 4608
    s_mov_b32 s27, 0x20000
    buffer_load_dwordx4 v[64:67], v7, s[24:27], 0 offen
    buffer_load_dwordx4 v[68:71], v7, s[24:27], 0 offen offset:16
    buffer_load_dwordx2 v[72:73], v10, s[16:19], 0 offen nt
    buffer_load_dwordx2 v[74:75], v11, s[16:19], 0 offen nt
    buffer_load_dwordx2 v[76:77], v12, s[16:19], 0 offen nt
    buffer_load_dwordx2 v[78:79], v6, s[16:19], 0 offen offset:0 nt
    buffer_load_dwordx2 v[96:97], v6, s[20:23], 0 offen offset:0 nt
    buffer_load_dwordx2 v[80:81], v6, s[16:19], 0 offen offset:1152 nt
    buffer_load_dwordx2 v[98:99], v6, s[20:23], 0 offen offset:1152 nt
    buffer_load_dwordx2 v[82:83], v6, s[16:19], 0 offen offset:2304 nt
    buffer_load_dwordx2 v[100:101], v6, s[20:23], 0 offen offset:2304 nt
    buffer_load_dwordx2 v[84:85], v6, s[16:19], 0 offen offset:3456 nt
    buffer_load_dwordx2 v[102:103], v6, s[20:23], 0 offen offset:3456 nt
    buffer_load_dwordx2 v[86:87], v13, s[16:19], 0 offen offset:0 nt
    buffer_load_dwordx2 v[104:105], v13, s[20:23], 0 offen offset:0 nt
    buffer_load_dwordx2 v[88:89], v13, s[16:19], 0 offen offset:1152 nt
    buffer_load_dwordx2 v[106:107], v13, s[20:23], 0 offen offset:1152 nt
    buffer_load_dwordx2 v[90:91], v13, s[16:19], 0 offen offset:2304 nt
    buffer_load_dwordx2 v[108:109], v13, s[20:23], 0 offen offset:2304 nt
    buffer_load_dwordx2 v[92:93], v13, s[16:19], 0 offen offset:3456 nt
    buffer_load_dwordx2 v[110:111], v13, s[20:23], 0 offen offset:3456 nt
    s_waitcnt lgkmcnt(0)
    s_mov_b64 exec, 0
    s_cmp_lg_u32 s28, 1
    s_cbranch_scc1 L_wn_c1_0
    s_call_b64 s[98:99], L_pg_conv0
L_wn_c1_0:
    s_cmp_lg_u32 s28, 2
    s_cbranch_scc1 L_wn_c1_1
    s_call_b64 s[98:99], L_pg_conv1
L_wn_c1_1:
    s_cmp_lg_u32 s28, 3
    s_cbranch_scc1 L_wn_c1_2
    s_call_b64 s[98:99], L_pg_conv2
L_wn_c1_2:
    s_mov_b64 exec, -1
    s_branch L_wret2
L_wret:
    s_setpc_b64 s[98:99]
L_wret2:
    s_mov_b32 s56, s96
    s_mov_b32 s57, s97
    s_mov_b32 s58, 256
    s_mov_b32 s59, 0x20000
    s_cmp_lg_u32 s28, 0
    s_cselect_b32 s34, 0x7f000000, 0
    v_mov_b32 v226, s34
    s_add_u32 s48, s10, 19922944
    s_addc_u32 s49, s11, 0
    s_mov_b32 s50, 2359296
    s_mov_b32 s51, 0x20000
    s_add_u32 s16, s10, 16777216
    s_addc_u32 s17, s11, 0
    s_mov_b32 s18, 2359296
    s_mov_b32 s19, 0x20000
    s_mov_b32 s24, s10
    s_mov_b32 s25, s11
    s_mov_b32 s26, 15925248
    s_mov_b32 s27, 0x20000
    s_mov_b32 s40, 0x05040100
    s_mov_b32 s41, 0x07060302
    s_lshl_b32 s34, s32, 18
    s_lshl_b32 s35, s33, 6
    s_add_u32 s44, s34, s35
    v_lshlrev_b32 v13, 14, v3
    v_lshl_add_u32 v13, v4, 4, v13
    s_waitcnt vmcnt(16)
    v_lshlrev_b32 v156, 16, v64
    v_lshlrev_b32 v157, 16, v66
    v_and_b32 v158, 0xffff0000, v64
    v_and_b32 v159, 0xffff0000, v66
    v_lshlrev_b32 v160, 16, v65
    v_lshlrev_b32 v161, 16, v67
    v_and_b32 v162, 0xffff0000, v65
    v_and_b32 v163, 0xffff0000, v67
    v_lshlrev_b32 v164, 16, v68
    v_lshlrev_b32 v165, 16, v70
    v_and_b32 v166, 0xffff0000, v68
    v_and_b32 v167, 0xffff0000, v70
    v_lshlrev_b32 v168, 16, v69
    v_lshlrev_b32 v169, 16, v71
    v_and_b32 v170, 0xffff0000, v69
    v_and_b32 v171, 0xffff0000, v71
    v_lshlrev_b32 v112, 16, v72
    v_and_b32 v113, 0xffff0000, v72
    v_lshlrev_b32 v114, 16, v73
    v_and_b32 v115, 0xffff0000, v73
    v_lshlrev_b32 v116, 16, v74
    v_and_b32 v117, 0xffff0000, v74
    v_lshlrev_b32 v118, 16, v75
    v_and_b32 v119, 0xffff0000, v75
    v_lshlrev_b32 v120, 16, v76
    v_and_b32 v121, 0xffff0000, v76
    v_lshlrev_b32 v122, 16, v77
    v_and_b32 v123, 0xffff0000, v77
    s_waitcnt vmcnt(14)
    v_lshlrev_b32 v124, 16, v78
    v_and_b32 v125, 0xffff0000, v78
    v_lshlrev_b32 v126, 16, v79
    v_and_b32 v127, 0xffff0000, v79
    v_pk_mul_f32 v[172:173], v[112:113], v[162:163]
    v_pk_mul_f32 v[174:175], v[116:117], v[160:161]
    v_pk_mul_f32 v[176:177], v[120:121], v[158:159]
    v_pk_mul_f32 v[178:179], v[124:125], v[156:157]
    v_pk_mul_f32 v[182:183], v[114:115], v[170:171]
    v_pk_mul_f32 v[184:185], v[118:119], v[168:169]
    v_pk_mul_f32 v[186:187], v[122:123], v[166:167]
    v_pk_mul_f32 v[188:189], v[126:127], v[164:165]
    v_cvt_pk_bf16_f32 v172, v172, v173
    v_cvt_pk_bf16_f32 v182, v182, v183
    v_cvt_pk_bf16_f32 v174, v174, v175
    v_cvt_pk_bf16_f32 v184, v184, v185
    v_cvt_pk_bf16_f32 v176, v176, v177
    v_cvt_pk_bf16_f32 v186, v186, v187
    v_cvt_pk_bf16_f32 v178, v178, v179
    v_cvt_pk_bf16_f32 v188, v188, v189
    v_and_b32 v173, 0xffff0000, v172
    v_lshlrev_b32 v172, 16, v172
    v_and_b32 v183, 0xffff0000, v182
    v_lshlrev_b32 v182, 16, v182
    v_and_b32 v175, 0xffff0000, v174
    v_lshlrev_b32 v174, 16, v174
    v_and_b32 v185, 0xffff0000, v184
    v_lshlrev_b32 v184, 16, v184
    v_and_b32 v177, 0xffff0000, v176
    v_lshlrev_b32 v176, 16, v176
    v_and_b32 v187, 0xffff0000, v186
    v_lshlrev_b32 v186, 16, v186
    v_and_b32 v179, 0xffff0000, v178
    v_lshlrev_b32 v178, 16, v178
    v_and_b32 v189, 0xffff0000, v188
    v_lshlrev_b32 v188, 16, v188
    v_lshlrev_b32 v180, 16, v96
    v_and_b32 v181, 0xffff0000, v96
    v_lshlrev_b32 v190, 16, v97
    v_and_b32 v191, 0xffff0000, v97
    v_pk_add_f32 v[172:173], v[172:173], v[174:175]
    v_pk_add_f32 v[182:183], v[182:183], v[184:185]
    v_cvt_pk_bf16_f32 v172, v172, v173
    v_cvt_pk_bf16_f32 v182, v182, v183
    v_and_b32 v173, 0xffff0000, v172
    v_lshlrev_b32 v172, 16, v172
    v_and_b32 v183, 0xffff0000, v182
    v_lshlrev_b32 v182, 16, v182
    v_pk_add_f32 v[172:173], v[172:173], v[176:177]
    v_pk_add_f32 v[182:183], v[182:183], v[186:187]
    v_cvt_pk_bf16_f32 v172, v172, v173
    v_cvt_pk_bf16_f32 v182, v182, v183
    v_and_b32 v173, 0xffff0000, v172
    v_lshlrev_b32 v172, 16, v172
    v_and_b32 v183, 0xffff0000, v182
    v_lshlrev_b32 v182, 16, v182
    v_pk_add_f32 v[172:173], v[172:173], v[178:179]
    v_pk_add_f32 v[182:183], v[182:183], v[188:189]
    v_cvt_pk_bf16_f32 v172, v172, v173
    v_cvt_pk_bf16_f32 v182, v182, v183
    v_and_b32 v173, 0xffff0000, v172
    v_lshlrev_b32 v172, 16, v172
    v_and_b32 v183, 0xffff0000, v182
    v_lshlrev_b32 v182, 16, v182
    v_pk_mul_f32 v[16:17], v[172:173], v[180:181]
    v_pk_mul_f32 v[18:19], v[182:183], v[190:191]
    s_waitcnt vmcnt(12)
    v_lshlrev_b32 v128, 16, v80
    v_and_b32 v129, 0xffff0000, v80
    v_lshlrev_b32 v130, 16, v81
    v_and_b32 v131, 0xffff0000, v81
    v_pk_mul_f32 v[172:173], v[116:117], v[162:163]
    v_pk_mul_f32 v[174:175], v[120:121], v[160:161]
    v_pk_mul_f32 v[176:177], v[124:125], v[158:159]
    v_pk_mul_f32 v[178:179], v[128:129], v[156:157]
    v_pk_mul_f32 v[182:183], v[118:119], v[170:171]
    v_pk_mul_f32 v[184:185], v[122:123], v[168:169]
    v_pk_mul_f32 v[186:187], v[126:127], v[166:167]
    v_pk_mul_f32 v[188:189], v[130:131], v[164:165]
    v_cvt_pk_bf16_f32 v172, v172, v173
    v_cvt_pk_bf16_f32 v182, v182, v183
    v_cvt_pk_bf16_f32 v174, v174, v175
    v_cvt_pk_bf16_f32 v184, v184, v185
    v_cvt_pk_bf16_f32 v176, v176, v177
    v_cvt_pk_bf16_f32 v186, v186, v187
    v_cvt_pk_bf16_f32 v178, v178, v179
    v_cvt_pk_bf16_f32 v188, v188, v189
    v_and_b32 v173, 0xffff0000, v172
    v_lshlrev_b32 v172, 16, v172
    v_and_b32 v183, 0xffff0000, v182
    v_lshlrev_b32 v182, 16, v182
    v_and_b32 v175, 0xffff0000, v174
    v_lshlrev_b32 v174, 16, v174
    v_and_b32 v185, 0xffff0000, v184
    v_lshlrev_b32 v184, 16, v184
    v_and_b32 v177, 0xffff0000, v176
    v_lshlrev_b32 v176, 16, v176
    v_and_b32 v187, 0xffff0000, v186
    v_lshlrev_b32 v186, 16, v186
    v_and_b32 v179, 0xffff0000, v178
    v_lshlrev_b32 v178, 16, v178
    v_and_b32 v189, 0xffff0000, v188
    v_lshlrev_b32 v188, 16, v188
    v_lshlrev_b32 v180, 16, v98
    v_and_b32 v181, 0xffff0000, v98
    v_lshlrev_b32 v190, 16, v99
    v_and_b32 v191, 0xffff0000, v99
    v_pk_add_f32 v[172:173], v[172:173], v[174:175]
    v_pk_add_f32 v[182:183], v[182:183], v[184:185]
    v_cvt_pk_bf16_f32 v172, v172, v173
    v_cvt_pk_bf16_f32 v182, v182, v183
    v_and_b32 v173, 0xffff0000, v172
    v_lshlrev_b32 v172, 16, v172
    v_and_b32 v183, 0xffff0000, v182
    v_lshlrev_b32 v182, 16, v182
    v_pk_add_f32 v[172:173], v[172:173], v[176:177]
    v_pk_add_f32 v[182:183], v[182:183], v[186:187]
    v_cvt_pk_bf16_f32 v172, v172, v173
    v_cvt_pk_bf16_f32 v182, v182, v183
    v_and_b32 v173, 0xffff0000, v172
    v_lshlrev_b32 v172, 16, v172
    v_and_b32 v183, 0xffff0000, v182
    v_lshlrev_b32 v182, 16, v182
    v_pk_add_f32 v[172:173], v[172:173], v[178:179]
    v_pk_add_f32 v[182:183], v[182:183], v[188:189]
    v_cvt_pk_bf16_f32 v172, v172, v173
    v_cvt_pk_bf16_f32 v182, v182, v183
    v_and_b32 v173, 0xffff0000, v172
    v_lshlrev_b32 v172, 16, v172
    v_and_b32 v183, 0xffff0000, v182
    v_lshlrev_b32 v182, 16, v182
    v_pk_mul_f32 v[20:21], v[172:173], v[180:181]
    v_pk_mul_f32 v[22:23], v[182:183], v[190:191]
    s_waitcnt vmcnt(10)
    s_add_u32 s12, s4, s31
    s_addc_u32 s13, s5, 0
    s_mov_b32 s14, 4096
    s_mov_b32 s15, 0x20000
    s_mov_b32 s20, s6
    s_mov_b32 s21, s7
    s_mov_b32 s22, 1152
    s_mov_b32 s23, 0x20000
    buffer_load_dwordx4 v[192:195], v5, s[12:15], 0 offen offset:0 nt
    buffer_load_dwordx2 v[196:197], v5, s[12:15], 0 offen offset:16 nt
    buffer_load_dwordx4 v[198:201], v5, s[12:15], 0 offen offset:1024 nt
    buffer_load_dwordx2 v[202:203], v5, s[12:15], 0 offen offset:1040 nt
    buffer_load_dwordx4 v[204:207], v5, s[12:15], 0 offen offset:2048 nt
    buffer_load_dwordx2 v[208:209], v5, s[12:15], 0 offen offset:2064 nt
    buffer_load_dwordx4 v[210:213], v5, s[12:15], 0 offen offset:3072 nt
    buffer_load_dwordx2 v[214:215], v5, s[12:15], 0 offen offset:3088 nt
    v_subrev_u32 v7, 48, v5
    s_lshl_b32 s34, s29, 1
    v_mov_b32 v9, s34
    buffer_load_dwordx2 v[220:221], v7, s[12:15], 0 offen nt
    buffer_load_ushort v8, v9, s[20:23], 0 offen
    buffer_load_dwordx2 v[224:225], v226, s[56:59], 0 offen sc1
    v_lshlrev_b32 v132, 16, v82
    v_and_b32 v133, 0xffff0000, v82
    v_lshlrev_b32 v134, 16, v83
    v_and_b32 v135, 0xffff0000, v83
    v_pk_mul_f32 v[172:173], v[120:121], v[162:163]
    v_pk_mul_f32 v[174:175], v[124:125], v[160:161]
    v_pk_mul_f32 v[176:177], v[128:129], v[158:159]
    v_pk_mul_f32 v[178:179], v[132:133], v[156:157]
    v_pk_mul_f32 v[182:183], v[122:123], v[170:171]
    v_pk_mul_f32 v[184:185], v[126:127], v[168:169]
    v_pk_mul_f32 v[186:187], v[130:131], v[166:167]
    v_pk_mul_f32 v[188:189], v[134:135], v[164:165]
    v_cvt_pk_bf16_f32 v172, v172, v173
    v_cvt_pk_bf16_f32 v182, v182, v183
    v_cvt_pk_bf16_f32 v174, v174, v175
    v_cvt_pk_bf16_f32 v184, v184, v185
    v_cvt_pk_bf16_f32 v176, v176, v177
    v_cvt_pk_bf16_f32 v186, v186, v187
    v_cvt_pk_bf16_f32 v178, v178, v179
    v_cvt_pk_bf16_f32 v188, v188, v189
    v_and_b32 v173, 0xffff0000, v172
    v_lshlrev_b32 v172, 16, v172
    v_and_b32 v183, 0xffff0000, v182
    v_lshlrev_b32 v182, 16, v182
    v_and_b32 v175, 0xffff0000, v174
    v_lshlrev_b32 v174, 16, v174
    v_and_b32 v185, 0xffff0000, v184
    v_lshlrev_b32 v184, 16, v184
    v_and_b32 v177, 0xffff0000, v176
    v_lshlrev_b32 v176, 16, v176
    v_and_b32 v187, 0xffff0000, v186
    v_lshlrev_b32 v186, 16, v186
    v_and_b32 v179, 0xffff0000, v178
    v_lshlrev_b32 v178, 16, v178
    v_and_b32 v189, 0xffff0000, v188
    v_lshlrev_b32 v188, 16, v188
    v_lshlrev_b32 v180, 16, v100
    v_and_b32 v181, 0xffff0000, v100
    v_lshlrev_b32 v190, 16, v101
    v_and_b32 v191, 0xffff0000, v101
    v_pk_add_f32 v[172:173], v[172:173], v[174:175]
    v_pk_add_f32 v[182:183], v[182:183], v[184:185]
    v_cvt_pk_bf16_f32 v172, v172, v173
    v_cvt_pk_bf16_f32 v182, v182, v183
    v_and_b32 v173, 0xffff0000, v172
    v_lshlrev_b32 v172, 16, v172
    v_and_b32 v183, 0xffff0000, v182
    v_lshlrev_b32 v182, 16, v182
    v_pk_add_f32 v[172:173], v[172:173], v[176:177]
    v_pk_add_f32 v[182:183], v[182:183], v[186:187]
    v_cvt_pk_bf16_f32 v172, v172, v173
    v_cvt_pk_bf16_f32 v182, v182, v183
    v_and_b32 v173, 0xffff0000, v172
    v_lshlrev_b32 v172, 16, v172
    v_and_b32 v183, 0xffff0000, v182
    v_lshlrev_b32 v182, 16, v182
    v_pk_add_f32 v[172:173], v[172:173], v[178:179]
    v_pk_add_f32 v[182:183], v[182:183], v[188:189]
    v_cvt_pk_bf16_f32 v172, v172, v173
    v_cvt_pk_bf16_f32 v182, v182, v183
    v_and_b32 v173, 0xffff0000, v172
    v_lshlrev_b32 v172, 16, v172
    v_and_b32 v183, 0xffff0000, v182
    v_lshlrev_b32 v182, 16, v182
    v_pk_mul_f32 v[24:25], v[172:173], v[180:181]
    v_pk_mul_f32 v[26:27], v[182:183], v[190:191]
    s_waitcnt vmcnt(19)
    v_lshlrev_b32 v136, 16, v84
    v_and_b32 v137, 0xffff0000, v84
    v_lshlrev_b32 v138, 16, v85
    v_and_b32 v139, 0xffff0000, v85
    v_pk_mul_f32 v[172:173], v[124:125], v[162:163]
    v_pk_mul_f32 v[174:175], v[128:129], v[160:161]
    v_pk_mul_f32 v[176:177], v[132:133], v[158:159]
    v_pk_mul_f32 v[178:179], v[136:137], v[156:157]
    v_pk_mul_f32 v[182:183], v[126:127], v[170:171]
    v_pk_mul_f32 v[184:185], v[130:131], v[168:169]
    v_pk_mul_f32 v[186:187], v[134:135], v[166:167]
    v_pk_mul_f32 v[188:189], v[138:139], v[164:165]
    v_cvt_pk_bf16_f32 v172, v172, v173
    v_cvt_pk_bf16_f32 v182, v182, v183
    v_cvt_pk_bf16_f32 v174, v174, v175
    v_cvt_pk_bf16_f32 v184, v184, v185
    v_cvt_pk_bf16_f32 v176, v176, v177
    v_cvt_pk_bf16_f32 v186, v186, v187
    v_cvt_pk_bf16_f32 v178, v178, v179
    v_cvt_pk_bf16_f32 v188, v188, v189
    v_and_b32 v173, 0xffff0000, v172
    v_lshlrev_b32 v172, 16, v172
    v_and_b32 v183, 0xffff0000, v182
    v_lshlrev_b32 v182, 16, v182
    v_and_b32 v175, 0xffff0000, v174
    v_lshlrev_b32 v174, 16, v174
    v_and_b32 v185, 0xffff0000, v184
    v_lshlrev_b32 v184, 16, v184
    v_and_b32 v177, 0xffff0000, v176
    v_lshlrev_b32 v176, 16, v176
    v_and_b32 v187, 0xffff0000, v186
    v_lshlrev_b32 v186, 16, v186
    v_and_b32 v179, 0xffff0000, v178
    v_lshlrev_b32 v178, 16, v178
    v_and_b32 v189, 0xffff0000, v188
    v_lshlrev_b32 v188, 16, v188
    v_lshlrev_b32 v180, 16, v102
    v_and_b32 v181, 0xffff0000, v102
    v_lshlrev_b32 v190, 16, v103
    v_and_b32 v191, 0xffff0000, v103
    v_pk_add_f32 v[172:173], v[172:173], v[174:175]
    v_pk_add_f32 v[182:183], v[182:183], v[184:185]
    v_cvt_pk_bf16_f32 v172, v172, v173
    v_cvt_pk_bf16_f32 v182, v182, v183
    v_and_b32 v173, 0xffff0000, v172
    v_lshlrev_b32 v172, 16, v172
    v_and_b32 v183, 0xffff0000, v182
    v_lshlrev_b32 v182, 16, v182
    v_pk_add_f32 v[172:173], v[172:173], v[176:177]
    v_pk_add_f32 v[182:183], v[182:183], v[186:187]
    v_cvt_pk_bf16_f32 v172, v172, v173
    v_cvt_pk_bf16_f32 v182, v182, v183
    v_and_b32 v173, 0xffff0000, v172
    v_lshlrev_b32 v172, 16, v172
    v_and_b32 v183, 0xffff0000, v182
    v_lshlrev_b32 v182, 16, v182
    v_pk_add_f32 v[172:173], v[172:173], v[178:179]
    v_pk_add_f32 v[182:183], v[182:183], v[188:189]
    v_cvt_pk_bf16_f32 v172, v172, v173
    v_cvt_pk_bf16_f32 v182, v182, v183
    v_and_b32 v173, 0xffff0000, v172
    v_lshlrev_b32 v172, 16, v172
    v_and_b32 v183, 0xffff0000, v182
    v_lshlrev_b32 v182, 16, v182
    v_pk_mul_f32 v[28:29], v[172:173], v[180:181]
    v_pk_mul_f32 v[30:31], v[182:183], v[190:191]
    s_waitcnt vmcnt(17)
    v_lshlrev_b32 v140, 16, v86
    v_and_b32 v141, 0xffff0000, v86
    v_lshlrev_b32 v142, 16, v87
    v_and_b32 v143, 0xffff0000, v87
    v_pk_mul_f32 v[172:173], v[128:129], v[162:163]
    v_pk_mul_f32 v[174:175], v[132:133], v[160:161]
    v_pk_mul_f32 v[176:177], v[136:137], v[158:159]
    v_pk_mul_f32 v[178:179], v[140:141], v[156:157]
    v_pk_mul_f32 v[182:183], v[130:131], v[170:171]
    v_pk_mul_f32 v[184:185], v[134:135], v[168:169]
    v_pk_mul_f32 v[186:187], v[138:139], v[166:167]
    v_pk_mul_f32 v[188:189], v[142:143], v[164:165]
    v_cvt_pk_bf16_f32 v172, v172, v173
    v_cvt_pk_bf16_f32 v182, v182, v183
    v_cvt_pk_bf16_f32 v174, v174, v175
    v_cvt_pk_bf16_f32 v184, v184, v185
    v_cvt_pk_bf16_f32 v176, v176, v177
    v_cvt_pk_bf16_f32 v186, v186, v187
    v_cvt_pk_bf16_f32 v178, v178, v179
    v_cvt_pk_bf16_f32 v188, v188, v189
    v_and_b32 v173, 0xffff0000, v172
    v_lshlrev_b32 v172, 16, v172
    v_and_b32 v183, 0xffff0000, v182
    v_lshlrev_b32 v182, 16, v182
    v_and_b32 v175, 0xffff0000, v174
    v_lshlrev_b32 v174, 16, v174
    v_and_b32 v185, 0xffff0000, v184
    v_lshlrev_b32 v184, 16, v184
    v_and_b32 v177, 0xffff0000, v176
    v_lshlrev_b32 v176, 16, v176
    v_and_b32 v187, 0xffff0000, v186
    v_lshlrev_b32 v186, 16, v186
    v_and_b32 v179, 0xffff0000, v178
    v_lshlrev_b32 v178, 16, v178
    v_and_b32 v189, 0xffff0000, v188
    v_lshlrev_b32 v188, 16, v188
    v_lshlrev_b32 v180, 16, v104
    v_and_b32 v181, 0xffff0000, v104
    v_lshlrev_b32 v190, 16, v105
    v_and_b32 v191, 0xffff0000, v105
    v_pk_add_f32 v[172:173], v[172:173], v[174:175]
    v_pk_add_f32 v[182:183], v[182:183], v[184:185]
    v_cvt_pk_bf16_f32 v172, v172, v173
    v_cvt_pk_bf16_f32 v182, v182, v183
    v_and_b32 v173, 0xffff0000, v172
    v_lshlrev_b32 v172, 16, v172
    v_and_b32 v183, 0xffff0000, v182
    v_lshlrev_b32 v182, 16, v182
    v_pk_add_f32 v[172:173], v[172:173], v[176:177]
    v_pk_add_f32 v[182:183], v[182:183], v[186:187]
    v_cvt_pk_bf16_f32 v172, v172, v173
    v_cvt_pk_bf16_f32 v182, v182, v183
    v_and_b32 v173, 0xffff0000, v172
    v_lshlrev_b32 v172, 16, v172
    v_and_b32 v183, 0xffff0000, v182
    v_lshlrev_b32 v182, 16, v182
    v_pk_add_f32 v[172:173], v[172:173], v[178:179]
    v_pk_add_f32 v[182:183], v[182:183], v[188:189]
    v_cvt_pk_bf16_f32 v172, v172, v173
    v_cvt_pk_bf16_f32 v182, v182, v183
    v_and_b32 v173, 0xffff0000, v172
    v_lshlrev_b32 v172, 16, v172
    v_and_b32 v183, 0xffff0000, v182
    v_lshlrev_b32 v182, 16, v182
L_pg_conv0:
    s_cbranch_execz L_wret
    v_pk_mul_f32 v[32:33], v[172:173], v[180:181]
    v_pk_mul_f32 v[34:35], v[182:183], v[190:191]
    s_waitcnt vmcnt(15)
    v_lshlrev_b32 v144, 16, v88
    v_and_b32 v145, 0xffff0000, v88
    v_lshlrev_b32 v146, 16, v89
    v_and_b32 v147, 0xffff0000, v89
    v_pk_mul_f32 v[172:173], v[132:133], v[162:163]
    v_pk_mul_f32 v[174:175], v[136:137], v[160:161]
    v_pk_mul_f32 v[176:177], v[140:141], v[158:159]
    v_pk_mul_f32 v[178:179], v[144:145], v[156:157]
    v_pk_mul_f32 v[182:183], v[134:135], v[170:171]
    v_pk_mul_f32 v[184:185], v[138:139], v[168:169]
    v_pk_mul_f32 v[186:187], v[142:143], v[166:167]
    v_pk_mul_f32 v[188:189], v[146:147], v[164:165]
    v_cvt_pk_bf16_f32 v172, v172, v173
    v_cvt_pk_bf16_f32 v182, v182, v183
    v_cvt_pk_bf16_f32 v174, v174, v175
    v_cvt_pk_bf16_f32 v184, v184, v185
    v_cvt_pk_bf16_f32 v176, v176, v177
    v_cvt_pk_bf16_f32 v186, v186, v187
    v_cvt_pk_bf16_f32 v178, v178, v179
    v_cvt_pk_bf16_f32 v188, v188, v189
    v_and_b32 v173, 0xffff0000, v172
    v_lshlrev_b32 v172, 16, v172
    v_and_b32 v183, 0xffff0000, v182
    v_lshlrev_b32 v182, 16, v182
    v_and_b32 v175, 0xffff0000, v174
    v_lshlrev_b32 v174, 16, v174
    v_and_b32 v185, 0xffff0000, v184
    v_lshlrev_b32 v184, 16, v184
    v_and_b32 v177, 0xffff0000, v176
    v_lshlrev_b32 v176, 16, v176
    v_and_b32 v187, 0xffff0000, v186
    v_lshlrev_b32 v186, 16, v186
    v_and_b32 v179, 0xffff0000, v178
    v_lshlrev_b32 v178, 16, v178
    v_and_b32 v189, 0xffff0000, v188
    v_lshlrev_b32 v188, 16, v188
    v_lshlrev_b32 v180, 16, v106
    v_and_b32 v181, 0xffff0000, v106
    v_lshlrev_b32 v190, 16, v107
    v_and_b32 v191, 0xffff0000, v107
    v_pk_add_f32 v[172:173], v[172:173], v[174:175]
    v_pk_add_f32 v[182:183], v[182:183], v[184:185]
    v_cvt_pk_bf16_f32 v172, v172, v173
    v_cvt_pk_bf16_f32 v182, v182, v183
    v_and_b32 v173, 0xffff0000, v172
    v_lshlrev_b32 v172, 16, v172
    v_and_b32 v183, 0xffff0000, v182
    v_lshlrev_b32 v182, 16, v182
    v_pk_add_f32 v[172:173], v[172:173], v[176:177]
    v_pk_add_f32 v[182:183], v[182:183], v[186:187]
    v_cvt_pk_bf16_f32 v172, v172, v173
    v_cvt_pk_bf16_f32 v182, v182, v183
    v_and_b32 v173, 0xffff0000, v172
    v_lshlrev_b32 v172, 16, v172
    v_and_b32 v183, 0xffff0000, v182
    v_lshlrev_b32 v182, 16, v182
    v_pk_add_f32 v[172:173], v[172:173], v[178:179]
    v_pk_add_f32 v[182:183], v[182:183], v[188:189]
    v_cvt_pk_bf16_f32 v172, v172, v173
    v_cvt_pk_bf16_f32 v182, v182, v183
    v_and_b32 v173, 0xffff0000, v172
    v_lshlrev_b32 v172, 16, v172
    v_and_b32 v183, 0xffff0000, v182
    v_lshlrev_b32 v182, 16, v182
    v_pk_mul_f32 v[36:37], v[172:173], v[180:181]
    v_pk_mul_f32 v[38:39], v[182:183], v[190:191]
    s_waitcnt vmcnt(13)
    v_lshlrev_b32 v148, 16, v90
    v_and_b32 v149, 0xffff0000, v90
    v_lshlrev_b32 v150, 16, v91
    v_and_b32 v151, 0xffff0000, v91
    v_pk_mul_f32 v[172:173], v[136:137], v[162:163]
    v_pk_mul_f32 v[174:175], v[140:141], v[160:161]
    v_pk_mul_f32 v[176:177], v[144:145], v[158:159]
    v_pk_mul_f32 v[178:179], v[148:149], v[156:157]
    v_pk_mul_f32 v[182:183], v[138:139], v[170:171]
    v_pk_mul_f32 v[184:185], v[142:143], v[168:169]
    v_pk_mul_f32 v[186:187], v[146:147], v[166:167]
    v_pk_mul_f32 v[188:189], v[150:151], v[164:165]
    v_cvt_pk_bf16_f32 v172, v172, v173
    v_cvt_pk_bf16_f32 v182, v182, v183
    v_cvt_pk_bf16_f32 v174, v174, v175
    v_cvt_pk_bf16_f32 v184, v184, v185
    v_cvt_pk_bf16_f32 v176, v176, v177
    v_cvt_pk_bf16_f32 v186, v186, v187
    v_cvt_pk_bf16_f32 v178, v178, v179
    v_cvt_pk_bf16_f32 v188, v188, v189
    v_and_b32 v173, 0xffff0000, v172
    v_lshlrev_b32 v172, 16, v172
    v_and_b32 v183, 0xffff0000, v182
    v_lshlrev_b32 v182, 16, v182
    v_and_b32 v175, 0xffff0000, v174
    v_lshlrev_b32 v174, 16, v174
    v_and_b32 v185, 0xffff0000, v184
    v_lshlrev_b32 v184, 16, v184
    v_and_b32 v177, 0xffff0000, v176
    v_lshlrev_b32 v176, 16, v176
    v_and_b32 v187, 0xffff0000, v186
    v_lshlrev_b32 v186, 16, v186
    v_and_b32 v179, 0xffff0000, v178
    v_lshlrev_b32 v178, 16, v178
    v_and_b32 v189, 0xffff0000, v188
    v_lshlrev_b32 v188, 16, v188
    v_lshlrev_b32 v180, 16, v108
    v_and_b32 v181, 0xffff0000, v108
    v_lshlrev_b32 v190, 16, v109
    v_and_b32 v191, 0xffff0000, v109
    v_pk_add_f32 v[172:173], v[172:173], v[174:175]
    v_pk_add_f32 v[182:183], v[182:183], v[184:185]
    v_cvt_pk_bf16_f32 v172, v172, v173
    v_cvt_pk_bf16_f32 v182, v182, v183
    v_and_b32 v173, 0xffff0000, v172
    v_lshlrev_b32 v172, 16, v172
    v_and_b32 v183, 0xffff0000, v182
    v_lshlrev_b32 v182, 16, v182
    v_pk_add_f32 v[172:173], v[172:173], v[176:177]
    v_pk_add_f32 v[182:183], v[182:183], v[186:187]
    v_cvt_pk_bf16_f32 v172, v172, v173
    v_cvt_pk_bf16_f32 v182, v182, v183
    v_and_b32 v173, 0xffff0000, v172
    v_lshlrev_b32 v172, 16, v172
    v_and_b32 v183, 0xffff0000, v182
    v_lshlrev_b32 v182, 16, v182
    v_pk_add_f32 v[172:173], v[172:173], v[178:179]
    v_pk_add_f32 v[182:183], v[182:183], v[188:189]
    v_cvt_pk_bf16_f32 v172, v172, v173
    v_cvt_pk_bf16_f32 v182, v182, v183
    v_and_b32 v173, 0xffff0000, v172
    v_lshlrev_b32 v172, 16, v172
    v_and_b32 v183, 0xffff0000, v182
    v_lshlrev_b32 v182, 16, v182
    v_pk_mul_f32 v[40:41], v[172:173], v[180:181]
    v_pk_mul_f32 v[42:43], v[182:183], v[190:191]
    s_waitcnt vmcnt(11)
    v_lshlrev_b32 v152, 16, v92
    v_and_b32 v153, 0xffff0000, v92
    v_lshlrev_b32 v154, 16, v93
    v_and_b32 v155, 0xffff0000, v93
    v_pk_mul_f32 v[172:173], v[140:141], v[162:163]
    v_pk_mul_f32 v[174:175], v[144:145], v[160:161]
    v_pk_mul_f32 v[176:177], v[148:149], v[158:159]
    v_pk_mul_f32 v[178:179], v[152:153], v[156:157]
    v_pk_mul_f32 v[182:183], v[142:143], v[170:171]
    v_pk_mul_f32 v[184:185], v[146:147], v[168:169]
    v_pk_mul_f32 v[186:187], v[150:151], v[166:167]
    v_pk_mul_f32 v[188:189], v[154:155], v[164:165]
    v_cvt_pk_bf16_f32 v172, v172, v173
    v_cvt_pk_bf16_f32 v182, v182, v183
    v_cvt_pk_bf16_f32 v174, v174, v175
    v_cvt_pk_bf16_f32 v184, v184, v185
    v_cvt_pk_bf16_f32 v176, v176, v177
    v_cvt_pk_bf16_f32 v186, v186, v187
    v_cvt_pk_bf16_f32 v178, v178, v179
    v_cvt_pk_bf16_f32 v188, v188, v189
    v_and_b32 v173, 0xffff0000, v172
    v_lshlrev_b32 v172, 16, v172
    v_and_b32 v183, 0xffff0000, v182
    v_lshlrev_b32 v182, 16, v182
    v_and_b32 v175, 0xffff0000, v174
    v_lshlrev_b32 v174, 16, v174
    v_and_b32 v185, 0xffff0000, v184
    v_lshlrev_b32 v184, 16, v184
    v_and_b32 v177, 0xffff0000, v176
    v_lshlrev_b32 v176, 16, v176
    v_and_b32 v187, 0xffff0000, v186
    v_lshlrev_b32 v186, 16, v186
    v_and_b32 v179, 0xffff0000, v178
    v_lshlrev_b32 v178, 16, v178
    v_and_b32 v189, 0xffff0000, v188
    v_lshlrev_b32 v188, 16, v188
    v_lshlrev_b32 v180, 16, v110
    v_and_b32 v181, 0xffff0000, v110
    v_lshlrev_b32 v190, 16, v111
    v_and_b32 v191, 0xffff0000, v111
    v_pk_add_f32 v[172:173], v[172:173], v[174:175]
    v_pk_add_f32 v[182:183], v[182:183], v[184:185]
    v_cvt_pk_bf16_f32 v172, v172, v173
    v_cvt_pk_bf16_f32 v182, v182, v183
    v_and_b32 v173, 0xffff0000, v172
    v_lshlrev_b32 v172, 16, v172
    v_and_b32 v183, 0xffff0000, v182
    v_lshlrev_b32 v182, 16, v182
    v_pk_add_f32 v[172:173], v[172:173], v[176:177]
    v_pk_add_f32 v[182:183], v[182:183], v[186:187]
    v_cvt_pk_bf16_f32 v172, v172, v173
    v_cvt_pk_bf16_f32 v182, v182, v183
    v_and_b32 v173, 0xffff0000, v172
    v_lshlrev_b32 v172, 16, v172
    v_and_b32 v183, 0xffff0000, v182
    v_lshlrev_b32 v182, 16, v182
    v_pk_add_f32 v[172:173], v[172:173], v[178:179]
    v_pk_add_f32 v[182:183], v[182:183], v[188:189]
    v_cvt_pk_bf16_f32 v172, v172, v173
    v_cvt_pk_bf16_f32 v182, v182, v183
    v_and_b32 v173, 0xffff0000, v172
    v_lshlrev_b32 v172, 16, v172
    v_and_b32 v183, 0xffff0000, v182
    v_lshlrev_b32 v182, 16, v182
    v_pk_mul_f32 v[44:45], v[172:173], v[180:181]
    v_pk_mul_f32 v[46:47], v[182:183], v[190:191]
    v_cvt_pk_bf16_f32 v48, v44, v40
    v_cvt_pk_bf16_f32 v49, v36, v32
    v_cvt_pk_bf16_f32 v50, v28, v24
    v_cvt_pk_bf16_f32 v51, v20, v16
    buffer_store_dwordx4 v[48:51], v13, s[16:19], s44 offen sc1
    s_add_u32 s44, s44, 4096
    v_cvt_pk_bf16_f32 v52, v45, v41
    v_cvt_pk_bf16_f32 v53, v37, v33
    v_cvt_pk_bf16_f32 v54, v29, v25
    v_cvt_pk_bf16_f32 v55, v21, v17
    buffer_store_dwordx4 v[52:55], v13, s[16:19], s44 offen sc1
    s_add_u32 s44, s44, 4096
    v_cvt_pk_bf16_f32 v56, v46, v42
    v_cvt_pk_bf16_f32 v57, v38, v34
    v_cvt_pk_bf16_f32 v58, v30, v26
    v_cvt_pk_bf16_f32 v59, v22, v18
    buffer_store_dwordx4 v[56:59], v13, s[16:19], s44 offen sc1
    s_add_u32 s44, s44, 4096
    v_cvt_pk_bf16_f32 v60, v47, v43
    v_cvt_pk_bf16_f32 v61, v39, v35
    v_cvt_pk_bf16_f32 v62, v31, v27
    v_cvt_pk_bf16_f32 v63, v23, v19
    buffer_store_dwordx4 v[60:63], v13, s[16:19], s44 offen sc1
    v_mov_b32 v216, 0
    v_mov_b32 v217, 0
    v_mov_b32 v218, 0
    v_mov_b32 v219, 0
    v_mul_u32_u24 v9, 1280, v4
    v_lshl_add_u32 v9, v3, 4, v9
    v_add_u32 v9, s30, v9
    ds_write_b128 v9, v[216:219] offset:0
    v_add_u32 v10, s30, v5
    s_waitcnt vmcnt(4)
    ds_write_b128 v10, v[192:195] offset:5184
    v_alignbit_b32 v72, v193, v192, 16
    v_alignbit_b32 v73, v194, v193, 16
    v_alignbit_b32 v74, v195, v194, 16
    v_alignbit_b32 v75, v196, v195, 16
    v_mov_b32 v76, v193
    v_mov_b32 v77, v194
    v_mov_b32 v78, v195
    v_mov_b32 v79, v196
    v_alignbit_b32 v80, v194, v193, 16
    v_alignbit_b32 v81, v195, v194, 16
    v_alignbit_b32 v82, v196, v195, 16
    v_alignbit_b32 v83, v197, v196, 16
    ds_write_b128 v10, v[72:75] offset:9344
    ds_write_b128 v10, v[76:79] offset:13504
    ds_write_b128 v10, v[80:83] offset:17664
    ds_write_b128 v10, v[198:201] offset:6208
    v_alignbit_b32 v84, v199, v198, 16
    v_alignbit_b32 v85, v200, v199, 16
    v_alignbit_b32 v86, v201, v200, 16
    v_alignbit_b32 v87, v202, v201, 16
    v_mov_b32 v88, v199
    v_mov_b32 v89, v200
    v_mov_b32 v90, v201
    v_mov_b32 v91, v202
    v_alignbit_b32 v92, v200, v199, 16
    v_alignbit_b32 v93, v201, v200, 16
    v_alignbit_b32 v94, v202, v201, 16
    v_alignbit_b32 v95, v203, v202, 16
    ds_write_b128 v10, v[84:87] offset:10368
    ds_write_b128 v10, v[88:91] offset:14528
    ds_write_b128 v10, v[92:95] offset:18688
    s_add_u32 s12, s10, 125829120
    s_addc_u32 s13, s11, 0
    s_mov_b32 s14, 32768
    s_mov_b32 s15, 0x20000
    s_lshl_b32 s45, s32, 8
    s_and_b32 s46, s3, 15
    s_lshl_b32 s46, s46, 3
    s_add_u32 s46, s46, s45
    v_lshl_add_u32 v12, v3, 3, s45
    v_mov_b32 v11, s46
    s_mov_b32 s46, 0
    s_waitcnt vmcnt(0)
    s_barrier
    s_cmp_lg_u32 s28, 0
    s_cbranch_scc1 L_conv_nosig
L_conv_tag:
    v_cmp_ne_u64 vcc, 0, v[224:225]
    s_add_u32 s46, s46, 1
    s_cmp_ge_u32 s46, 200000
    s_cbranch_vccnz L_conv_tagok
    s_cbranch_scc1 L_conv_tagok
    buffer_load_dwordx2 v[224:225], v226, s[56:59], 0 offen sc1
    s_waitcnt vmcnt(0)
    s_branch L_conv_tag
L_conv_tagok:
    s_mov_b64 exec, 1
    buffer_store_dwordx2 v[224:225], v11, s[12:15], 0 offen sc1
    v_mov_b32 v227, 157808
    ds_write_b64 v227, v[224:225]
    s_mov_b64 exec, -1
L_conv_nosig:
    ds_write_b128 v10, v[204:207] offset:7232
    v_alignbit_b32 v96, v205, v204, 16
    v_alignbit_b32 v97, v206, v205, 16
    v_alignbit_b32 v98, v207, v206, 16
    v_alignbit_b32 v99, v208, v207, 16
    v_mov_b32 v100, v205
    v_mov_b32 v101, v206
    v_mov_b32 v102, v207
    v_mov_b32 v103, v208
    v_alignbit_b32 v104, v206, v205, 16
    v_alignbit_b32 v105, v207, v206, 16
    v_alignbit_b32 v106, v208, v207, 16
    v_alignbit_b32 v107, v209, v208, 16
    ds_write_b128 v10, v[96:99] offset:11392
    ds_write_b128 v10, v[100:103] offset:15552
    ds_write_b128 v10, v[104:107] offset:19712
    ds_write_b128 v10, v[210:213] offset:8256
    v_alignbit_b32 v108, v211, v210, 16
    v_alignbit_b32 v109, v212, v211, 16
    v_alignbit_b32 v110, v213, v212, 16
    v_alignbit_b32 v111, v214, v213, 16
    v_mov_b32 v112, v211
    v_mov_b32 v113, v212
    v_mov_b32 v114, v213
    v_mov_b32 v115, v214
    v_alignbit_b32 v116, v212, v211, 16
    v_alignbit_b32 v117, v213, v212, 16
    v_alignbit_b32 v118, v214, v213, 16
    v_alignbit_b32 v119, v215, v214, 16
    ds_write_b128 v10, v[108:111] offset:12416
    ds_write_b128 v10, v[112:115] offset:16576
    ds_write_b128 v10, v[116:119] offset:20736
    s_mov_b64 exec, 15
    ds_write_b128 v10, v[216:219] offset:5120
    v_alignbit_b32 v120, v217, v216, 16
    v_alignbit_b32 v121, v218, v217, 16
    v_alignbit_b32 v122, v219, v218, 16
    v_alignbit_b32 v123, v220, v219, 16
    v_mov_b32 v124, v217
    v_mov_b32 v125, v218
    v_mov_b32 v126, v219
    v_mov_b32 v127, v220
    v_alignbit_b32 v128, v218, v217, 16
    v_alignbit_b32 v129, v219, v218, 16
    v_alignbit_b32 v130, v220, v219, 16
    v_alignbit_b32 v131, v221, v220, 16
    ds_write_b128 v10, v[120:123] offset:9280
    ds_write_b128 v10, v[124:127] offset:13440
    ds_write_b128 v10, v[128:131] offset:17600
    s_mov_b64 exec, -1
    v_lshlrev_b32 v8, 16, v8
    v_add_u32 v11, 1, v3
    v_and_b32 v13, 3, v11
    v_sub_u32 v11, v11, v13
    v_lshlrev_b32 v14, 3, v4
    v_sub_u32 v11, v11, v14
    v_lshlrev_b32 v11, 1, v11
    v_mul_u32_u24 v13, 4160, v13
    v_add3_u32 v11, v11, v13, s30
    v_add_u32 v11, 5168, v11
    v_and_b32 v14, 3, v2
    v_mul_u32_u24 v14, 1280, v14
    v_lshrrev_b32 v15, 2, v2
    v_lshl_add_u32 v14, v15, 4, v14
    v_add_u32 v14, s30, v14
    v_mov_b32 v112, 0
    v_mov_b32 v113, 0
    v_mov_b32 v114, 0
    v_mov_b32 v115, 0
    v_mov_b32 v116, 0
    v_mov_b32 v117, 0
    v_mov_b32 v118, 0
    v_mov_b32 v119, 0
    v_mov_b32 v120, 0
    v_mov_b32 v121, 0
    v_mov_b32 v122, 0
    v_mov_b32 v123, 0
    v_mov_b32 v124, 0
    v_mov_b32 v125, 0
    v_mov_b32 v126, 0
    v_mov_b32 v127, 0
    v_mov_b32 v128, 0
    v_mov_b32 v129, 0
    v_mov_b32 v130, 0
    v_mov_b32 v131, 0
    v_mov_b32 v132, 0
    v_mov_b32 v133, 0
    v_mov_b32 v134, 0
    v_mov_b32 v135, 0
    v_mov_b32 v136, 0
    v_mov_b32 v137, 0
    v_mov_b32 v138, 0
    v_mov_b32 v139, 0
    v_mov_b32 v140, 0
    v_mov_b32 v141, 0
    v_mov_b32 v142, 0
    v_mov_b32 v143, 0
    s_mov_b32 s20, s52
    s_mov_b32 s21, s53
    s_mov_b32 s22, 5308416
    s_mov_b32 s23, 0x20000
    s_mul_i32 s47, s28, 9216
    s_mul_i32 s4, s3, 7282
    s_lshr_b32 s4, s4, 16
    s_mul_i32 s43, s4, 9
    s_sub_u32 s43, s3, s43
    s_and_b32 s5, s4, 1
    s_sub_u32 s43, s43, s5
    s_cselect_b32 s43, 8, s43
    s_and_b32 s40, s4, 12
    s_add_u32 s40, s40, s28
    s_sub_u32 s4, s4, s40
    s_and_b32 s4, s4, 3
    s_mul_i32 s42, s4, 6
    s_add_u32 s42, s42, 3
    s_mul_i32 s5, s4, 3
    s_add_u32 s5, s5, 18
    s_cmp_ge_u32 s43, 6
    s_cselect_b32 s42, s5, s42
    s_add_u32 s42, s42, s43
    s_add_u32 s5, s43, 2
    s_and_b32 s5, s5, 7
    s_cmp_eq_u32 s43, 8
    s_cselect_b32 s5, 8, s5
    s_cmp_eq_u32 s4, 0
    s_cselect_b32 s42, s5, s42
    s_lshr_b32 s41, s42, 2
    s_and_b32 s42, s42, 3
    s_mul_i32 s39, s3, 36864
    s_mul_i32 s5, s28, 288
    s_add_u32 s39, s39, s5
    s_mul_i32 s36, s40, 995328
    s_add_u32 s5, s41, 18
    s_mul_i32 s5, s5, 36864
    s_add_u32 s36, s36, s5
    s_lshl_b32 s5, s42, 10
    s_mul_i32 s42, s42, 9216
    s_cmp_eq_u32 s41, 8
    s_cselect_b32 s5, s5, s42
    s_cselect_b32 s37, 2, 0
    s_lshl_b32 s37, 1024, s37
    s_add_u32 s36, s36, s5
    s_and_b32 s5, s40, 1
    s_mul_i32 s5, s5, s37
    s_lshl_b32 s38, s5, 3
    s_add_u32 s38, s38, s36
    s_sub_u32 s36, s36, s5
    s_add_u32 s47, s47, 87040
    v_add_u32 v154, 0, v2
    v_mul_u32_u24 v155, 3641, v154
    v_lshrrev_b32 v155, 16, v155
    v_mul_u32_u24 v156, 18, v155
    v_sub_u32 v154, v154, v156
    v_mul_u32_u24 v155, 1152, v155
    v_lshl_add_u32 v155, v154, 4, v155
    v_subrev_u32 v144, 0, v155
    v_add_u32 v154, 64, v2
    v_mul_u32_u24 v155, 3641, v154
    v_lshrrev_b32 v155, 16, v155
    v_mul_u32_u24 v156, 18, v155
    v_sub_u32 v154, v154, v156
    v_mul_u32_u24 v155, 1152, v155
    v_lshl_add_u32 v155, v154, 4, v155
    v_subrev_u32 v145, 1024, v155
    v_add_u32 v154, 128, v2
    v_mul_u32_u24 v155, 3641, v154
    v_lshrrev_b32 v155, 16, v155
    v_mul_u32_u24 v156, 18, v155
    v_sub_u32 v154, v154, v156
    v_mul_u32_u24 v155, 1152, v155
    v_lshl_add_u32 v155, v154, 4, v155
    v_subrev_u32 v146, 2048, v155
    v_add_u32 v154, 192, v2
    v_mul_u32_u24 v155, 3641, v154
    v_lshrrev_b32 v155, 16, v155
    v_mul_u32_u24 v156, 18, v155
    v_sub_u32 v154, v154, v156
    v_mul_u32_u24 v155, 1152, v155
    v_lshl_add_u32 v155, v154, 4, v155
    v_subrev_u32 v147, 3072, v155
    v_add_u32 v154, 256, v2
    v_mul_u32_u24 v155, 3641, v154
    v_lshrrev_b32 v155, 16, v155
    v_mul_u32_u24 v156, 18, v155
    v_sub_u32 v154, v154, v156
    v_mul_u32_u24 v155, 1152, v155
    v_lshl_add_u32 v155, v154, 4, v155
    v_subrev_u32 v148, 0, v155
    v_add_u32 v154, 320, v2
    v_mul_u32_u24 v155, 3641, v154
    v_lshrrev_b32 v155, 16, v155
    v_mul_u32_u24 v156, 18, v155
    v_sub_u32 v154, v154, v156
    v_mul_u32_u24 v155, 1152, v155
    v_lshl_add_u32 v155, v154, 4, v155
    v_subrev_u32 v149, 1024, v155
    v_add_u32 v154, 384, v2
    v_mul_u32_u24 v155, 3641, v154
    v_lshrrev_b32 v155, 16, v155
    v_mul_u32_u24 v156, 18, v155
    v_sub_u32 v154, v154, v156
    v_mul_u32_u24 v155, 1152, v155
    v_lshl_add_u32 v155, v154, 4, v155
    v_subrev_u32 v150, 2048, v155
    v_add_u32 v154, 448, v2
    v_mul_u32_u24 v155, 3641, v154
    v_lshrrev_b32 v155, 16, v155
    v_mul_u32_u24 v156, 18, v155
    v_sub_u32 v154, v154, v156
    v_mul_u32_u24 v155, 1152, v155
    v_lshl_add_u32 v155, v154, 4, v155
    v_subrev_u32 v151, 3072, v155
    v_add_u32 v154, 512, v2
    v_mul_u32_u24 v155, 3641, v154
    v_lshrrev_b32 v155, 16, v155
    v_mul_u32_u24 v156, 18, v155
    v_sub_u32 v154, v154, v156
    v_mul_u32_u24 v155, 1152, v155
    v_lshl_add_u32 v155, v154, 4, v155
    v_subrev_u32 v152, 0, v155
    v_lshrrev_b32 v154, 2, v2
    v_and_b32 v155, 3, v2
    v_lshlrev_b32 v155, 3, v155
    v_mul_u32_u24 v153, 288, v154
    v_add3_u32 v153, v153, v155, s47
    v_lshrrev_b32 v216, 1, v4
    v_mul_u32_u24 v216, 1280, v216
    v_lshl_add_u32 v216, v3, 4, v216
    v_and_b32 v217, 1, v4
    v_xor_b32 v217, 1, v217
    v_lshl_add_u32 v216, v217, 3, v216
    v_add_u32 v216, s30, v216
    v_and_b32 v217, 1, v4
    v_lshrrev_b32 v218, 1, v4
    v_lshl_add_u32 v217, v217, 1, v218
    v_lshl_add_u32 v217, v3, 2, v217
    v_lshlrev_b32 v217, 4, v217
    s_lshl_b32 s35, s28, 6
    s_add_u32 s35, s35, s30
    v_add_u32 v217, s35, v217
    v_and_b32 v220, 3, v2
    v_lshrrev_b32 v219, 2, v2
    v_mul_u32_u24 v218, 21824, v220
    v_lshl_add_u32 v218, v219, 4, v218
    s_lshl_b32 s35, s28, 10
    v_add_u32 v218, s35, v218
    v_and_b32 v221, 1, v219
    v_sub_u32 v219, v219, v221
    v_mul_u32_u24 v219, 9216, v219
    v_lshl_add_u32 v219, v221, 6, v219
    v_lshl_add_u32 v219, v220, 4, v219
    s_lshl_b32 s34, s3, 3
    s_add_u32 s34, s34, 49152
    v_mov_b32 v220, s34
    v_mov_b32 v221, 2130706432
    v_cmp_eq_u32 vcc, 0, v0
    v_mov_b32 v233, 0
    s_mul_i32 s34, s28, 589824
    s_lshl_b32 s35, s3, 7
    s_add_u32 s34, s34, s35
    v_cndmask_b32 v221, v221, v220, vcc
    s_and_b32 s40, s2, 3
    s_lshl_b32 s40, s40, 2
    s_bfe_u32 s41, s2, 0x20003
    s_add_u32 s40, s40, s41
    s_lshr_b32 s43, s2, 5
    s_lshl_b32 s43, s43, 1
    s_bfe_u32 s41, s2, 0x10002
    s_add_u32 s43, s43, s41
    s_lshl_b32 s43, s43, 4
    s_add_u32 s43, s43, s40
    s_lshl_b32 s43, s43, 2
    s_add_u32 s43, s43, s28
    s_mul_i32 s43, s43, 2304
    v_and_b32 v154, 1, v0
    v_mul_u32_u24 v246, 1152, v154
    v_bfe_u32 v154, v0, 5, 1
    v_lshl_add_u32 v246, v154, 7, v246
    v_bfe_u32 v154, v0, 3, 1
    v_lshl_add_u32 v246, v154, 6, v246
    v_bfe_u32 v154, v0, 4, 1
    v_lshl_add_u32 v246, v154, 5, v246
    v_bfe_u32 v154, v0, 1, 2
    v_lshl_add_u32 v246, v154, 3, v246
    v_bfe_u32 v154, v0, 5, 1
    v_mul_u32_u24 v154, 0x7f0000, v154
    v_lshl_add_u32 v247, v154, 8, v246
    s_and_b32 s40, s2, 7
    s_lshl_b32 s40, s40, 10
    s_cmp_lg_u32 s28, 0
    s_cselect_b32 s40, 2130706432, s40
    v_and_b32 v154, 63, v0
    v_min_u32 v154, 55, v154
    v_lshl_add_u32 v227, v154, 4, s40
    s_load_dwordx2 s[6:7], s[0:1], 80
    v_mov_b32 v226, 157808
    s_waitcnt lgkmcnt(0)
    s_mov_b64 exec, 0
    s_cmp_lg_u32 s28, 1
    s_cbranch_scc1 L_wn_c2_0
    s_call_b64 s[98:99], L_pm_entry
    s_call_b64 s[98:99], L_pg_main2
    s_call_b64 s[98:99], L_pg_main5
    s_call_b64 s[98:99], L_pm_fin
L_wn_c2_0:
    s_cmp_lg_u32 s28, 2
    s_cbranch_scc1 L_wn_c2_1
    s_call_b64 s[98:99], L_pg_main0
    s_call_b64 s[98:99], L_pg_main3
    s_call_b64 s[98:99], L_pm_p1m
L_wn_c2_1:
    s_cmp_lg_u32 s28, 3
    s_cbranch_scc1 L_wn_c2_2
    s_call_b64 s[98:99], L_pg_main1
    s_call_b64 s[98:99], L_pg_main4
    s_call_b64 s[98:99], L_pm_p1
L_wn_c2_2:
    s_mov_b64 exec, -1
    s_cmp_lg_u32 s28, 0
    s_cbranch_scc1 L_conv_polled
    s_mov_b32 s46, 0
L_conv_poll:
    buffer_load_dwordx2 v[16:17], v12, s[12:15], 0 offen sc1
    s_add_u32 s46, s46, 1
    s_waitcnt vmcnt(0)
    v_cmp_ne_u64 vcc, v[16:17], v[224:225]
    s_cmp_ge_u32 s46, 200000
    s_cbranch_vccz L_conv_polled
    s_cbranch_scc1 L_conv_polled
    s_branch L_conv_poll
L_conv_polled:
    s_barrier
    buffer_load_dwordx4 v[16:19], v5, s[16:19], s31 offen offset:0 sc1
    buffer_load_dwordx4 v[20:23], v5, s[16:19], s31 offen offset:1024 sc1
    buffer_load_dwordx4 v[24:27], v5, s[16:19], s31 offen offset:2048 sc1
    buffer_load_dwordx4 v[28:31], v5, s[16:19], s31 offen offset:3072 sc1
    v_add_u32 v12, 240, v9
    s_waitcnt vmcnt(3)
    ds_write_b128 v14, v[16:19] offset:256
    s_waitcnt vmcnt(2)
    ds_write_b128 v14, v[20:23] offset:512
    s_waitcnt vmcnt(1)
    ds_write_b128 v14, v[24:27] offset:768
    s_waitcnt vmcnt(0)
    ds_write_b128 v14, v[28:31] offset:1024
    s_add_u32 m0, s47, 0
    s_nop 0
    buffer_load_dwordx4 v144, s[20:23], s39 offen offset:0 nt lds
    buffer_load_dwordx4 v145, s[20:23], s39 offen offset:1024 nt lds
    buffer_load_dwordx4 v146, s[20:23], s39 offen offset:2048 nt lds
    buffer_load_dwordx4 v147, s[20:23], s39 offen offset:3072 nt lds
    s_add_u32 m0, s47, 4096
    s_nop 0
    buffer_load_dwordx4 v148, s[20:23], s39 offen offset:0 nt lds
    buffer_load_dwordx4 v149, s[20:23], s39 offen offset:1024 nt lds
    buffer_load_dwordx4 v150, s[20:23], s39 offen offset:2048 nt lds
    buffer_load_dwordx4 v151, s[20:23], s39 offen offset:3072 nt lds
    s_add_u32 m0, s47, 8192
    s_nop 0
    buffer_load_dwordx4 v152, s[20:23], s39 offen offset:0 nt lds
    s_mov_b32 s56, s54
    s_mov_b32 s57, s55
    s_mov_b32 s58, 2359296
    s_mov_b32 s59, 0x20000
    ds_read_b64 v[224:225], v226
    s_add_u32 s12, s10, 125927424
    s_addc_u32 s13, s11, 0
    s_mov_b32 s14, 28672
    s_mov_b32 s15, 0x20000
    s_waitcnt lgkmcnt(0)
L_pg_conv1:
    s_cbranch_execz L_wret
    ds_read_b64 v[200:201], v216 offset:256
    ds_read_b64 v[202:203], v216 offset:2816
    ds_read_b64 v[204:205], v216 offset:512
    ds_read_b64 v[206:207], v216 offset:3072
    ds_read_b64 v[208:209], v216 offset:768
    ds_read_b64 v[210:211], v216 offset:3328
    ds_read_b64 v[212:213], v216 offset:1024
    ds_read_b64 v[214:215], v216 offset:3584
    ds_read_b128 v[48:51], v12 offset:16
    ds_read_b64 v[16:17], v11 offset:0
    ds_read_b64 v[18:19], v11 offset:8
    ds_read_b128 v[52:55], v12 offset:272
    ds_read_b128 v[56:59], v12 offset:528
    ds_read_b128 v[60:63], v12 offset:784
    ds_read_b64 v[20:21], v11 offset:32
    ds_read_b64 v[22:23], v11 offset:40
    ds_read_b64 v[24:25], v11 offset:1024
    ds_read_b64 v[26:27], v11 offset:1032
    ds_read_b64 v[28:29], v11 offset:1056
    ds_read_b64 v[30:31], v11 offset:1064
    ds_read_b64 v[32:33], v11 offset:2048
    ds_read_b64 v[34:35], v11 offset:2056
    ds_read_b64 v[36:37], v11 offset:2080
    ds_read_b64 v[38:39], v11 offset:2088
    ds_read_b64 v[40:41], v11 offset:3072
    ds_read_b64 v[42:43], v11 offset:3080
    ds_read_b64 v[44:45], v11 offset:3104
    ds_read_b64 v[46:47], v11 offset:3112
    s_mov_b32 s33, 0
L_conv_loop:
    s_waitcnt lgkmcnt(12)
    v_mfma_f32_16x16x32_bf16 v[112:115], v[16:19], v[48:51], v[112:115]
    ds_read_b128 v[96:99], v12 offset:0
    v_mfma_f32_16x16x32_bf16 v[120:123], v[16:19], v[52:55], v[120:123]
    ds_read_b64 v[64:65], v11 offset:64
    v_mfma_f32_16x16x32_bf16 v[128:131], v[16:19], v[56:59], v[128:131]
    ds_read_b64 v[66:67], v11 offset:72
    v_mfma_f32_16x16x32_bf16 v[136:139], v[16:19], v[60:63], v[136:139]
    ds_read_b128 v[100:103], v12 offset:256
    v_mfma_f32_16x16x32_bf16 v[116:119], v[20:23], v[48:51], v[116:119]
    ds_read_b128 v[104:107], v12 offset:512
    v_mfma_f32_16x16x32_bf16 v[124:127], v[20:23], v[52:55], v[124:127]
    ds_read_b128 v[108:111], v12 offset:768
    v_mfma_f32_16x16x32_bf16 v[132:135], v[20:23], v[56:59], v[132:135]
    ds_read_b64 v[68:69], v11 offset:96
    v_mfma_f32_16x16x32_bf16 v[140:143], v[20:23], v[60:63], v[140:143]
    ds_read_b64 v[70:71], v11 offset:104
    s_waitcnt lgkmcnt(14)
    v_mfma_f32_16x16x32_bf16 v[120:123], v[24:27], v[48:51], v[120:123]
    ds_read_b64 v[72:73], v11 offset:1088
    v_mfma_f32_16x16x32_bf16 v[128:131], v[24:27], v[52:55], v[128:131]
    ds_read_b64 v[74:75], v11 offset:1096
    v_mfma_f32_16x16x32_bf16 v[136:139], v[24:27], v[56:59], v[136:139]
    ds_read_b64 v[76:77], v11 offset:1120
    v_mfma_f32_16x16x32_bf16 v[124:127], v[28:31], v[48:51], v[124:127]
    ds_read_b64 v[78:79], v11 offset:1128
    v_mfma_f32_16x16x32_bf16 v[132:135], v[28:31], v[52:55], v[132:135]
    ds_read_b64 v[80:81], v11 offset:2112
    v_mfma_f32_16x16x32_bf16 v[140:143], v[28:31], v[56:59], v[140:143]
    ds_read_b64 v[82:83], v11 offset:2120
    v_mfma_f32_16x16x32_bf16 v[128:131], v[32:35], v[48:51], v[128:131]
    ds_read_b64 v[84:85], v11 offset:2144
    v_mfma_f32_16x16x32_bf16 v[136:139], v[32:35], v[52:55], v[136:139]
    ds_read_b64 v[86:87], v11 offset:2152
    s_waitcnt lgkmcnt(15)
    v_mfma_f32_16x16x32_bf16 v[132:135], v[36:39], v[48:51], v[132:135]
    ds_read_b64 v[88:89], v11 offset:3136
    v_mfma_f32_16x16x32_bf16 v[140:143], v[36:39], v[52:55], v[140:143]
    ds_read_b64 v[90:91], v11 offset:3144
    v_mfma_f32_16x16x32_bf16 v[136:139], v[40:43], v[48:51], v[136:139]
    ds_read_b64 v[92:93], v11 offset:3168
    v_mfma_f32_16x16x32_bf16 v[140:143], v[44:47], v[48:51], v[140:143]
    ds_read_b64 v[94:95], v11 offset:3176
    v_add_u32 v11, 128, v11
    v_subrev_u32 v12, 32, v12
    s_waitcnt lgkmcnt(12)
    v_mfma_f32_16x16x32_bf16 v[112:115], v[64:67], v[96:99], v[112:115]
    ds_read_b128 v[48:51], v12 offset:16
    v_mfma_f32_16x16x32_bf16 v[120:123], v[64:67], v[100:103], v[120:123]
    ds_read_b64 v[16:17], v11 offset:0
    v_mfma_f32_16x16x32_bf16 v[128:131], v[64:67], v[104:107], v[128:131]
    ds_read_b64 v[18:19], v11 offset:8
    v_mfma_f32_16x16x32_bf16 v[136:139], v[64:67], v[108:111], v[136:139]
    ds_read_b128 v[52:55], v12 offset:272
    v_mfma_f32_16x16x32_bf16 v[116:119], v[68:71], v[96:99], v[116:119]
    ds_read_b128 v[56:59], v12 offset:528
    v_mfma_f32_16x16x32_bf16 v[124:127], v[68:71], v[100:103], v[124:127]
    ds_read_b128 v[60:63], v12 offset:784
    v_mfma_f32_16x16x32_bf16 v[132:135], v[68:71], v[104:107], v[132:135]
    ds_read_b64 v[20:21], v11 offset:32
    v_mfma_f32_16x16x32_bf16 v[140:143], v[68:71], v[108:111], v[140:143]
    ds_read_b64 v[22:23], v11 offset:40
    s_waitcnt lgkmcnt(14)
    v_mfma_f32_16x16x32_bf16 v[120:123], v[72:75], v[96:99], v[120:123]
    ds_read_b64 v[24:25], v11 offset:1024
    v_mfma_f32_16x16x32_bf16 v[128:131], v[72:75], v[100:103], v[128:131]
    ds_read_b64 v[26:27], v11 offset:1032
    v_mfma_f32_16x16x32_bf16 v[136:139], v[72:75], v[104:107], v[136:139]
    ds_read_b64 v[28:29], v11 offset:1056
    v_mfma_f32_16x16x32_bf16 v[124:127], v[76:79], v[96:99], v[124:127]
    ds_read_b64 v[30:31], v11 offset:1064
    v_mfma_f32_16x16x32_bf16 v[132:135], v[76:79], v[100:103], v[132:135]
    ds_read_b64 v[32:33], v11 offset:2048
    v_mfma_f32_16x16x32_bf16 v[140:143], v[76:79], v[104:107], v[140:143]
    ds_read_b64 v[34:35], v11 offset:2056
    v_mfma_f32_16x16x32_bf16 v[128:131], v[80:83], v[96:99], v[128:131]
    ds_read_b64 v[36:37], v11 offset:2080
    v_mfma_f32_16x16x32_bf16 v[136:139], v[80:83], v[100:103], v[136:139]
    ds_read_b64 v[38:39], v11 offset:2088
    s_waitcnt lgkmcnt(15)
    v_mfma_f32_16x16x32_bf16 v[132:135], v[84:87], v[96:99], v[132:135]
    ds_read_b64 v[40:41], v11 offset:3072
    v_mfma_f32_16x16x32_bf16 v[140:143], v[84:87], v[100:103], v[140:143]
    ds_read_b64 v[42:43], v11 offset:3080
    v_mfma_f32_16x16x32_bf16 v[136:139], v[88:91], v[96:99], v[136:139]
    ds_read_b64 v[44:45], v11 offset:3104
    v_mfma_f32_16x16x32_bf16 v[140:143], v[92:95], v[96:99], v[140:143]
    ds_read_b64 v[46:47], v11 offset:3112
    s_add_u32 s33, s33, 1
    s_cmp_lt_u32 s33, 4
    s_cbranch_scc1 L_conv_loop
    v_readfirstlane_b32 s100, v224
    v_readfirstlane_b32 s101, v225
    s_waitcnt lgkmcnt(12)
    v_mfma_f32_16x16x32_bf16 v[112:115], v[16:19], v[48:51], v[112:115]
    ds_read_b128 v[96:99], v12 offset:0
    v_mov_b32 v9, v8
    v_mfma_f32_16x16x32_bf16 v[120:123], v[16:19], v[52:55], v[120:123]
    ds_read_b64 v[64:65], v11 offset:64
    buffer_load_dwordx4 v[228:231], v227, s[12:15], 0 offen sc1
    v_mfma_f32_16x16x32_bf16 v[128:131], v[16:19], v[56:59], v[128:131]
    ds_read_b64 v[66:67], v11 offset:72
    v_and_b32 v188, 0xffff0000, v201
    v_mfma_f32_16x16x32_bf16 v[136:139], v[16:19], v[60:63], v[136:139]
    ds_read_b128 v[100:103], v12 offset:256
    v_lshlrev_b32 v189, 16, v201
    v_mfma_f32_16x16x32_bf16 v[116:119], v[20:23], v[48:51], v[116:119]
    ds_read_b128 v[104:107], v12 offset:512
    buffer_load_dwordx2 v[236:237], v246, s[56:59], s43 offen offset:0
    v_mfma_f32_16x16x32_bf16 v[124:127], v[20:23], v[52:55], v[124:127]
    ds_read_b128 v[108:111], v12 offset:768
    v_mfma_f32_16x16x32_bf16 v[132:135], v[20:23], v[56:59], v[132:135]
    ds_read_b64 v[68:69], v11 offset:96
    v_and_b32 v190, 0xffff0000, v200
    v_mfma_f32_16x16x32_bf16 v[140:143], v[20:23], v[60:63], v[140:143]
    ds_read_b64 v[70:71], v11 offset:104
    buffer_load_dwordx2 v[238:239], v246, s[56:59], s43 offen offset:256
    s_waitcnt lgkmcnt(14)
    v_mfma_f32_16x16x32_bf16 v[120:123], v[24:27], v[48:51], v[120:123]
    ds_read_b64 v[72:73], v11 offset:1088
    v_lshlrev_b32 v191, 16, v200
    v_mfma_f32_16x16x32_bf16 v[128:131], v[24:27], v[52:55], v[128:131]
    ds_read_b64 v[74:75], v11 offset:1096
    v_pk_mul_f32 v[188:189], v[188:189], v[8:9]
    v_mfma_f32_16x16x32_bf16 v[136:139], v[24:27], v[56:59], v[136:139]
    ds_read_b64 v[76:77], v11 offset:1120
    buffer_load_dwordx2 v[240:241], v246, s[56:59], s43 offen offset:512
    v_mfma_f32_16x16x32_bf16 v[124:127], v[28:31], v[48:51], v[124:127]
    ds_read_b64 v[78:79], v11 offset:1128
    v_mfma_f32_16x16x32_bf16 v[132:135], v[28:31], v[52:55], v[132:135]
    ds_read_b64 v[80:81], v11 offset:2112
    v_pk_mul_f32 v[190:191], v[190:191], v[8:9]
    v_mfma_f32_16x16x32_bf16 v[140:143], v[28:31], v[56:59], v[140:143]
    ds_read_b64 v[82:83], v11 offset:2120
    buffer_load_dwordx2 v[242:243], v246, s[56:59], s43 offen offset:768
    v_mfma_f32_16x16x32_bf16 v[128:131], v[32:35], v[48:51], v[128:131]
    ds_read_b64 v[84:85], v11 offset:2144
    v_cvt_pk_bf16_f32 v192, v188, v189
    v_mfma_f32_16x16x32_bf16 v[136:139], v[32:35], v[52:55], v[136:139]
    ds_read_b64 v[86:87], v11 offset:2152
    s_waitcnt lgkmcnt(15)
    v_mfma_f32_16x16x32_bf16 v[132:135], v[36:39], v[48:51], v[132:135]
    ds_read_b64 v[88:89], v11 offset:3136
    buffer_load_dwordx2 v[244:245], v247, s[56:59], s43 offen offset:1024
    v_mfma_f32_16x16x32_bf16 v[140:143], v[36:39], v[52:55], v[140:143]
    ds_read_b64 v[90:91], v11 offset:3144
    v_cvt_pk_bf16_f32 v193, v190, v191
    v_mfma_f32_16x16x32_bf16 v[136:139], v[40:43], v[48:51], v[136:139]
    ds_read_b64 v[92:93], v11 offset:3168
    v_lshlrev_b32 v156, 16, v192
    v_mfma_f32_16x16x32_bf16 v[140:143], v[44:47], v[48:51], v[140:143]
    ds_read_b64 v[94:95], v11 offset:3176
    v_add_u32 v11, 128, v11
    v_subrev_u32 v12, 32, v12
    v_and_b32 v157, 0xffff0000, v192
    s_waitcnt lgkmcnt(12)
    v_mfma_f32_16x16x32_bf16 v[112:115], v[64:67], v[96:99], v[112:115]
    ds_read_b128 v[48:51], v12 offset:16
    v_mfma_f32_16x16x32_bf16 v[120:123], v[64:67], v[100:103], v[120:123]
    ds_read_b64 v[16:17], v11 offset:0
    v_lshlrev_b32 v158, 16, v193
    v_mfma_f32_16x16x32_bf16 v[128:131], v[64:67], v[104:107], v[128:131]
    ds_read_b64 v[18:19], v11 offset:8
    v_and_b32 v159, 0xffff0000, v193
    v_mfma_f32_16x16x32_bf16 v[136:139], v[64:67], v[108:111], v[136:139]
    ds_read_b128 v[52:55], v12 offset:272
    v_and_b32 v194, 0xffff0000, v203
    v_mfma_f32_16x16x32_bf16 v[116:119], v[68:71], v[96:99], v[116:119]
    ds_read_b128 v[56:59], v12 offset:528
    v_mfma_f32_16x16x32_bf16 v[124:127], v[68:71], v[100:103], v[124:127]
    ds_read_b128 v[60:63], v12 offset:784
    v_lshlrev_b32 v195, 16, v203
    v_mfma_f32_16x16x32_bf16 v[132:135], v[68:71], v[104:107], v[132:135]
    ds_read_b64 v[20:21], v11 offset:32
    v_and_b32 v196, 0xffff0000, v202
    v_mfma_f32_16x16x32_bf16 v[140:143], v[68:71], v[108:111], v[140:143]
    ds_read_b64 v[22:23], v11 offset:40
    s_waitcnt lgkmcnt(14)
    v_mfma_f32_16x16x32_bf16 v[120:123], v[72:75], v[96:99], v[120:123]
    ds_read_b64 v[24:25], v11 offset:1024
    v_lshlrev_b32 v197, 16, v202
    v_mfma_f32_16x16x32_bf16 v[128:131], v[72:75], v[100:103], v[128:131]
    ds_read_b64 v[26:27], v11 offset:1032
    v_pk_mul_f32 v[194:195], v[194:195], v[8:9]
    v_mfma_f32_16x16x32_bf16 v[136:139], v[72:75], v[104:107], v[136:139]
    ds_read_b64 v[28:29], v11 offset:1056
    v_pk_mul_f32 v[196:197], v[196:197], v[8:9]
    v_mfma_f32_16x16x32_bf16 v[124:127], v[76:79], v[96:99], v[124:127]
    ds_read_b64 v[30:31], v11 offset:1064
    v_mfma_f32_16x16x32_bf16 v[132:135], v[76:79], v[100:103], v[132:135]
    ds_read_b64 v[32:33], v11 offset:2048
    v_cvt_pk_bf16_f32 v198, v194, v195
    v_mfma_f32_16x16x32_bf16 v[140:143], v[76:79], v[104:107], v[140:143]
    ds_read_b64 v[34:35], v11 offset:2056
    v_cvt_pk_bf16_f32 v199, v196, v197
    v_mfma_f32_16x16x32_bf16 v[128:131], v[80:83], v[96:99], v[128:131]
    ds_read_b64 v[36:37], v11 offset:2080
    v_mfma_f32_16x16x32_bf16 v[136:139], v[80:83], v[100:103], v[136:139]
    ds_read_b64 v[38:39], v11 offset:2088
    v_lshlrev_b32 v160, 16, v198
    s_waitcnt lgkmcnt(15)
    v_mfma_f32_16x16x32_bf16 v[132:135], v[84:87], v[96:99], v[132:135]
    ds_read_b64 v[40:41], v11 offset:3072
    v_and_b32 v161, 0xffff0000, v198
    v_mfma_f32_16x16x32_bf16 v[140:143], v[84:87], v[100:103], v[140:143]
    ds_read_b64 v[42:43], v11 offset:3080
    v_lshlrev_b32 v162, 16, v199
    v_mfma_f32_16x16x32_bf16 v[136:139], v[88:91], v[96:99], v[136:139]
    ds_read_b64 v[44:45], v11 offset:3104
    v_mfma_f32_16x16x32_bf16 v[140:143], v[92:95], v[96:99], v[140:143]
    ds_read_b64 v[46:47], v11 offset:3112
    v_and_b32 v163, 0xffff0000, v199
    s_waitcnt lgkmcnt(12)
    v_mfma_f32_16x16x32_bf16 v[112:115], v[16:19], v[48:51], v[112:115]
    ds_read_b128 v[96:99], v12 offset:0
    v_and_b32 v188, 0xffff0000, v205
    v_mfma_f32_16x16x32_bf16 v[120:123], v[16:19], v[52:55], v[120:123]
    ds_read_b64 v[64:65], v11 offset:64
    v_lshlrev_b32 v189, 16, v205
    v_mfma_f32_16x16x32_bf16 v[128:131], v[16:19], v[56:59], v[128:131]
    ds_read_b64 v[66:67], v11 offset:72
    v_mfma_f32_16x16x32_bf16 v[136:139], v[16:19], v[60:63], v[136:139]
    ds_read_b128 v[100:103], v12 offset:256
    v_and_b32 v190, 0xffff0000, v204
    v_mfma_f32_16x16x32_bf16 v[116:119], v[20:23], v[48:51], v[116:119]
    ds_read_b128 v[104:107], v12 offset:512
    v_lshlrev_b32 v191, 16, v204
    v_mfma_f32_16x16x32_bf16 v[124:127], v[20:23], v[52:55], v[124:127]
    ds_read_b128 v[108:111], v12 offset:768
    v_mfma_f32_16x16x32_bf16 v[132:135], v[20:23], v[56:59], v[132:135]
    ds_read_b64 v[68:69], v11 offset:96
    v_pk_mul_f32 v[188:189], v[188:189], v[8:9]
    v_mfma_f32_16x16x32_bf16 v[140:143], v[20:23], v[60:63], v[140:143]
    ds_read_b64 v[70:71], v11 offset:104
    v_pk_mul_f32 v[190:191], v[190:191], v[8:9]
    s_waitcnt lgkmcnt(14)
    v_mfma_f32_16x16x32_bf16 v[120:123], v[24:27], v[48:51], v[120:123]
    ds_read_b64 v[72:73], v11 offset:1088
    v_cvt_pk_bf16_f32 v192, v188, v189
    v_mfma_f32_16x16x32_bf16 v[128:131], v[24:27], v[52:55], v[128:131]
    ds_read_b64 v[74:75], v11 offset:1096
    v_mfma_f32_16x16x32_bf16 v[136:139], v[24:27], v[56:59], v[136:139]
    ds_read_b64 v[76:77], v11 offset:1120
    v_cvt_pk_bf16_f32 v193, v190, v191
    v_mfma_f32_16x16x32_bf16 v[124:127], v[28:31], v[48:51], v[124:127]
    ds_read_b64 v[78:79], v11 offset:1128
    v_lshlrev_b32 v164, 16, v192
    v_mfma_f32_16x16x32_bf16 v[132:135], v[28:31], v[52:55], v[132:135]
    ds_read_b64 v[80:81], v11 offset:2112
    v_and_b32 v165, 0xffff0000, v192
    v_mfma_f32_16x16x32_bf16 v[140:143], v[28:31], v[56:59], v[140:143]
    ds_read_b64 v[82:83], v11 offset:2120
    v_mfma_f32_16x16x32_bf16 v[128:131], v[32:35], v[48:51], v[128:131]
    ds_read_b64 v[84:85], v11 offset:2144
    v_lshlrev_b32 v166, 16, v193
    v_mfma_f32_16x16x32_bf16 v[136:139], v[32:35], v[52:55], v[136:139]
    ds_read_b64 v[86:87], v11 offset:2152
    v_and_b32 v167, 0xffff0000, v193
    s_waitcnt lgkmcnt(15)
    v_mfma_f32_16x16x32_bf16 v[132:135], v[36:39], v[48:51], v[132:135]
    ds_read_b64 v[88:89], v11 offset:3136
    v_mfma_f32_16x16x32_bf16 v[140:143], v[36:39], v[52:55], v[140:143]
    ds_read_b64 v[90:91], v11 offset:3144
    v_and_b32 v194, 0xffff0000, v207
    v_mfma_f32_16x16x32_bf16 v[136:139], v[40:43], v[48:51], v[136:139]
    ds_read_b64 v[92:93], v11 offset:3168
    v_lshlrev_b32 v195, 16, v207
    v_mfma_f32_16x16x32_bf16 v[140:143], v[44:47], v[48:51], v[140:143]
    ds_read_b64 v[94:95], v11 offset:3176
    v_add_u32 v11, 128, v11
    v_subrev_u32 v12, 32, v12
    v_and_b32 v196, 0xffff0000, v206
    s_waitcnt lgkmcnt(12)
    v_mfma_f32_16x16x32_bf16 v[112:115], v[64:67], v[96:99], v[112:115]
    ds_read_b128 v[48:51], v12 offset:16
    v_mfma_f32_16x16x32_bf16 v[120:123], v[64:67], v[100:103], v[120:123]
    ds_read_b64 v[16:17], v11 offset:0
    v_lshlrev_b32 v197, 16, v206
    v_mfma_f32_16x16x32_bf16 v[128:131], v[64:67], v[104:107], v[128:131]
    ds_read_b64 v[18:19], v11 offset:8
    v_pk_mul_f32 v[194:195], v[194:195], v[8:9]
    v_mfma_f32_16x16x32_bf16 v[136:139], v[64:67], v[108:111], v[136:139]
    ds_read_b128 v[52:55], v12 offset:272
    v_mfma_f32_16x16x32_bf16 v[116:119], v[68:71], v[96:99], v[116:119]
    ds_read_b128 v[56:59], v12 offset:528
    v_pk_mul_f32 v[196:197], v[196:197], v[8:9]
    v_mfma_f32_16x16x32_bf16 v[124:127], v[68:71], v[100:103], v[124:127]
    ds_read_b128 v[60:63], v12 offset:784
    v_cvt_pk_bf16_f32 v198, v194, v195
    v_mfma_f32_16x16x32_bf16 v[132:135], v[68:71], v[104:107], v[132:135]
    ds_read_b64 v[20:21], v11 offset:32
    v_cvt_pk_bf16_f32 v199, v196, v197
    v_mfma_f32_16x16x32_bf16 v[140:143], v[68:71], v[108:111], v[140:143]
    ds_read_b64 v[22:23], v11 offset:40
    s_waitcnt lgkmcnt(14)
    v_mfma_f32_16x16x32_bf16 v[120:123], v[72:75], v[96:99], v[120:123]
    ds_read_b64 v[24:25], v11 offset:1024
    v_lshlrev_b32 v168, 16, v198
    v_mfma_f32_16x16x32_bf16 v[128:131], v[72:75], v[100:103], v[128:131]
    ds_read_b64 v[26:27], v11 offset:1032
    v_and_b32 v169, 0xffff0000, v198
    v_mfma_f32_16x16x32_bf16 v[136:139], v[72:75], v[104:107], v[136:139]
    ds_read_b64 v[28:29], v11 offset:1056
    v_lshlrev_b32 v170, 16, v199
    v_mfma_f32_16x16x32_bf16 v[124:127], v[76:79], v[96:99], v[124:127]
    ds_read_b64 v[30:31], v11 offset:1064
    v_mfma_f32_16x16x32_bf16 v[132:135], v[76:79], v[100:103], v[132:135]
    ds_read_b64 v[32:33], v11 offset:2048
    v_and_b32 v171, 0xffff0000, v199
    v_mfma_f32_16x16x32_bf16 v[140:143], v[76:79], v[104:107], v[140:143]
    ds_read_b64 v[34:35], v11 offset:2056
    v_and_b32 v188, 0xffff0000, v209
    v_mfma_f32_16x16x32_bf16 v[128:131], v[80:83], v[96:99], v[128:131]
    ds_read_b64 v[36:37], v11 offset:2080
    v_mfma_f32_16x16x32_bf16 v[136:139], v[80:83], v[100:103], v[136:139]
    ds_read_b64 v[38:39], v11 offset:2088
    v_lshlrev_b32 v189, 16, v209
    s_waitcnt lgkmcnt(15)
    v_mfma_f32_16x16x32_bf16 v[132:135], v[84:87], v[96:99], v[132:135]
    ds_read_b64 v[40:41], v11 offset:3072
    v_and_b32 v190, 0xffff0000, v208
    v_mfma_f32_16x16x32_bf16 v[140:143], v[84:87], v[100:103], v[140:143]
    ds_read_b64 v[42:43], v11 offset:3080
    v_lshlrev_b32 v191, 16, v208
    v_mfma_f32_16x16x32_bf16 v[136:139], v[88:91], v[96:99], v[136:139]
    ds_read_b64 v[44:45], v11 offset:3104
    v_mfma_f32_16x16x32_bf16 v[140:143], v[92:95], v[96:99], v[140:143]
    ds_read_b64 v[46:47], v11 offset:3112
    v_pk_mul_f32 v[188:189], v[188:189], v[8:9]
    s_waitcnt vmcnt(6)
    s_waitcnt lgkmcnt(12)
    v_mfma_f32_16x16x32_bf16 v[112:115], v[16:19], v[48:51], v[112:115]
    ds_read_b128 v[96:99], v12 offset:0
    ds_read_b64_tr_b16 a[192:193], v153 offset:0
    v_mfma_f32_16x16x32_bf16 v[120:123], v[16:19], v[52:55], v[120:123]
    ds_read_b64 v[64:65], v11 offset:64
    ds_read_b64_tr_b16 a[194:195], v153 offset:4608
    v_mfma_f32_16x16x32_bf16 v[128:131], v[16:19], v[56:59], v[128:131]
    ds_read_b64 v[66:67], v11 offset:72
    ds_read_b64_tr_b16 a[196:197], v153 offset:32
    v_mfma_f32_16x16x32_bf16 v[136:139], v[16:19], v[60:63], v[136:139]
    ds_read_b128 v[100:103], v12 offset:256
    ds_read_b64_tr_b16 a[198:199], v153 offset:4640
    v_mfma_f32_16x16x32_bf16 v[116:119], v[20:23], v[48:51], v[116:119]
    ds_read_b128 v[104:107], v12 offset:512
    ds_read_b64_tr_b16 a[200:201], v153 offset:64
    v_mfma_f32_16x16x32_bf16 v[124:127], v[20:23], v[52:55], v[124:127]
    ds_read_b128 v[108:111], v12 offset:768
    ds_read_b64_tr_b16 a[202:203], v153 offset:4672
    v_mfma_f32_16x16x32_bf16 v[132:135], v[20:23], v[56:59], v[132:135]
    ds_read_b64 v[68:69], v11 offset:96
    ds_read_b64_tr_b16 a[204:205], v153 offset:96
    v_mfma_f32_16x16x32_bf16 v[140:143], v[20:23], v[60:63], v[140:143]
    ds_read_b64 v[70:71], v11 offset:104
    ds_read_b64_tr_b16 a[206:207], v153 offset:4704
    s_waitcnt lgkmcnt(15)
    v_mfma_f32_16x16x32_bf16 v[120:123], v[24:27], v[48:51], v[120:123]
    ds_read_b64 v[72:73], v11 offset:1088
    ds_read_b64_tr_b16 a[208:209], v153 offset:128
    v_mfma_f32_16x16x32_bf16 v[128:131], v[24:27], v[52:55], v[128:131]
    ds_read_b64 v[74:75], v11 offset:1096
    ds_read_b64_tr_b16 a[210:211], v153 offset:4736
    v_mfma_f32_16x16x32_bf16 v[136:139], v[24:27], v[56:59], v[136:139]
    ds_read_b64 v[76:77], v11 offset:1120
    ds_read_b64_tr_b16 a[212:213], v153 offset:160
    v_mfma_f32_16x16x32_bf16 v[124:127], v[28:31], v[48:51], v[124:127]
    ds_read_b64 v[78:79], v11 offset:1128
    ds_read_b64_tr_b16 a[214:215], v153 offset:4768
    v_mfma_f32_16x16x32_bf16 v[132:135], v[28:31], v[52:55], v[132:135]
    ds_read_b64 v[80:81], v11 offset:2112
    ds_read_b64_tr_b16 a[216:217], v153 offset:192
    v_mfma_f32_16x16x32_bf16 v[140:143], v[28:31], v[56:59], v[140:143]
    ds_read_b64 v[82:83], v11 offset:2120
    ds_read_b64_tr_b16 a[218:219], v153 offset:4800
    v_mfma_f32_16x16x32_bf16 v[128:131], v[32:35], v[48:51], v[128:131]
    ds_read_b64 v[84:85], v11 offset:2144
    ds_read_b64_tr_b16 a[220:221], v153 offset:224
    v_mfma_f32_16x16x32_bf16 v[136:139], v[32:35], v[52:55], v[136:139]
    ds_read_b64 v[86:87], v11 offset:2152
    ds_read_b64_tr_b16 a[222:223], v153 offset:4832
    s_waitcnt lgkmcnt(15)
    v_mfma_f32_16x16x32_bf16 v[132:135], v[36:39], v[48:51], v[132:135]
    ds_read_b64 v[88:89], v11 offset:3136
    ds_read_b64_tr_b16 a[224:225], v153 offset:256
    v_mfma_f32_16x16x32_bf16 v[140:143], v[36:39], v[52:55], v[140:143]
    ds_read_b64 v[90:91], v11 offset:3144
    ds_read_b64_tr_b16 a[226:227], v153 offset:4864
    v_mfma_f32_16x16x32_bf16 v[136:139], v[40:43], v[48:51], v[136:139]
    ds_read_b64 v[92:93], v11 offset:3168
    v_mfma_f32_16x16x32_bf16 v[140:143], v[44:47], v[48:51], v[140:143]
    ds_read_b64 v[94:95], v11 offset:3176
    v_add_u32 v11, 128, v11
    v_subrev_u32 v12, 32, v12
    s_waitcnt lgkmcnt(0)
    v_mfma_f32_16x16x32_bf16 v[112:115], v[64:67], v[96:99], v[112:115]
    ds_read_b128 v[48:51], v12 offset:16
    v_pk_mul_f32 v[190:191], v[190:191], v[8:9]
    v_mfma_f32_16x16x32_bf16 v[120:123], v[64:67], v[100:103], v[120:123]
    ds_read_b64 v[16:17], v11 offset:0
    v_cvt_pk_bf16_f32 v192, v188, v189
    v_mfma_f32_16x16x32_bf16 v[128:131], v[64:67], v[104:107], v[128:131]
    ds_read_b64 v[18:19], v11 offset:8
    v_mfma_f32_16x16x32_bf16 v[136:139], v[64:67], v[108:111], v[136:139]
    ds_read_b128 v[52:55], v12 offset:272
    v_cvt_pk_bf16_f32 v193, v190, v191
    v_mfma_f32_16x16x32_bf16 v[116:119], v[68:71], v[96:99], v[116:119]
    ds_read_b128 v[56:59], v12 offset:528
    v_lshlrev_b32 v172, 16, v192
    v_mfma_f32_16x16x32_bf16 v[124:127], v[68:71], v[100:103], v[124:127]
    ds_read_b128 v[60:63], v12 offset:784
    v_mfma_f32_16x16x32_bf16 v[132:135], v[68:71], v[104:107], v[132:135]
    ds_read_b64 v[20:21], v11 offset:32
    v_and_b32 v173, 0xffff0000, v192
    v_mfma_f32_16x16x32_bf16 v[140:143], v[68:71], v[108:111], v[140:143]
    ds_read_b64 v[22:23], v11 offset:40
    v_lshlrev_b32 v174, 16, v193
    s_waitcnt lgkmcnt(14)
    v_mfma_f32_16x16x32_bf16 v[120:123], v[72:75], v[96:99], v[120:123]
    ds_read_b64 v[24:25], v11 offset:1024
    v_and_b32 v175, 0xffff0000, v193
    v_mfma_f32_16x16x32_bf16 v[128:131], v[72:75], v[100:103], v[128:131]
    ds_read_b64 v[26:27], v11 offset:1032
    v_mfma_f32_16x16x32_bf16 v[136:139], v[72:75], v[104:107], v[136:139]
    ds_read_b64 v[28:29], v11 offset:1056
    v_and_b32 v194, 0xffff0000, v211
    v_mfma_f32_16x16x32_bf16 v[124:127], v[76:79], v[96:99], v[124:127]
    ds_read_b64 v[30:31], v11 offset:1064
    v_lshlrev_b32 v195, 16, v211
    v_mfma_f32_16x16x32_bf16 v[132:135], v[76:79], v[100:103], v[132:135]
    ds_read_b64 v[32:33], v11 offset:2048
    v_mfma_f32_16x16x32_bf16 v[140:143], v[76:79], v[104:107], v[140:143]
    ds_read_b64 v[34:35], v11 offset:2056
    v_and_b32 v196, 0xffff0000, v210
    v_mfma_f32_16x16x32_bf16 v[128:131], v[80:83], v[96:99], v[128:131]
    ds_read_b64 v[36:37], v11 offset:2080
    v_lshlrev_b32 v197, 16, v210
    v_mfma_f32_16x16x32_bf16 v[136:139], v[80:83], v[100:103], v[136:139]
    ds_read_b64 v[38:39], v11 offset:2088
    v_pk_mul_f32 v[194:195], v[194:195], v[8:9]
    s_waitcnt lgkmcnt(15)
    v_mfma_f32_16x16x32_bf16 v[132:135], v[84:87], v[96:99], v[132:135]
    ds_read_b64 v[40:41], v11 offset:3072
    v_mfma_f32_16x16x32_bf16 v[140:143], v[84:87], v[100:103], v[140:143]
    ds_read_b64 v[42:43], v11 offset:3080
    v_pk_mul_f32 v[196:197], v[196:197], v[8:9]
    v_mfma_f32_16x16x32_bf16 v[136:139], v[88:91], v[96:99], v[136:139]
    ds_read_b64 v[44:45], v11 offset:3104
    v_cvt_pk_bf16_f32 v198, v194, v195
    v_mfma_f32_16x16x32_bf16 v[140:143], v[92:95], v[96:99], v[140:143]
    ds_read_b64 v[46:47], v11 offset:3112
    v_cvt_pk_bf16_f32 v199, v196, v197
    s_waitcnt lgkmcnt(12)
    v_mfma_f32_16x16x32_bf16 v[112:115], v[16:19], v[48:51], v[112:115]
    ds_read_b128 v[96:99], v12 offset:0
    v_mfma_f32_16x16x32_bf16 v[120:123], v[16:19], v[52:55], v[120:123]
    ds_read_b64 v[64:65], v11 offset:64
    v_lshlrev_b32 v176, 16, v198
    v_mfma_f32_16x16x32_bf16 v[128:131], v[16:19], v[56:59], v[128:131]
    ds_read_b64 v[66:67], v11 offset:72
    v_and_b32 v177, 0xffff0000, v198
    v_mfma_f32_16x16x32_bf16 v[136:139], v[16:19], v[60:63], v[136:139]
    ds_read_b128 v[100:103], v12 offset:256
    v_mfma_f32_16x16x32_bf16 v[116:119], v[20:23], v[48:51], v[116:119]
    ds_read_b128 v[104:107], v12 offset:512
    v_lshlrev_b32 v178, 16, v199
    v_mfma_f32_16x16x32_bf16 v[124:127], v[20:23], v[52:55], v[124:127]
    ds_read_b128 v[108:111], v12 offset:768
    v_and_b32 v179, 0xffff0000, v199
    v_mfma_f32_16x16x32_bf16 v[132:135], v[20:23], v[56:59], v[132:135]
    ds_read_b64 v[68:69], v11 offset:96
    v_and_b32 v188, 0xffff0000, v213
    v_mfma_f32_16x16x32_bf16 v[140:143], v[20:23], v[60:63], v[140:143]
    ds_read_b64 v[70:71], v11 offset:104
    s_waitcnt lgkmcnt(14)
    v_mfma_f32_16x16x32_bf16 v[120:123], v[24:27], v[48:51], v[120:123]
    ds_read_b64 v[72:73], v11 offset:1088
    v_lshlrev_b32 v189, 16, v213
    v_mfma_f32_16x16x32_bf16 v[128:131], v[24:27], v[52:55], v[128:131]
    ds_read_b64 v[74:75], v11 offset:1096
    v_and_b32 v190, 0xffff0000, v212
    v_mfma_f32_16x16x32_bf16 v[136:139], v[24:27], v[56:59], v[136:139]
    ds_read_b64 v[76:77], v11 offset:1120
    v_lshlrev_b32 v191, 16, v212
    v_mfma_f32_16x16x32_bf16 v[124:127], v[28:31], v[48:51], v[124:127]
    ds_read_b64 v[78:79], v11 offset:1128
    v_mfma_f32_16x16x32_bf16 v[132:135], v[28:31], v[52:55], v[132:135]
    ds_read_b64 v[80:81], v11 offset:2112
    v_pk_mul_f32 v[188:189], v[188:189], v[8:9]
    v_mfma_f32_16x16x32_bf16 v[140:143], v[28:31], v[56:59], v[140:143]
    ds_read_b64 v[82:83], v11 offset:2120
    v_pk_mul_f32 v[190:191], v[190:191], v[8:9]
    v_mfma_f32_16x16x32_bf16 v[128:131], v[32:35], v[48:51], v[128:131]
    ds_read_b64 v[84:85], v11 offset:2144
    v_mfma_f32_16x16x32_bf16 v[136:139], v[32:35], v[52:55], v[136:139]
    ds_read_b64 v[86:87], v11 offset:2152
    v_cvt_pk_bf16_f32 v192, v188, v189
    s_waitcnt lgkmcnt(15)
    v_mfma_f32_16x16x32_bf16 v[132:135], v[36:39], v[48:51], v[132:135]
    ds_read_b64 v[88:89], v11 offset:3136
    v_cvt_pk_bf16_f32 v193, v190, v191
    v_mfma_f32_16x16x32_bf16 v[140:143], v[36:39], v[52:55], v[140:143]
    ds_read_b64 v[90:91], v11 offset:3144
    v_lshlrev_b32 v180, 16, v192
    v_mfma_f32_16x16x32_bf16 v[136:139], v[40:43], v[48:51], v[136:139]
    ds_read_b64 v[92:93], v11 offset:3168
    v_mfma_f32_16x16x32_bf16 v[140:143], v[44:47], v[48:51], v[140:143]
    ds_read_b64 v[94:95], v11 offset:3176
    v_add_u32 v11, 128, v11
    v_subrev_u32 v12, 32, v12
    v_and_b32 v181, 0xffff0000, v192
    s_waitcnt lgkmcnt(12)
    v_mfma_f32_16x16x32_bf16 v[112:115], v[64:67], v[96:99], v[112:115]
    v_lshlrev_b32 v182, 16, v193
    v_mfma_f32_16x16x32_bf16 v[120:123], v[64:67], v[100:103], v[120:123]
L_pg_conv2:
    s_cbranch_execz L_wret
    v_mfma_f32_16x16x32_bf16 v[128:131], v[64:67], v[104:107], v[128:131]
    v_and_b32 v183, 0xffff0000, v193
    v_mfma_f32_16x16x32_bf16 v[136:139], v[64:67], v[108:111], v[136:139]
    v_and_b32 v194, 0xffff0000, v215
    v_mfma_f32_16x16x32_bf16 v[116:119], v[68:71], v[96:99], v[116:119]
    v_lshlrev_b32 v195, 16, v215
    v_mfma_f32_16x16x32_bf16 v[124:127], v[68:71], v[100:103], v[124:127]
    v_mfma_f32_16x16x32_bf16 v[132:135], v[68:71], v[104:107], v[132:135]
    v_and_b32 v196, 0xffff0000, v214
    v_mfma_f32_16x16x32_bf16 v[140:143], v[68:71], v[108:111], v[140:143]
    v_lshlrev_b32 v197, 16, v214
    s_waitcnt lgkmcnt(6)
    v_mfma_f32_16x16x32_bf16 v[120:123], v[72:75], v[96:99], v[120:123]
    v_pk_mul_f32 v[194:195], v[194:195], v[8:9]
    v_mfma_f32_16x16x32_bf16 v[128:131], v[72:75], v[100:103], v[128:131]
    v_mfma_f32_16x16x32_bf16 v[136:139], v[72:75], v[104:107], v[136:139]
    v_pk_mul_f32 v[196:197], v[196:197], v[8:9]
    v_mfma_f32_16x16x32_bf16 v[124:127], v[76:79], v[96:99], v[124:127]
    v_cvt_pk_bf16_f32 v198, v194, v195
    v_mfma_f32_16x16x32_bf16 v[132:135], v[76:79], v[100:103], v[132:135]
    v_mfma_f32_16x16x32_bf16 v[140:143], v[76:79], v[104:107], v[140:143]
    v_cvt_pk_bf16_f32 v199, v196, v197
    v_mfma_f32_16x16x32_bf16 v[128:131], v[80:83], v[96:99], v[128:131]
    v_lshlrev_b32 v184, 16, v198
    v_mfma_f32_16x16x32_bf16 v[136:139], v[80:83], v[100:103], v[136:139]
    v_and_b32 v185, 0xffff0000, v198
    s_waitcnt lgkmcnt(0)
    v_mfma_f32_16x16x32_bf16 v[132:135], v[84:87], v[96:99], v[132:135]
    v_mfma_f32_16x16x32_bf16 v[140:143], v[84:87], v[100:103], v[140:143]
    v_lshlrev_b32 v186, 16, v199
    v_mfma_f32_16x16x32_bf16 v[136:139], v[88:91], v[96:99], v[136:139]
    v_and_b32 v187, 0xffff0000, v199
    v_mfma_f32_16x16x32_bf16 v[140:143], v[92:95], v[96:99], v[140:143]
    s_mov_b32 s42, 0
    s_cmp_lg_u32 s28, 0
    s_waitcnt vmcnt(5)
    s_cbranch_scc1 L_flok_ca
L_fl_ca:
    v_cmp_ne_u64 vcc, s[100:101], v[228:229]
    v_cmp_ne_u64 s[40:41], s[100:101], v[230:231]
    s_add_u32 s42, s42, 1
    s_nop 3
    s_or_b64 vcc, vcc, s[40:41]
    s_cbranch_scc0 L_flok_ca
    s_cmp_ge_u32 s42, 200000
    s_cbranch_scc1 L_flok_ca
    buffer_load_dwordx4 v[228:231], v227, s[12:15], 0 offen sc1
    s_waitcnt vmcnt(0)
    s_branch L_fl_ca
L_flok_ca:
    s_mov_b32 s40, 8192
    buffer_load_dwordx4 v[228:231], v227, s[12:15], s40 offen sc1
    v_cvt_pk_bf16_f32 v44, v112, v113
    v_cvt_pk_bf16_f32 v45, v114, v115
    v_lshlrev_b32 v40, 16, v44
    v_and_b32 v41, 0xffff0000, v44
    v_lshlrev_b32 v42, 16, v45
    v_and_b32 v43, 0xffff0000, v45
    v_pk_add_f32 v[40:41], v[156:157], v[40:41]
    v_pk_add_f32 v[42:43], v[158:159], v[42:43]
    v_cvt_pk_bf16_f32 v64, v40, v41
    v_cvt_pk_bf16_f32 v65, v42, v43
    v_cvt_pk_bf16_f32 v50, v116, v117
    v_cvt_pk_bf16_f32 v51, v118, v119
    v_lshlrev_b32 v46, 16, v50
    v_and_b32 v47, 0xffff0000, v50
    v_lshlrev_b32 v48, 16, v51
    v_and_b32 v49, 0xffff0000, v51
    v_pk_add_f32 v[46:47], v[160:161], v[46:47]
    v_pk_add_f32 v[48:49], v[162:163], v[48:49]
    v_cvt_pk_bf16_f32 v66, v46, v47
    v_cvt_pk_bf16_f32 v67, v48, v49
    s_nop 1
    v_permlane16_swap_b32 v64, v66
    v_permlane16_swap_b32 v65, v67
    s_nop 0
    ds_write_b128 v217, v[64:67] offset:5120
    v_cvt_pk_bf16_f32 v44, v120, v121
    v_cvt_pk_bf16_f32 v45, v122, v123
    v_lshlrev_b32 v40, 16, v44
    v_and_b32 v41, 0xffff0000, v44
    v_lshlrev_b32 v42, 16, v45
    v_and_b32 v43, 0xffff0000, v45
    v_pk_add_f32 v[40:41], v[164:165], v[40:41]
    v_pk_add_f32 v[42:43], v[166:167], v[42:43]
    v_cvt_pk_bf16_f32 v68, v40, v41
    v_cvt_pk_bf16_f32 v69, v42, v43
    v_cvt_pk_bf16_f32 v50, v124, v125
    v_cvt_pk_bf16_f32 v51, v126, v127
    v_lshlrev_b32 v46, 16, v50
    v_and_b32 v47, 0xffff0000, v50
    v_lshlrev_b32 v48, 16, v51
    v_and_b32 v49, 0xffff0000, v51
    v_pk_add_f32 v[46:47], v[168:169], v[46:47]
    v_pk_add_f32 v[48:49], v[170:171], v[48:49]
    v_cvt_pk_bf16_f32 v70, v46, v47
    v_cvt_pk_bf16_f32 v71, v48, v49
    s_nop 1
    v_permlane16_swap_b32 v68, v70
    v_permlane16_swap_b32 v69, v71
    s_nop 0
    ds_write_b128 v217, v[68:71] offset:6144
    v_cvt_pk_bf16_f32 v44, v128, v129
    v_cvt_pk_bf16_f32 v45, v130, v131
    v_lshlrev_b32 v40, 16, v44
    v_and_b32 v41, 0xffff0000, v44
    v_lshlrev_b32 v42, 16, v45
    v_and_b32 v43, 0xffff0000, v45
    v_pk_add_f32 v[40:41], v[172:173], v[40:41]
    v_pk_add_f32 v[42:43], v[174:175], v[42:43]
    v_cvt_pk_bf16_f32 v72, v40, v41
    v_cvt_pk_bf16_f32 v73, v42, v43
    v_cvt_pk_bf16_f32 v50, v132, v133
    v_cvt_pk_bf16_f32 v51, v134, v135
    v_lshlrev_b32 v46, 16, v50
    v_and_b32 v47, 0xffff0000, v50
    v_lshlrev_b32 v48, 16, v51
    v_and_b32 v49, 0xffff0000, v51
    v_pk_add_f32 v[46:47], v[176:177], v[46:47]
    v_pk_add_f32 v[48:49], v[178:179], v[48:49]
    v_cvt_pk_bf16_f32 v74, v46, v47
    v_cvt_pk_bf16_f32 v75, v48, v49
    s_nop 1
    v_permlane16_swap_b32 v72, v74
    v_permlane16_swap_b32 v73, v75
    s_nop 0
    ds_write_b128 v217, v[72:75] offset:7168
    v_cvt_pk_bf16_f32 v44, v136, v137
    v_cvt_pk_bf16_f32 v45, v138, v139
    v_lshlrev_b32 v40, 16, v44
    v_and_b32 v41, 0xffff0000, v44
    v_lshlrev_b32 v42, 16, v45
    v_and_b32 v43, 0xffff0000, v45
    v_pk_add_f32 v[40:41], v[180:181], v[40:41]
    v_pk_add_f32 v[42:43], v[182:183], v[42:43]
    v_cvt_pk_bf16_f32 v76, v40, v41
    v_cvt_pk_bf16_f32 v77, v42, v43
    v_cvt_pk_bf16_f32 v50, v140, v141
    v_cvt_pk_bf16_f32 v51, v142, v143
    v_lshlrev_b32 v46, 16, v50
    v_and_b32 v47, 0xffff0000, v50
    v_lshlrev_b32 v48, 16, v51
    v_and_b32 v49, 0xffff0000, v51
    v_pk_add_f32 v[46:47], v[184:185], v[46:47]
    v_pk_add_f32 v[48:49], v[186:187], v[48:49]
    v_cvt_pk_bf16_f32 v78, v46, v47
    v_cvt_pk_bf16_f32 v79, v48, v49
    s_nop 1
    v_permlane16_swap_b32 v76, v78
    v_permlane16_swap_b32 v77, v79
    s_nop 0
    ds_write_b128 v217, v[76:79] offset:8192
    v_mov_b32 v226, v221
    s_waitcnt lgkmcnt(0)
    s_barrier
    ds_read_b128 v[64:67], v218 offset:5120
    ds_read_b128 v[68:71], v218 offset:5376
    ds_read_b128 v[72:75], v218 offset:5632
    ds_read_b128 v[76:79], v218 offset:5888
    s_waitcnt lgkmcnt(3)
    buffer_store_dwordx4 v[64:67], v219, s[48:51], s34 offen sc1
    s_add_u32 s34, s34, 147456
    s_waitcnt lgkmcnt(2)
    buffer_store_dwordx4 v[68:71], v219, s[48:51], s34 offen sc1
    s_add_u32 s34, s34, 147456
    s_waitcnt lgkmcnt(1)
    buffer_store_dwordx4 v[72:75], v219, s[48:51], s34 offen sc1
    s_add_u32 s34, s34, 147456
    s_waitcnt lgkmcnt(0)
    buffer_store_dwordx4 v[76:79], v219, s[48:51], s34 offen sc1
L_conv_last:
    s_branch L_main0
.p2align 12
L_conv_end:
    s_sub_u32 s3, s2, 144
    s_load_dwordx4 s[4:7], s[0:1], 56
    s_load_dwordx2 s[8:9], s[0:1], 72
    s_load_dwordx2 s[10:11], s[0:1], 96
    s_load_dwordx2 s[36:37], s[0:1], 0
    s_getpc_b64 s[98:99]
L_pf_sh:
    s_sub_u32 s98, s98, L_pf_sh-L_front_conv
    s_subb_u32 s99, s99, 0
    v_and_b32 v15, 63, v0
    v_lshlrev_b32 v15, 6, v15
    v_min_u32 v12, L_text_end-L_front_conv-4, v15
    v_mov_b32 v13, s99
    v_add_co_u32 v12, vcc, s98, v12
    v_add_u32 v15, 4096, v15
    s_nop 0
    v_addc_co_u32 v13, vcc, 0, v13, vcc
    global_load_dword v14, v[12:13], off
    v_min_u32 v12, L_text_end-L_front_conv-4, v15
    v_mov_b32 v13, s99
    v_add_co_u32 v12, vcc, s98, v12
    v_add_u32 v15, 4096, v15
    s_nop 0
    v_addc_co_u32 v13, vcc, 0, v13, vcc
    global_load_dword v14, v[12:13], off
    v_min_u32 v12, L_text_end-L_front_conv-4, v15
    v_mov_b32 v13, s99
    v_add_co_u32 v12, vcc, s98, v12
    v_add_u32 v15, 4096, v15
    s_nop 0
    v_addc_co_u32 v13, vcc, 0, v13, vcc
    global_load_dword v14, v[12:13], off
    v_min_u32 v12, L_text_end-L_front_conv-4, v15
    v_mov_b32 v13, s99
    v_add_co_u32 v12, vcc, s98, v12
    v_add_u32 v15, 4096, v15
    s_nop 0
    v_addc_co_u32 v13, vcc, 0, v13, vcc
    global_load_dword v14, v[12:13], off
    v_min_u32 v12, L_text_end-L_front_conv-4, v15
    v_mov_b32 v13, s99
    v_add_co_u32 v12, vcc, s98, v12
    v_add_u32 v15, 4096, v15
    s_nop 0
    v_addc_co_u32 v13, vcc, 0, v13, vcc
    global_load_dword v14, v[12:13], off
    v_min_u32 v12, L_text_end-L_front_conv-4, v15
    v_mov_b32 v13, s99
    v_add_co_u32 v12, vcc, s98, v12
    v_add_u32 v15, 4096, v15
    s_nop 0
    v_addc_co_u32 v13, vcc, 0, v13, vcc
    global_load_dword v14, v[12:13], off
    v_min_u32 v12, L_text_end-L_front_conv-4, v15
    v_mov_b32 v13, s99
    v_add_co_u32 v12, vcc, s98, v12
    v_add_u32 v15, 4096, v15
    s_nop 0
    v_addc_co_u32 v13, vcc, 0, v13, vcc
    global_load_dword v14, v[12:13], off
    v_min_u32 v12, L_text_end-L_front_conv-4, v15
    v_mov_b32 v13, s99
    v_add_co_u32 v12, vcc, s98, v12
    v_add_u32 v15, 4096, v15
    s_nop 0
    v_addc_co_u32 v13, vcc, 0, v13, vcc
    global_load_dword v14, v[12:13], off
    v_min_u32 v12, L_text_end-L_front_conv-4, v15
    v_mov_b32 v13, s99
    v_add_co_u32 v12, vcc, s98, v12
    v_add_u32 v15, 4096, v15
    s_nop 0
    v_addc_co_u32 v13, vcc, 0, v13, vcc
    global_load_dword v14, v[12:13], off
    v_min_u32 v12, L_text_end-L_front_conv-4, v15
    v_mov_b32 v13, s99
    v_add_co_u32 v12, vcc, s98, v12
    v_add_u32 v15, 4096, v15
    s_nop 0
    v_addc_co_u32 v13, vcc, 0, v13, vcc
    global_load_dword v14, v[12:13], off
    v_min_u32 v12, L_text_end-L_front_conv-4, v15
    v_mov_b32 v13, s99
    v_add_co_u32 v12, vcc, s98, v12
    v_add_u32 v15, 4096, v15
    s_nop 0
    v_addc_co_u32 v13, vcc, 0, v13, vcc
    global_load_dword v14, v[12:13], off
    v_min_u32 v12, L_text_end-L_front_conv-4, v15
    v_mov_b32 v13, s99
    v_add_co_u32 v12, vcc, s98, v12
    v_add_u32 v15, 4096, v15
    s_nop 0
    v_addc_co_u32 v13, vcc, 0, v13, vcc
    global_load_dword v14, v[12:13], off
    v_min_u32 v12, L_text_end-L_front_conv-4, v15
    v_mov_b32 v13, s99
    v_add_co_u32 v12, vcc, s98, v12
    v_add_u32 v15, 4096, v15
    s_nop 0
    v_addc_co_u32 v13, vcc, 0, v13, vcc
    global_load_dword v14, v[12:13], off
    v_lshrrev_b32 v1, 6, v0
    v_and_b32 v2, 63, v0
    v_lshlrev_b32 v5, 4, v2
    v_readfirstlane_b32 s28, v1
    v_bfe_u32 v3, v0, 1, 2
    v_and_b32 v4, 1, v0
    s_lshl_b32 s29, s3, 2
    s_add_u32 s29, s29, s28
    s_lshr_b32 s30, s3, 3
    s_lshl_b32 s30, s30, 2
    s_add_u32 s30, s30, s28
    s_mul_i32 s31, s28, 8
    s_mul_i32 s44, s28, 9216
    v_lshrrev_b32 v6, 3, v2
    v_lshrrev_b32 v7, 1, v6
    v_xor_b32 v7, v7, v3
    v_add_u32 v6, s31, v6
    v_lshlrev_b32 v8, 5, v7
    v_lshl_add_u32 v8, v4, 4, v8
    v_mul_u32_u24 v20, 9216, v6
    v_add_u32 v20, v20, v8
    v_lshrrev_b32 v7, 1, v7
    v_mul_u32_u24 v29, 2654144, v7
    v_lshrrev_b32 v6, 2, v2
    v_and_b32 v7, 3, v0
    v_lshlrev_b32 v7, 3, v7
    v_lshl_add_u32 v6, v6, 7, v7
    v_lshrrev_b32 v7, 5, v2
    v_mul_u32_u24 v7, 8192, v7
    v_add_u32 v6, v6, v7
    v_bfe_u32 v7, v0, 3, 2
    v_xor_b32 v7, s28, v7
    v_lshl_add_u32 v40, v7, 5, v6
    v_add_u32 v41, 36864, v40
    v_add_u32 v42, 73728, v40
    s_lshl_b32 s31, s28, 10
    v_add_u32 v43, s31, v5
    v_mov_b32 v16, 0
    v_mov_b32 v17, 0
    v_mov_b32 v18, 0
    v_mov_b32 v19, 0
    s_lshl_b32 s34, s29, 10
    s_waitcnt lgkmcnt(0)
    s_mov_b32 s20, s8
    s_mov_b32 s21, s9
    s_mov_b32 s22, 5308416
    s_mov_b32 s23, 0x20000
    s_add_u32 s24, s10, 125894656
    s_addc_u32 s25, s11, 0
    s_mov_b32 s26, 32768
    s_mov_b32 s27, 0x20000
    s_mov_b32 s40, s36
    s_mov_b32 s41, s37
    s_mov_b32 s42, 2359296
    s_mov_b32 s43, 0x20000
    s_mov_b32 s16, s10
    s_mov_b32 s17, s11
    s_mov_b32 s18, 15925248
    s_mov_b32 s19, 0x20000
    s_mov_b32 s14, 5308416
    s_mov_b32 s15, 0x20000
    buffer_store_dwordx4 v[16:19], v5, s[24:27], s34 offen sc1
    s_load_dwordx2 s[50:51], s[0:1], 88
    v_mov_b32 v226, 0
    v_lshlrev_b32 v232, 10, v2
    s_and_b32 s31, s2, 3
    s_lshl_b32 s31, s31, 2
    s_bfe_u32 s32, s2, 0x20003
    s_add_u32 s31, s31, s32
    s_lshr_b32 s92, s2, 5
    s_lshl_b32 s92, s92, 1
    s_bfe_u32 s32, s2, 0x10002
    s_add_u32 s92, s92, s32
    s_lshl_b32 s92, s92, 4
    s_add_u32 s92, s92, s31
    s_lshl_b32 s92, s92, 2
    s_add_u32 s92, s92, s28
    s_mul_i32 s92, s92, 2304
    v_and_b32 v6, 1, v0
    v_mul_u32_u24 v246, 1152, v6
    v_bfe_u32 v6, v0, 5, 1
    v_lshl_add_u32 v246, v6, 7, v246
    v_bfe_u32 v6, v0, 3, 1
    v_lshl_add_u32 v246, v6, 6, v246
    v_bfe_u32 v6, v0, 4, 1
    v_lshl_add_u32 v246, v6, 5, v246
    v_bfe_u32 v6, v0, 1, 2
    v_lshl_add_u32 v246, v6, 3, v246
    v_bfe_u32 v6, v0, 5, 1
    v_mul_u32_u24 v6, 0x7f0000, v6
    v_lshl_add_u32 v247, v6, 8, v246
    s_and_b32 s31, s2, 7
    s_lshl_b32 s31, s31, 10
    s_cmp_lg_u32 s28, 0
    s_cselect_b32 s31, 2130706432, s31
    v_and_b32 v6, 63, v0
    v_min_u32 v6, 55, v6
    v_lshl_add_u32 v227, v6, 4, s31
    s_add_u32 s24, s10, 125927424
    s_addc_u32 s25, s11, 0
    s_mov_b32 s26, 28672
    s_mov_b32 s27, 0x20000
    s_waitcnt lgkmcnt(0)
    s_mov_b32 s56, s50
    s_mov_b32 s57, s51
    s_mov_b32 s58, 256
    s_mov_b32 s59, 0x20000
    buffer_load_dwordx2 v[224:225], v226, s[56:59], 0 offen sc1
    s_add_u32 s52, s10, 23068672
    s_addc_u32 s53, s11, 0
    s_mov_b32 s54, 2359296
    s_mov_b32 s55, 0x20000
    v_mov_b32 v208, -1
    v_mov_b32 v209, -1
    v_mov_b32 v210, -1
    v_mov_b32 v211, -1
    s_add_u32 s31, s34, 0
    buffer_store_dwordx4 v[208:211], v5, s[52:55], s31 offen sc1
    s_add_u32 s31, s34, 458752
    buffer_store_dwordx4 v[208:211], v5, s[52:55], s31 offen sc1
    s_add_u32 s31, s34, 917504
    buffer_store_dwordx4 v[208:211], v5, s[52:55], s31 offen sc1
    s_add_u32 s31, s34, 1376256
    buffer_store_dwordx4 v[208:211], v5, s[52:55], s31 offen sc1
    s_add_u32 s31, s34, 1835008
    buffer_store_dwordx4 v[208:211], v5, s[52:55], s31 offen sc1
    s_add_u32 s31, s34, 2293760
    buffer_store_dwordx4 v[208:211], v5, s[52:55], s31 offen sc1
    s_add_u32 s52, s10, 19922944
    s_addc_u32 s53, s11, 0
    s_mov_b32 s54, 2359296
    s_mov_b32 s55, 0x20000
    v_mov_b32 v208, -1
    v_mov_b32 v209, -1
    v_mov_b32 v210, -1
    v_mov_b32 v211, -1
    s_add_u32 s31, s34, 0
    buffer_store_dwordx4 v[208:211], v5, s[52:55], s31 offen sc1
    s_add_u32 s31, s34, 458752
    buffer_store_dwordx4 v[208:211], v5, s[52:55], s31 offen sc1
    s_add_u32 s31, s34, 917504
    buffer_store_dwordx4 v[208:211], v5, s[52:55], s31 offen sc1
    s_add_u32 s31, s34, 1376256
    buffer_store_dwordx4 v[208:211], v5, s[52:55], s31 offen sc1
    s_add_u32 s31, s34, 1835008
    buffer_store_dwordx4 v[208:211], v5, s[52:55], s31 offen sc1
    s_add_u32 s31, s34, 2293760
    buffer_store_dwordx4 v[208:211], v5, s[52:55], s31 offen sc1
    s_add_u32 s31, s3, 0
    s_lshr_b32 s32, s31, 3
    s_and_b32 s33, s31, 7
    s_and_b32 s35, s32, 1
    s_lshr_b32 s32, s32, 1
    s_cmp_lg_u32 s35, 0
    s_cselect_b32 s12, s6, s4
    s_cselect_b32 s13, s7, s5
    s_mul_i32 s38, s32, 294912
    s_mul_i32 s39, s33, 1152
    s_add_u32 s38, s38, s39
    s_mul_i32 s33, s33, 1990656
    s_cmp_ge_u32 s32, 9
    s_cselect_b32 s39, 1, 0
    s_mul_i32 s45, s39, 9
    s_sub_u32 s32, s32, s45
    s_lshl_b32 s32, s32, 12
    s_add_u32 s33, s33, s32
    s_lshl_b32 s45, s35, 1
    s_add_u32 s45, s45, s39
    s_mul_i32 s45, s45, 36864
    s_add_u32 s46, s33, s45
    s_add_u32 s35, s35, 16
    s_mul_i32 s35, s35, 36864
    s_lshl_b32 s39, s39, 11
    s_add_u32 s33, s33, s35
    s_add_u32 s33, s33, s39
    s_lshr_b32 s35, s28, 1
    s_mul_i32 s35, s35, 993280
    s_add_u32 s93, s33, s35
    s_add_u32 m0, s44, 0
    s_nop 0
    buffer_load_dwordx4 v20, s[12:15], s38 offen offset:0 nt lds
    s_add_u32 m0, s44, 896
    s_nop 0
    buffer_load_dwordx4 v20, s[12:15], s38 offen offset:128 nt lds
    s_add_u32 m0, s44, 1792
    s_nop 0
    buffer_load_dwordx4 v20, s[12:15], s38 offen offset:256 nt lds
    s_add_u32 m0, s44, 2688
    s_nop 0
    buffer_load_dwordx4 v20, s[12:15], s38 offen offset:384 nt lds
    s_add_u32 m0, s44, 3584
    s_nop 0
    buffer_load_dwordx4 v20, s[12:15], s38 offen offset:512 nt lds
    s_add_u32 m0, s44, 4480
    s_nop 0
    buffer_load_dwordx4 v20, s[12:15], s38 offen offset:640 nt lds
    s_add_u32 m0, s44, 5376
    s_nop 0
    buffer_load_dwordx4 v20, s[12:15], s38 offen offset:768 nt lds
    s_add_u32 m0, s44, 6272
    s_nop 0
    buffer_load_dwordx4 v20, s[12:15], s38 offen offset:896 nt lds
    s_add_u32 m0, s44, 7168
    s_nop 0
    buffer_load_dwordx4 v20, s[12:15], s38 offen offset:1024 nt lds
    s_add_u32 s31, s3, 112
    s_lshr_b32 s32, s31, 3
    s_and_b32 s33, s31, 7
    s_and_b32 s35, s32, 1
    s_lshr_b32 s32, s32, 1
    s_cmp_lg_u32 s35, 0
    s_cselect_b32 s12, s6, s4
    s_cselect_b32 s13, s7, s5
    s_mul_i32 s38, s32, 294912
    s_mul_i32 s39, s33, 1152
    s_add_u32 s38, s38, s39
    s_mul_i32 s33, s33, 1990656
    s_cmp_ge_u32 s32, 9
    s_cselect_b32 s39, 1, 0
    s_mul_i32 s45, s39, 9
    s_sub_u32 s32, s32, s45
    s_lshl_b32 s32, s32, 12
    s_add_u32 s33, s33, s32
    s_lshl_b32 s45, s35, 1
    s_add_u32 s45, s45, s39
    s_mul_i32 s45, s45, 36864
    s_add_u32 s47, s33, s45
    s_add_u32 s35, s35, 16
    s_mul_i32 s35, s35, 36864
    s_lshl_b32 s39, s39, 11
    s_add_u32 s33, s33, s35
    s_add_u32 s33, s33, s39
    s_lshr_b32 s35, s28, 1
    s_mul_i32 s35, s35, 993280
    s_add_u32 s94, s33, s35
    s_add_u32 m0, s44, 36864
    s_nop 0
    buffer_load_dwordx4 v20, s[12:15], s38 offen offset:0 nt lds
    s_add_u32 m0, s44, 37760
    s_nop 0
    buffer_load_dwordx4 v20, s[12:15], s38 offen offset:128 nt lds
    s_add_u32 m0, s44, 38656
    s_nop 0
    buffer_load_dwordx4 v20, s[12:15], s38 offen offset:256 nt lds
    s_add_u32 m0, s44, 39552
    s_nop 0
    buffer_load_dwordx4 v20, s[12:15], s38 offen offset:384 nt lds
    s_add_u32 m0, s44, 40448
    s_nop 0
    buffer_load_dwordx4 v20, s[12:15], s38 offen offset:512 nt lds
    s_add_u32 m0, s44, 41344
    s_nop 0
    buffer_load_dwordx4 v20, s[12:15], s38 offen offset:640 nt lds
    s_add_u32 m0, s44, 42240
    s_nop 0
    buffer_load_dwordx4 v20, s[12:15], s38 offen offset:768 nt lds
    s_add_u32 m0, s44, 43136
    s_nop 0
    buffer_load_dwordx4 v20, s[12:15], s38 offen offset:896 nt lds
    s_add_u32 m0, s44, 44032
    s_nop 0
    buffer_load_dwordx4 v20, s[12:15], s38 offen offset:1024 nt lds
    s_add_u32 s31, s3, 224
    s_lshr_b32 s32, s31, 3
    s_and_b32 s33, s31, 7
    s_and_b32 s35, s32, 1
    s_lshr_b32 s32, s32, 1
    s_cmp_lg_u32 s35, 0
    s_cselect_b32 s12, s6, s4
    s_cselect_b32 s13, s7, s5
    s_mul_i32 s38, s32, 294912
    s_mul_i32 s39, s33, 1152
    s_add_u32 s38, s38, s39
    s_mul_i32 s33, s33, 1990656
    s_cmp_ge_u32 s32, 9
    s_cselect_b32 s39, 1, 0
    s_mul_i32 s45, s39, 9
    s_sub_u32 s32, s32, s45
    s_lshl_b32 s32, s32, 12
    s_add_u32 s33, s33, s32
    s_lshl_b32 s45, s35, 1
    s_add_u32 s45, s45, s39
    s_mul_i32 s45, s45, 36864
    s_add_u32 s48, s33, s45
    s_add_u32 s35, s35, 16
    s_mul_i32 s35, s35, 36864
    s_lshl_b32 s39, s39, 11
    s_add_u32 s33, s33, s35
    s_add_u32 s33, s33, s39
    s_lshr_b32 s35, s28, 1
    s_mul_i32 s35, s35, 993280
    s_add_u32 s95, s33, s35
    s_cmp_ge_u32 s31, 288
    s_cselect_b32 s38, 2130706432, s38
    s_cselect_b32 s48, 2130706432, s48
    s_cselect_b32 s95, 2130706432, s95
    s_add_u32 m0, s44, 73728
    s_nop 0
    buffer_load_dwordx4 v20, s[12:15], s38 offen offset:0 nt lds
    s_add_u32 m0, s44, 74624
    s_nop 0
    buffer_load_dwordx4 v20, s[12:15], s38 offen offset:128 nt lds
    s_add_u32 m0, s44, 75520
    s_nop 0
    buffer_load_dwordx4 v20, s[12:15], s38 offen offset:256 nt lds
    s_add_u32 m0, s44, 76416
    s_nop 0
    buffer_load_dwordx4 v20, s[12:15], s38 offen offset:384 nt lds
    s_add_u32 m0, s44, 77312
    s_nop 0
    buffer_load_dwordx4 v20, s[12:15], s38 offen offset:512 nt lds
    s_add_u32 m0, s44, 78208
    s_nop 0
    buffer_load_dwordx4 v20, s[12:15], s38 offen offset:640 nt lds
    s_add_u32 m0, s44, 79104
    s_nop 0
    buffer_load_dwordx4 v20, s[12:15], s38 offen offset:768 nt lds
    s_add_u32 m0, s44, 80000
    s_nop 0
    buffer_load_dwordx4 v20, s[12:15], s38 offen offset:896 nt lds
    s_add_u32 m0, s44, 80896
    s_nop 0
    buffer_load_dwordx4 v20, s[12:15], s38 offen offset:1024 nt lds
    s_mov_b32 s31, 0
    s_waitcnt vmcnt(27)
L_hp_tag:
    v_cmp_ne_u64 vcc, 0, v[224:225]
    s_add_u32 s31, s31, 1
    s_cmp_ge_u32 s31, 200000
    s_cbranch_vccnz L_hp_tagok
    s_cbranch_scc1 L_hp_tagok
    buffer_load_dwordx2 v[224:225], v226, s[56:59], 0 offen sc1
    s_waitcnt vmcnt(0)
    s_branch L_hp_tag
L_hp_tagok:
    v_readfirstlane_b32 s100, v224
    v_readfirstlane_b32 s101, v225
    s_barrier
    s_lshl_b32 s31, s3, 3
    s_add_u32 s31, s31, 0
    s_cmp_lg_u32 s28, 0
    s_cselect_b32 s31, 2130706432, s31
    s_mov_b64 exec, 255
    buffer_store_dwordx2 v[224:225], v232, s[24:27], s31 offen sc1
    s_mov_b64 exec, -1
    s_waitcnt lgkmcnt(0)
    s_mov_b64 exec, 0
    s_cmp_lg_u32 s28, 0
    s_cbranch_scc1 L_wn_h1_0
    s_call_b64 s[98:99], L_pm_entry
    s_call_b64 s[98:99], L_pg_main3
    s_call_b64 s[98:99], L_pm_p1
L_wn_h1_0:
    s_cmp_lg_u32 s28, 1
    s_cbranch_scc1 L_wn_h1_1
    s_call_b64 s[98:99], L_pg_main0
    s_call_b64 s[98:99], L_pg_main4
    s_call_b64 s[98:99], L_pm_fin
L_wn_h1_1:
    s_cmp_lg_u32 s28, 2
    s_cbranch_scc1 L_wn_h1_2
    s_call_b64 s[98:99], L_pg_main1
    s_call_b64 s[98:99], L_pg_main5
L_wn_h1_2:
    s_cmp_lg_u32 s28, 3
    s_cbranch_scc1 L_wn_h1_3
    s_call_b64 s[98:99], L_pg_main2
    s_call_b64 s[98:99], L_pm_p1m
L_wn_h1_3:
    s_mov_b64 exec, -1
    s_waitcnt vmcnt(19)
    s_barrier
    ds_read_b64_tr_b16 v[48:49], v40 offset:0
    ds_read_b64_tr_b16 v[50:51], v40 offset:18432
    ds_read_b64_tr_b16 v[52:53], v40 offset:1024
    ds_read_b64_tr_b16 v[54:55], v40 offset:19456
    ds_read_b64_tr_b16 v[56:57], v40 offset:2048
    ds_read_b64_tr_b16 v[58:59], v40 offset:20480
    ds_read_b64_tr_b16 v[60:61], v40 offset:3072
    ds_read_b64_tr_b16 v[62:63], v40 offset:21504
    ds_read_b64_tr_b16 v[64:65], v40 offset:4096
    ds_read_b64_tr_b16 v[66:67], v40 offset:22528
    ds_read_b64_tr_b16 v[68:69], v40 offset:5120
    ds_read_b64_tr_b16 v[70:71], v40 offset:23552
    ds_read_b64_tr_b16 v[72:73], v40 offset:6144
    ds_read_b64_tr_b16 v[74:75], v40 offset:24576
    ds_read_b64_tr_b16 v[76:77], v40 offset:7168
    ds_read_b64_tr_b16 v[78:79], v40 offset:25600
    ds_read_b64_tr_b16 v[80:81], v40 offset:8192
    ds_read_b64_tr_b16 v[82:83], v40 offset:26624
    s_waitcnt lgkmcnt(15)
    buffer_store_dwordx4 v[48:51], v43, s[16:19], s46 offen sc1
    s_add_u32 s46, s46, 147456
    s_waitcnt lgkmcnt(14)
    buffer_store_dwordx4 v[52:55], v43, s[16:19], s46 offen sc1
    s_add_u32 s46, s46, 147456
    s_waitcnt lgkmcnt(12)
    buffer_store_dwordx4 v[56:59], v43, s[16:19], s46 offen sc1
    s_add_u32 s46, s46, 147456
    s_waitcnt lgkmcnt(10)
    buffer_store_dwordx4 v[60:63], v43, s[16:19], s46 offen sc1
    s_add_u32 s46, s46, 552960
    s_waitcnt lgkmcnt(8)
    buffer_store_dwordx4 v[64:67], v43, s[16:19], s93 offen sc1
    s_waitcnt lgkmcnt(6)
    buffer_store_dwordx4 v[68:71], v43, s[16:19], s46 offen sc1
    s_add_u32 s46, s46, 147456
    s_waitcnt lgkmcnt(4)
    buffer_store_dwordx4 v[72:75], v43, s[16:19], s46 offen sc1
    s_add_u32 s46, s46, 147456
    s_waitcnt lgkmcnt(2)
    buffer_store_dwordx4 v[76:79], v43, s[16:19], s46 offen sc1
    s_add_u32 s46, s46, 147456
    s_waitcnt lgkmcnt(0)
    buffer_store_dwordx4 v[80:83], v43, s[16:19], s46 offen sc1
    s_waitcnt vmcnt(19)
    s_barrier
    ds_read_b64_tr_b16 v[84:85], v41 offset:0
    ds_read_b64_tr_b16 v[86:87], v41 offset:18432
    ds_read_b64_tr_b16 v[88:89], v41 offset:1024
    ds_read_b64_tr_b16 v[90:91], v41 offset:19456
    ds_read_b64_tr_b16 v[92:93], v41 offset:2048
    ds_read_b64_tr_b16 v[94:95], v41 offset:20480
    ds_read_b64_tr_b16 v[96:97], v41 offset:3072
    ds_read_b64_tr_b16 v[98:99], v41 offset:21504
    ds_read_b64_tr_b16 v[100:101], v41 offset:4096
    ds_read_b64_tr_b16 v[102:103], v41 offset:22528
    ds_read_b64_tr_b16 v[104:105], v41 offset:5120
    ds_read_b64_tr_b16 v[106:107], v41 offset:23552
    ds_read_b64_tr_b16 v[108:109], v41 offset:6144
    ds_read_b64_tr_b16 v[110:111], v41 offset:24576
    ds_read_b64_tr_b16 v[112:113], v41 offset:7168
    ds_read_b64_tr_b16 v[114:115], v41 offset:25600
    ds_read_b64_tr_b16 v[116:117], v41 offset:8192
    ds_read_b64_tr_b16 v[118:119], v41 offset:26624
    s_waitcnt lgkmcnt(15)
    buffer_store_dwordx4 v[84:87], v43, s[16:19], s47 offen sc1
    s_add_u32 s47, s47, 147456
    s_waitcnt lgkmcnt(14)
    buffer_store_dwordx4 v[88:91], v43, s[16:19], s47 offen sc1
    s_add_u32 s47, s47, 147456
    s_waitcnt lgkmcnt(12)
    buffer_store_dwordx4 v[92:95], v43, s[16:19], s47 offen sc1
    s_add_u32 s47, s47, 147456
    s_waitcnt lgkmcnt(10)
    buffer_store_dwordx4 v[96:99], v43, s[16:19], s47 offen sc1
    s_add_u32 s47, s47, 552960
    s_waitcnt lgkmcnt(8)
    buffer_store_dwordx4 v[100:103], v43, s[16:19], s94 offen sc1
    s_waitcnt lgkmcnt(6)
    buffer_store_dwordx4 v[104:107], v43, s[16:19], s47 offen sc1
    s_add_u32 s47, s47, 147456
    s_waitcnt lgkmcnt(4)
    buffer_store_dwordx4 v[108:111], v43, s[16:19], s47 offen sc1
    s_add_u32 s47, s47, 147456
    s_waitcnt lgkmcnt(2)
    buffer_store_dwordx4 v[112:115], v43, s[16:19], s47 offen sc1
    s_add_u32 s47, s47, 147456
    s_waitcnt lgkmcnt(0)
    buffer_store_dwordx4 v[116:119], v43, s[16:19], s47 offen sc1
    s_waitcnt vmcnt(19)
    s_barrier
    ds_read_b64_tr_b16 v[120:121], v42 offset:0
    ds_read_b64_tr_b16 v[122:123], v42 offset:18432
    ds_read_b64_tr_b16 v[124:125], v42 offset:1024
    ds_read_b64_tr_b16 v[126:127], v42 offset:19456
    ds_read_b64_tr_b16 v[128:129], v42 offset:2048
    ds_read_b64_tr_b16 v[130:131], v42 offset:20480
    ds_read_b64_tr_b16 v[132:133], v42 offset:3072
    ds_read_b64_tr_b16 v[134:135], v42 offset:21504
    ds_read_b64_tr_b16 v[136:137], v42 offset:4096
    ds_read_b64_tr_b16 v[138:139], v42 offset:22528
    ds_read_b64_tr_b16 v[140:141], v42 offset:5120
    ds_read_b64_tr_b16 v[142:143], v42 offset:23552
    ds_read_b64_tr_b16 v[144:145], v42 offset:6144
    ds_read_b64_tr_b16 v[146:147], v42 offset:24576
    ds_read_b64_tr_b16 v[148:149], v42 offset:7168
    ds_read_b64_tr_b16 v[150:151], v42 offset:25600
    ds_read_b64_tr_b16 v[152:153], v42 offset:8192
    ds_read_b64_tr_b16 v[154:155], v42 offset:26624
    s_waitcnt lgkmcnt(15)
    buffer_store_dwordx4 v[120:123], v43, s[16:19], s48 offen sc1
    s_add_u32 s48, s48, 147456
    s_waitcnt lgkmcnt(14)
    buffer_store_dwordx4 v[124:127], v43, s[16:19], s48 offen sc1
    s_add_u32 s48, s48, 147456
    s_waitcnt lgkmcnt(12)
    buffer_store_dwordx4 v[128:131], v43, s[16:19], s48 offen sc1
    s_add_u32 s48, s48, 147456
    s_waitcnt lgkmcnt(10)
    buffer_store_dwordx4 v[132:135], v43, s[16:19], s48 offen sc1
    s_add_u32 s48, s48, 552960
    s_waitcnt lgkmcnt(8)
    buffer_store_dwordx4 v[136:139], v43, s[16:19], s95 offen sc1
    s_waitcnt lgkmcnt(6)
    buffer_store_dwordx4 v[140:143], v43, s[16:19], s48 offen sc1
    s_add_u32 s48, s48, 147456
    s_waitcnt lgkmcnt(4)
    buffer_store_dwordx4 v[144:147], v43, s[16:19], s48 offen sc1
    s_add_u32 s48, s48, 147456
    s_waitcnt lgkmcnt(2)
    buffer_store_dwordx4 v[148:151], v43, s[16:19], s48 offen sc1
    s_add_u32 s48, s48, 147456
    s_waitcnt lgkmcnt(0)
    buffer_store_dwordx4 v[152:155], v43, s[16:19], s48 offen sc1
    s_load_dwordx2 s[6:7], s[0:1], 80
    buffer_load_dwordx2 v[236:237], v246, s[40:43], s92 offen offset:0
    buffer_load_dwordx2 v[238:239], v246, s[40:43], s92 offen offset:256
    buffer_load_dwordx2 v[240:241], v246, s[40:43], s92 offen offset:512
    buffer_load_dwordx2 v[242:243], v246, s[40:43], s92 offen offset:768
    buffer_load_dwordx2 v[244:245], v247, s[40:43], s92 offen offset:1024
    s_waitcnt vmcnt(5)
    s_barrier
    s_lshl_b32 s31, s3, 3
    s_add_u32 s31, s31, 8192
    s_cmp_lg_u32 s28, 0
    s_cselect_b32 s31, 2130706432, s31
    s_mov_b64 exec, 255
    buffer_store_dwordx2 v[224:225], v232, s[24:27], s31 offen sc1
    s_mov_b64 exec, -1
    s_mov_b32 s31, 8192
    buffer_load_dwordx4 v[228:231], v227, s[24:27], s31 offen sc1
    v_mov_b32 v233, -1
    v_mov_b32 v226, 2130706432
    s_mov_b32 s36, 2130706432
    s_mov_b32 s37, 0
    s_mov_b32 s38, 2130706432
    s_waitcnt vmcnt(0)
    s_branch L_main0
L_front_end:
    s_endpgm
.p2align 12
L_main0:
L_pm_entry:
    s_cbranch_execz L_wret
    v_lshrrev_b32 v67, 6, v0
    v_and_b32 v60, 63, v0
    v_lshlrev_b32 v38, 4, v60
    v_readfirstlane_b32 s48, v67
    s_and_b32 s56, s2, 3
    s_lshl_b32 s56, s56, 2
    s_bfe_u32 s4, s2, 0x20003
    s_add_u32 s56, s56, s4
    s_lshr_b32 s57, s2, 5
    s_lshl_b32 s57, s57, 1
    s_bfe_u32 s4, s2, 0x10002
    s_add_u32 s57, s57, s4
    s_lshl_b32 s58, s57, 4
    s_add_u32 s58, s58, s56
    s_lshl_b32 s59, s58, 2
    s_add_u32 s59, s59, s48
    s_mul_i32 s59, s59, 2304
    v_and_b32 v61, 1, v0
    v_bfe_u32 v62, v0, 1, 2
    v_bfe_u32 v63, v0, 3, 1
    v_bfe_u32 v64, v0, 4, 1
    v_bfe_u32 v65, v0, 5, 1
    v_mul_u32_u24 v45, 1152, v61
    v_lshl_add_u32 v45, v65, 7, v45
    v_lshl_add_u32 v45, v63, 6, v45
    v_lshl_add_u32 v45, v64, 5, v45
    v_lshl_add_u32 v45, v62, 3, v45
    v_mov_b32 v66, 2130706432
    v_cmp_gt_u32 vcc, 32, v60
    v_lshlrev_b32 v71, 4, v0
    s_mul_i32 s4, s58, 9216
    v_cndmask_b32 v46, v66, v45, vcc
    s_add_u32 s5, s4, 4096
    s_add_u32 s39, s4, 8192
    s_cmp_lg_u32 s48, 0
    s_cselect_b32 s39, 2130706432, s39
    s_waitcnt lgkmcnt(0)
    s_and_b32 s5, s58, 1
    s_sub_u32 s4, s58, s5
    s_mul_i32 s4, s4, 9216
    s_lshl_b32 s5, s5, 6
    s_add_u32 s4, s4, s5
    s_add_u32 s5, s4, 8192
    s_add_u32 s39, s4, 16384
    s_cmp_lg_u32 s48, 0
    s_cselect_b32 s39, 2130706432, s39
    v_lshrrev_b32 v71, 2, v0
    v_lshlrev_b32 v71, 7, v71
    v_and_b32 v67, 3, v0
    v_lshl_add_u32 v71, v67, 4, v71
    s_add_u32 s44, s10, 19922944
    s_addc_u32 s45, s11, 0
    s_mov_b32 s46, 2359296
    s_mov_b32 s47, 0x20000
    s_mov_b32 s12, s10
    s_mov_b32 s13, s11
    s_mov_b32 s14, 15925248
    s_mov_b32 s15, 0x20000
    s_and_b32 s8, s56, 1
    s_mul_i32 s66, s56, 995328
    s_mul_i32 s50, s48, 9216
    v_add_u32 v16, s50, v38
    v_add_u32 v17, 4096, v16
    v_add_u32 v18, 8192, v16
    s_add_u32 s24, s10, 23068672
    s_addc_u32 s25, s11, 0
    s_mov_b32 s26, 5505024
    s_mov_b32 s27, 0x20000
    s_add_u32 s28, s10, 41943040
    s_addc_u32 s29, s11, 0
    s_mov_b32 s30, 9437184
    s_mov_b32 s31, 0x20000
    s_add_u32 s32, s10, 125894656
    s_addc_u32 s33, s11, 0
    s_mov_b32 s34, 61440
    s_mov_b32 s35, 0x20000
    s_add_u32 s40, s10, 62914560
    s_addc_u32 s41, s11, 0
    s_mov_b32 s42, 18874368
    s_mov_b32 s43, 0x20000
    s_mov_b32 s60, 0x3ae38e39
    s_mov_b32 s61, 0
    s_mov_b32 s67, 0
    s_mov_b32 s49, 0xc0135761
    v_mov_b32 v37, 0xbdd2d3e8
    s_lshl_b32 s8, s57, 11
    s_lshl_b32 s55, s48, 12
    s_add_u32 s55, s55, s8
    v_and_b32 v67, 15, v0
    v_lshl_add_u32 v41, v67, 7, s8
    s_and_b32 s9, s56, 12
    s_lshl_b32 s9, s9, 7
    s_add_u32 s9, s9, s8
    v_and_b32 v68, 3, v0
    v_lshl_add_u32 v44, v68, 7, s9
    s_lshl_b32 s9, s56, 7
    s_add_u32 s8, s8, s9
    v_lshl_add_u32 v68, v0, 12, s8
    v_cmp_gt_u32 vcc, 1, v0
    v_lshrrev_b32 v69, 4, v60
    v_mul_u32_u24 v39, 9216, v69
    v_cndmask_b32 v40, v66, v68, vcc
    v_lshl_add_u32 v39, v67, 4, v39
    v_mov_b32 v15, v41
    v_mul_u32_u24 v36, 36864, v63
    v_mul_u32_u24 v68, 2304, v62
    v_add_u32 v36, v36, v68
    v_lshl_add_u32 v36, v61, 4, v36
    v_lshl_add_u32 v36, v69, 5, v36
    s_and_b32 s8, s56, 3
    s_mul_i32 s9, s8, 9
    s_add_u32 s9, s9, 1
    s_lshr_b32 s9, s9, 1
    s_lshl_b32 s9, s9, 7
    v_add_u32 v35, s9, v36
    s_lshr_b32 s9, s8, 1
    s_mul_i32 s9, s9, 1152
    s_and_b32 s8, s8, 1
    s_lshl_b32 s8, s8, 3
    s_add_u32 s9, s9, s8
    s_add_u32 s9, s9, 512
    v_add_u32 v36, s9, v36
    v_bfe_u32 v68, v0, 1, 3
    v_mul_u32_u24 v13, 2304, v68
    v_lshl_add_u32 v13, v69, 5, v13
    v_lshl_add_u32 v13, v61, 4, v13
    v_lshlrev_b32 v48, 8, v68
    v_lshl_add_u32 v48, v61, 4, v48
    v_cmp_gt_u32 vcc, 16, v60
    v_lshl_add_u32 v47, v64, 12, v48
    v_lshl_add_u32 v47, v65, 11, v47
    v_cndmask_b32 v48, v66, v48, vcc
    v_mov_b32 v1, v38
    v_add_u32 v2, 49152, v38
    v_add_u32 v3, 98304, v38
    v_lshrrev_b32 v67, 3, v0
    v_mul_u32_u24 v67, 144, v67
    v_and_b32 v68, 7, v0
    v_lshl_add_u32 v67, v68, 4, v67
    v_add_u32 v67, 147456, v67
    v_lshlrev_b32 v68, 1, v65
    v_add_u32 v68, v68, v63
    v_lshl_add_u32 v68, v68, 1, v64
    v_lshrrev_b32 v69, 1, v62
    v_lshl_add_u32 v68, v68, 1, v69
    v_mul_u32_u24 v68, 144, v68
    v_and_b32 v69, 1, v62
    v_lshl_add_u32 v68, v69, 6, v68
    v_lshl_add_u32 v68, v61, 1, v68
    s_lshl_b32 s8, s48, 2
    s_add_u32 s8, s8, 147456
    v_add_u32 v49, s8, v68
    s_mul_i32 s62, s58, 36864
    s_mul_i32 s8, s48, 2304
    s_add_u32 s62, s62, s8
    s_lshl_b32 s8, s57, 2
    s_add_u32 s8, s8, s48
    s_mul_i32 s51, s8, 147456
    s_lshr_b32 s9, s56, 2
    s_mul_i32 s9, s9, 9216
    s_add_u32 s51, s51, s9
    s_add_u32 s52, s51, 73728
    s_add_u32 s8, s56, 1
    s_and_b32 s8, s8, 3
    s_and_b32 s9, s58, 0xffc
    s_add_u32 s8, s8, s9
    s_lshl_b32 s8, s8, 2
    s_add_u32 s8, s8, s48
    s_mul_i32 s71, s8, 18432
    s_add_u32 s8, s56, 2
    s_and_b32 s8, s8, 3
    s_and_b32 s9, s58, 0xffc
    s_add_u32 s8, s8, s9
    s_lshl_b32 s8, s8, 2
    s_add_u32 s8, s8, s48
    s_mul_i32 s72, s8, 18432
    s_add_u32 s8, s56, 3
    s_and_b32 s8, s8, 3
    s_and_b32 s9, s58, 0xffc
    s_add_u32 s8, s8, s9
    s_lshl_b32 s8, s8, 2
    s_add_u32 s8, s8, s48
    s_mul_i32 s73, s8, 18432
    s_lshr_b32 s8, s58, 1
    s_mul_i32 s8, s8, 18432
    s_and_b32 s9, s58, 1
    s_lshl_b32 s9, s9, 7
    s_add_u32 s8, s8, s9
    s_lshl_b32 s9, s48, 5
    s_add_u32 s16, s8, s9
    s_lshl_b32 s8, s57, 2
    s_add_u32 s8, s8, s48
    s_mul_i32 s17, s8, 36864
    s_add_u32 s20, s62, 10485760
    s_add_u32 s21, s16, 3145728
    s_mov_b32 s22, 0
    s_lshr_b32 s8, s56, 2
    s_mul_i32 s8, s8, 288
    s_add_u32 s8, s8, 49152
    v_min_u32 v50, 35, v60
    v_lshl_add_u32 v50, v50, 3, s8
    v_mov_b32 v10, v224
    v_mov_b32 v11, v225
    v_mov_b32 v12, v226
    v_mov_b32 v14, 0
    v_mov_b32 v15, 0
    s_add_u32 s32, s10, 125894656
    s_addc_u32 s33, s11, 0
    s_mov_b32 s34, 61440
    s_mov_b32 s35, 0x20000
    s_mov_b32 s9, 40960
    s_mov_b32 s68, 0
    s_cmp_lg_u32 s48, 0
    s_waitcnt vmcnt(4)
    s_cbranch_scc1 L_flok_mb
L_fl_mb:
    v_cmp_ne_u64 vcc, s[100:101], v[228:229]
    v_cmp_ne_u64 s[98:99], s[100:101], v[230:231]
    s_add_u32 s68, s68, 1
    s_nop 3
    s_or_b64 vcc, vcc, s[98:99]
    s_cbranch_scc0 L_flok_mb
    s_cmp_ge_u32 s68, 200000
    s_cbranch_scc1 L_flok_mb
    s_sleep 4
    buffer_load_dwordx4 v[228:231], v227, s[32:35], s9 offen sc1
    s_waitcnt vmcnt(0)
    s_branch L_fl_mb
L_flok_mb:
    s_barrier
    buffer_load_dwordx4 v[72:75], v71, s[44:47], s4 offen sc1
    buffer_load_dwordx4 v[76:79], v71, s[44:47], s5 offen sc1
    buffer_load_dwordx4 v[80:83], v71, s[44:47], s39 offen sc1
    s_add_u32 m0, s50, 0
    s_nop 0
    buffer_load_dwordx4 v16, s[12:15], s66 offen offset:0 lds
    buffer_load_dwordx4 v16, s[12:15], s66 offen offset:1024 lds
    buffer_load_dwordx4 v16, s[12:15], s66 offen offset:2048 lds
    buffer_load_dwordx4 v16, s[12:15], s66 offen offset:3072 lds
    s_add_u32 m0, s50, 4096
    s_nop 0
    buffer_load_dwordx4 v17, s[12:15], s66 offen offset:0 lds
    buffer_load_dwordx4 v17, s[12:15], s66 offen offset:1024 lds
    buffer_load_dwordx4 v17, s[12:15], s66 offen offset:2048 lds
    buffer_load_dwordx4 v17, s[12:15], s66 offen offset:3072 lds
    s_add_u32 m0, s50, 8192
    s_nop 0
    buffer_load_dwordx4 v18, s[12:15], s66 offen offset:0 lds
    s_mov_b64 s[98:99], 0
    s_mov_b32 s23, 0
    s_cmp_eq_u32 s48, 0
    s_cselect_b32 s75, 2, 99
    s_add_u32 s21, s59, 3145728
    v_cmp_gt_u32 vcc, 16, v60
    v_mov_b32 v228, -1
    v_mov_b32 v229, -1
    v_mov_b32 v230, -1
    v_mov_b32 v231, -1
    v_cndmask_b32 v9, v66, v38, vcc
    v_lshlrev_b32 v124, 16, v236
    v_and_b32 v125, 0xffff0000, v236
    v_lshlrev_b32 v126, 16, v237
    v_and_b32 v127, 0xffff0000, v237
    v_lshlrev_b32 v128, 16, v238
    v_and_b32 v129, 0xffff0000, v238
    v_lshlrev_b32 v130, 16, v239
    v_and_b32 v131, 0xffff0000, v239
    v_lshlrev_b32 v132, 16, v240
    v_and_b32 v133, 0xffff0000, v240
    v_lshlrev_b32 v134, 16, v241
    v_and_b32 v135, 0xffff0000, v241
    v_lshlrev_b32 v136, 16, v242
    v_and_b32 v137, 0xffff0000, v242
    v_lshlrev_b32 v138, 16, v243
    v_and_b32 v139, 0xffff0000, v243
    v_lshlrev_b32 v140, 16, v244
    v_and_b32 v141, 0xffff0000, v244
    v_lshlrev_b32 v142, 16, v245
    v_and_b32 v143, 0xffff0000, v245
L_main_gate:
    v_and_b32 v148, 32, v0
    v_cmp_eq_u32 vcc, 0, v148
    s_nop 1
    v_cndmask_b32 v148, 0, 1.0, vcc
    v_pk_add_f32 v[144:145], v[124:125], v[126:127]
    v_pk_add_f32 v[146:147], v[128:129], v[130:131]
    v_pk_add_f32 v[144:145], v[144:145], v[132:133]
    v_pk_add_f32 v[146:147], v[146:147], v[134:135]
    v_pk_add_f32 v[144:145], v[144:145], v[136:137]
    v_pk_add_f32 v[146:147], v[146:147], v[138:139]
    v_pk_add_f32 v[144:145], v[144:145], v[140:141]
    v_pk_add_f32 v[146:147], v[146:147], v[142:143]
    v_pk_add_f32 v[144:145], v[144:145], v[146:147]
    v_add_f32 v144, v144, v145
    s_nop 1
    v_add_f32_dpp v144, v144, v144 quad_perm:[2,3,0,1] row_mask:0xf bank_mask:0xf
    s_nop 1
    v_add_f32_dpp v144, v144, v144 row_ror:4 row_mask:0xf bank_mask:0xf
    s_nop 1
    v_add_f32_dpp v144, v144, v144 row_ror:8 row_mask:0xf bank_mask:0xf
    v_mov_b32 v145, v144
    s_nop 1
    v_permlane16_swap_b32 v144, v145
    v_add_f32 v144, v144, v145
    v_mov_b32 v145, v144
    s_nop 1
    v_permlane32_swap_b32 v144, v145
    v_add_f32 v144, v144, v145
    v_mul_f32 v144, s60, v144
    v_pk_add_f32 v[92:93], v[124:125], v[144:145] op_sel_hi:[1,0] neg_lo:[0,1] neg_hi:[0,1]
    v_pk_add_f32 v[94:95], v[126:127], v[144:145] op_sel_hi:[1,0] neg_lo:[0,1] neg_hi:[0,1]
    v_pk_add_f32 v[96:97], v[128:129], v[144:145] op_sel_hi:[1,0] neg_lo:[0,1] neg_hi:[0,1]
    v_pk_add_f32 v[98:99], v[130:131], v[144:145] op_sel_hi:[1,0] neg_lo:[0,1] neg_hi:[0,1]
    v_pk_add_f32 v[100:101], v[132:133], v[144:145] op_sel_hi:[1,0] neg_lo:[0,1] neg_hi:[0,1]
    v_pk_add_f32 v[102:103], v[134:135], v[144:145] op_sel_hi:[1,0] neg_lo:[0,1] neg_hi:[0,1]
    v_pk_add_f32 v[104:105], v[136:137], v[144:145] op_sel_hi:[1,0] neg_lo:[0,1] neg_hi:[0,1]
    v_pk_add_f32 v[106:107], v[138:139], v[144:145] op_sel_hi:[1,0] neg_lo:[0,1] neg_hi:[0,1]
    v_pk_add_f32 v[108:109], v[140:141], v[144:145] op_sel_hi:[1,0] neg_lo:[0,1] neg_hi:[0,1]
    v_pk_add_f32 v[110:111], v[142:143], v[144:145] op_sel_hi:[1,0] neg_lo:[0,1] neg_hi:[0,1]
    v_pk_mul_f32 v[108:109], v[108:109], v[148:149] op_sel_hi:[1,0]
    v_pk_mul_f32 v[110:111], v[110:111], v[148:149] op_sel_hi:[1,0]
    v_pk_mul_f32 v[146:147], v[92:93], v[92:93]
    v_pk_fma_f32 v[146:147], v[94:95], v[94:95], v[146:147]
    v_pk_fma_f32 v[146:147], v[96:97], v[96:97], v[146:147]
    v_pk_fma_f32 v[146:147], v[98:99], v[98:99], v[146:147]
    v_pk_fma_f32 v[146:147], v[100:101], v[100:101], v[146:147]
    v_pk_fma_f32 v[146:147], v[102:103], v[102:103], v[146:147]
    v_pk_fma_f32 v[146:147], v[104:105], v[104:105], v[146:147]
    v_pk_fma_f32 v[146:147], v[106:107], v[106:107], v[146:147]
    v_pk_fma_f32 v[146:147], v[108:109], v[108:109], v[146:147]
    v_pk_fma_f32 v[146:147], v[110:111], v[110:111], v[146:147]
    v_add_f32 v146, v146, v147
    s_nop 1
    v_add_f32_dpp v146, v146, v146 quad_perm:[2,3,0,1] row_mask:0xf bank_mask:0xf
    s_nop 1
    v_add_f32_dpp v146, v146, v146 row_ror:4 row_mask:0xf bank_mask:0xf
    s_nop 1
    v_add_f32_dpp v146, v146, v146 row_ror:8 row_mask:0xf bank_mask:0xf
    v_mov_b32 v147, v146
    s_nop 1
    v_permlane16_swap_b32 v146, v147
    v_add_f32 v146, v146, v147
    v_mov_b32 v147, v146
    s_nop 1
    v_permlane32_swap_b32 v146, v147
    v_add_f32 v146, v146, v147
    v_mul_f32 v146, s60, v146
    v_cvt_pk_bf16_f32 v145, v144, v146
    v_and_b32 v146, 0xffff0000, v145
    v_lshlrev_b32 v144, 16, v145
    v_add_f32 v146, 0x3727c5ac, v146
    v_cvt_pk_bf16_f32 v146, v146, v146
    v_and_b32 v146, 0xffff0000, v146
    v_sqrt_f32 v146, v146
    v_pk_add_f32 v[92:93], v[124:125], v[144:145] op_sel_hi:[1,0] neg_lo:[0,1] neg_hi:[0,1]
    v_pk_add_f32 v[94:95], v[126:127], v[144:145] op_sel_hi:[1,0] neg_lo:[0,1] neg_hi:[0,1]
    v_pk_add_f32 v[96:97], v[128:129], v[144:145] op_sel_hi:[1,0] neg_lo:[0,1] neg_hi:[0,1]
    v_pk_add_f32 v[98:99], v[130:131], v[144:145] op_sel_hi:[1,0] neg_lo:[0,1] neg_hi:[0,1]
    v_pk_add_f32 v[100:101], v[132:133], v[144:145] op_sel_hi:[1,0] neg_lo:[0,1] neg_hi:[0,1]
    v_pk_add_f32 v[102:103], v[134:135], v[144:145] op_sel_hi:[1,0] neg_lo:[0,1] neg_hi:[0,1]
    v_pk_add_f32 v[104:105], v[136:137], v[144:145] op_sel_hi:[1,0] neg_lo:[0,1] neg_hi:[0,1]
    v_pk_add_f32 v[106:107], v[138:139], v[144:145] op_sel_hi:[1,0] neg_lo:[0,1] neg_hi:[0,1]
    v_pk_add_f32 v[108:109], v[140:141], v[144:145] op_sel_hi:[1,0] neg_lo:[0,1] neg_hi:[0,1]
    v_pk_add_f32 v[110:111], v[142:143], v[144:145] op_sel_hi:[1,0] neg_lo:[0,1] neg_hi:[0,1]
    v_cvt_pk_bf16_f32 v146, v146, v146
    v_and_b32 v146, 0xffff0000, v146
    v_rcp_f32 v146, v146
    v_cvt_pk_bf16_f32 v112, v92, v93
    v_cvt_pk_bf16_f32 v113, v94, v95
    v_cvt_pk_bf16_f32 v114, v96, v97
    v_cvt_pk_bf16_f32 v115, v98, v99
    v_cvt_pk_bf16_f32 v116, v100, v101
    v_cvt_pk_bf16_f32 v117, v102, v103
    v_cvt_pk_bf16_f32 v118, v104, v105
    v_cvt_pk_bf16_f32 v119, v106, v107
    v_cvt_pk_bf16_f32 v120, v108, v109
    v_cvt_pk_bf16_f32 v121, v110, v111
    v_lshlrev_b32 v92, 16, v112
    v_and_b32 v93, 0xffff0000, v112
    v_lshlrev_b32 v94, 16, v113
    v_and_b32 v95, 0xffff0000, v113
    v_lshlrev_b32 v96, 16, v114
    v_and_b32 v97, 0xffff0000, v114
    v_lshlrev_b32 v98, 16, v115
    v_and_b32 v99, 0xffff0000, v115
    v_lshlrev_b32 v100, 16, v116
    v_and_b32 v101, 0xffff0000, v116
    v_lshlrev_b32 v102, 16, v117
    v_and_b32 v103, 0xffff0000, v117
    v_lshlrev_b32 v104, 16, v118
    v_and_b32 v105, 0xffff0000, v118
    v_lshlrev_b32 v106, 16, v119
    v_and_b32 v107, 0xffff0000, v119
    v_lshlrev_b32 v108, 16, v120
    v_and_b32 v109, 0xffff0000, v120
    v_lshlrev_b32 v110, 16, v121
    v_and_b32 v111, 0xffff0000, v121
    v_pk_mul_f32 v[92:93], v[92:93], v[146:147] op_sel_hi:[1,0]
    v_pk_mul_f32 v[94:95], v[94:95], v[146:147] op_sel_hi:[1,0]
    v_pk_mul_f32 v[96:97], v[96:97], v[146:147] op_sel_hi:[1,0]
    v_pk_mul_f32 v[98:99], v[98:99], v[146:147] op_sel_hi:[1,0]
    v_pk_mul_f32 v[100:101], v[100:101], v[146:147] op_sel_hi:[1,0]
    v_pk_mul_f32 v[102:103], v[102:103], v[146:147] op_sel_hi:[1,0]
    v_pk_mul_f32 v[104:105], v[104:105], v[146:147] op_sel_hi:[1,0]
    v_pk_mul_f32 v[106:107], v[106:107], v[146:147] op_sel_hi:[1,0]
    v_pk_mul_f32 v[108:109], v[108:109], v[146:147] op_sel_hi:[1,0]
    v_pk_mul_f32 v[110:111], v[110:111], v[146:147] op_sel_hi:[1,0]
    v_cvt_pk_bf16_f32 v112, v92, v93
    v_cvt_pk_bf16_f32 v113, v94, v95
    v_cvt_pk_bf16_f32 v114, v96, v97
    v_cvt_pk_bf16_f32 v115, v98, v99
    v_cvt_pk_bf16_f32 v116, v100, v101
    v_cvt_pk_bf16_f32 v117, v102, v103
    v_cvt_pk_bf16_f32 v118, v104, v105
    v_cvt_pk_bf16_f32 v119, v106, v107
    v_cvt_pk_bf16_f32 v120, v108, v109
    v_cvt_pk_bf16_f32 v121, v110, v111
    v_lshlrev_b32 v92, 16, v112
    v_and_b32 v93, 0xffff0000, v112
    v_lshlrev_b32 v94, 16, v113
    v_and_b32 v95, 0xffff0000, v113
    v_lshlrev_b32 v96, 16, v114
    v_and_b32 v97, 0xffff0000, v114
    v_lshlrev_b32 v98, 16, v115
    v_and_b32 v99, 0xffff0000, v115
    v_lshlrev_b32 v100, 16, v116
    v_and_b32 v101, 0xffff0000, v116
    v_lshlrev_b32 v102, 16, v117
    v_and_b32 v103, 0xffff0000, v117
    v_lshlrev_b32 v104, 16, v118
    v_and_b32 v105, 0xffff0000, v118
    v_lshlrev_b32 v106, 16, v119
    v_and_b32 v107, 0xffff0000, v119
    v_lshlrev_b32 v108, 16, v120
    v_and_b32 v109, 0xffff0000, v120
    v_lshlrev_b32 v110, 16, v121
    v_and_b32 v111, 0xffff0000, v121
    s_cmp_lg_u32 s61, 0
    s_cbranch_scc1 L_main_yd
    s_mov_b32 s68, 0
    s_waitcnt vmcnt(9)
    v_max3_u32 v68, v72, v76, v80
    v_cmp_eq_u32 vcc, -1, v68
    s_cbranch_vccz L_main_yq
L_main_yp:
    buffer_load_dwordx4 v[72:75], v71, s[44:47], s4 offen sc1
    buffer_load_dwordx4 v[76:79], v71, s[44:47], s5 offen sc1
    buffer_load_dwordx4 v[80:83], v71, s[44:47], s39 offen sc1
    s_add_u32 s68, s68, 1
    s_waitcnt vmcnt(0)
    v_max3_u32 v68, v72, v76, v80
    v_cmp_eq_u32 vcc, -1, v68
    s_cmp_ge_u32 s68, 100000
    s_cbranch_vccz L_main_yq
    s_cbranch_scc1 L_main_yq
    s_sleep 2
    s_branch L_main_yp
L_main_yq:
    ds_write_b128 v67, v[72:75]
    ds_write_b128 v67, v[76:79] offset:4608
    s_cmp_lg_u32 s48, 0
    s_cbranch_scc1 L_main_y3
    ds_write_b128 v67, v[80:83] offset:9216
L_main_y3:
    s_waitcnt lgkmcnt(0)
    s_barrier
    v_mov_b32 v180, 0
    v_mov_b32 v181, 0
    v_mov_b32 v182, 0
    v_mov_b32 v183, 0
    ds_read_u16 v164, v49 offset:0
    ds_read_u16 v165, v49 offset:16
    ds_read_u16 v166, v49 offset:32
    ds_read_u16 v167, v49 offset:48
    ds_read_u16 v168, v49 offset:2304
    ds_read_u16 v169, v49 offset:2320
    ds_read_u16 v170, v49 offset:2336
    ds_read_u16 v171, v49 offset:2352
    ds_read_u16 v172, v49 offset:4608
    ds_read_u16 v173, v49 offset:4624
    ds_read_u16 v174, v49 offset:4640
    ds_read_u16 v175, v49 offset:4656
    ds_read_u16 v176, v49 offset:6912
    ds_read_u16 v177, v49 offset:6928
    ds_read_u16 v178, v49 offset:6944
    ds_read_u16 v179, v49 offset:6960
    s_mov_b64 exec, 0xffffffff
    ds_read_u16 v180, v49 offset:9216
    ds_read_u16 v181, v49 offset:9232
    ds_read_u16 v182, v49 offset:9248
    ds_read_u16 v183, v49 offset:9264
    s_mov_b64 exec, -1
    s_add_u32 s54, s66, 36864
    s_add_u32 m0, s50, 36864
    s_nop 0
    buffer_load_dwordx4 v16, s[12:15], s54 offen offset:0 lds
    buffer_load_dwordx4 v16, s[12:15], s54 offen offset:1024 lds
    buffer_load_dwordx4 v16, s[12:15], s54 offen offset:2048 lds
    buffer_load_dwordx4 v16, s[12:15], s54 offen offset:3072 lds
    s_add_u32 m0, s50, 40960
    s_nop 0
    buffer_load_dwordx4 v17, s[12:15], s54 offen offset:0 lds
    buffer_load_dwordx4 v17, s[12:15], s54 offen offset:1024 lds
    buffer_load_dwordx4 v17, s[12:15], s54 offen offset:2048 lds
    buffer_load_dwordx4 v17, s[12:15], s54 offen offset:3072 lds
    s_add_u32 m0, s50, 45056
    s_nop 0
    buffer_load_dwordx4 v18, s[12:15], s54 offen offset:0 lds
L_main_yd:
    s_waitcnt lgkmcnt(0)
    v_lshlrev_b32 v164, 16, v164
    v_lshlrev_b32 v165, 16, v165
    v_lshlrev_b32 v166, 16, v166
    v_lshlrev_b32 v167, 16, v167
    v_lshlrev_b32 v168, 16, v168
    v_lshlrev_b32 v169, 16, v169
    v_lshlrev_b32 v170, 16, v170
    v_lshlrev_b32 v171, 16, v171
    v_lshlrev_b32 v172, 16, v172
    v_lshlrev_b32 v173, 16, v173
    v_lshlrev_b32 v174, 16, v174
    v_lshlrev_b32 v175, 16, v175
    v_lshlrev_b32 v176, 16, v176
    v_lshlrev_b32 v177, 16, v177
    v_lshlrev_b32 v178, 16, v178
    v_lshlrev_b32 v179, 16, v179
    v_lshlrev_b32 v180, 16, v180
    v_lshlrev_b32 v181, 16, v181
    v_lshlrev_b32 v182, 16, v182
    v_lshlrev_b32 v183, 16, v183
    v_pk_mul_f32 v[92:93], v[92:93], v[164:165]
    v_pk_mul_f32 v[94:95], v[94:95], v[166:167]
    v_pk_mul_f32 v[96:97], v[96:97], v[168:169]
    v_pk_mul_f32 v[98:99], v[98:99], v[170:171]
    v_pk_mul_f32 v[100:101], v[100:101], v[172:173]
    v_pk_mul_f32 v[102:103], v[102:103], v[174:175]
    v_pk_mul_f32 v[104:105], v[104:105], v[176:177]
    v_pk_mul_f32 v[106:107], v[106:107], v[178:179]
    v_pk_mul_f32 v[108:109], v[108:109], v[180:181]
    v_pk_mul_f32 v[110:111], v[110:111], v[182:183]
    v_cvt_pk_bf16_f32 v112, v92, v93
    v_cvt_pk_bf16_f32 v113, v94, v95
    v_cvt_pk_bf16_f32 v114, v96, v97
    v_cvt_pk_bf16_f32 v115, v98, v99
    v_cvt_pk_bf16_f32 v116, v100, v101
    v_cvt_pk_bf16_f32 v117, v102, v103
    v_cvt_pk_bf16_f32 v118, v104, v105
    v_cvt_pk_bf16_f32 v119, v106, v107
    v_cvt_pk_bf16_f32 v120, v108, v109
    v_cvt_pk_bf16_f32 v121, v110, v111
    v_lshlrev_b32 v92, 16, v112
    v_and_b32 v93, 0xffff0000, v112
    v_lshlrev_b32 v94, 16, v113
    v_and_b32 v95, 0xffff0000, v113
    v_lshlrev_b32 v96, 16, v114
    v_and_b32 v97, 0xffff0000, v114
    v_lshlrev_b32 v98, 16, v115
    v_and_b32 v99, 0xffff0000, v115
    v_lshlrev_b32 v100, 16, v116
    v_and_b32 v101, 0xffff0000, v116
    v_lshlrev_b32 v102, 16, v117
    v_and_b32 v103, 0xffff0000, v117
    v_lshlrev_b32 v104, 16, v118
    v_and_b32 v105, 0xffff0000, v118
    v_lshlrev_b32 v106, 16, v119
    v_and_b32 v107, 0xffff0000, v119
    v_lshlrev_b32 v108, 16, v120
    v_and_b32 v109, 0xffff0000, v120
    v_lshlrev_b32 v110, 16, v121
    v_and_b32 v111, 0xffff0000, v121
    v_pk_add_f32 v[124:125], v[124:125], v[92:93]
    v_pk_add_f32 v[126:127], v[126:127], v[94:95]
    v_pk_add_f32 v[128:129], v[128:129], v[96:97]
    v_pk_add_f32 v[130:131], v[130:131], v[98:99]
    v_pk_add_f32 v[132:133], v[132:133], v[100:101]
    v_pk_add_f32 v[134:135], v[134:135], v[102:103]
    v_pk_add_f32 v[136:137], v[136:137], v[104:105]
    v_pk_add_f32 v[138:139], v[138:139], v[106:107]
    v_pk_add_f32 v[140:141], v[140:141], v[108:109]
    v_pk_add_f32 v[142:143], v[142:143], v[110:111]
    v_cvt_pk_bf16_f32 v236, v124, v125
    v_cvt_pk_bf16_f32 v237, v126, v127
    v_cvt_pk_bf16_f32 v238, v128, v129
    v_cvt_pk_bf16_f32 v239, v130, v131
    v_cvt_pk_bf16_f32 v240, v132, v133
    v_cvt_pk_bf16_f32 v241, v134, v135
    v_cvt_pk_bf16_f32 v242, v136, v137
    v_cvt_pk_bf16_f32 v243, v138, v139
    v_cvt_pk_bf16_f32 v244, v140, v141
    v_cvt_pk_bf16_f32 v245, v142, v143
    v_lshlrev_b32 v124, 16, v236
    v_and_b32 v125, 0xffff0000, v236
    v_lshlrev_b32 v126, 16, v237
    v_and_b32 v127, 0xffff0000, v237
    v_lshlrev_b32 v128, 16, v238
    v_and_b32 v129, 0xffff0000, v238
    v_lshlrev_b32 v130, 16, v239
    v_and_b32 v131, 0xffff0000, v239
    v_lshlrev_b32 v132, 16, v240
    v_and_b32 v133, 0xffff0000, v240
    v_lshlrev_b32 v134, 16, v241
    v_and_b32 v135, 0xffff0000, v241
    v_lshlrev_b32 v136, 16, v242
    v_and_b32 v137, 0xffff0000, v242
    v_lshlrev_b32 v138, 16, v243
    v_and_b32 v139, 0xffff0000, v243
    v_lshlrev_b32 v140, 16, v244
    v_and_b32 v141, 0xffff0000, v244
    v_lshlrev_b32 v142, 16, v245
    v_and_b32 v143, 0xffff0000, v245
    v_pk_add_f32 v[144:145], v[124:125], v[126:127]
    v_pk_add_f32 v[146:147], v[128:129], v[130:131]
    v_pk_add_f32 v[144:145], v[144:145], v[132:133]
    v_pk_add_f32 v[146:147], v[146:147], v[134:135]
    v_pk_add_f32 v[144:145], v[144:145], v[136:137]
    v_pk_add_f32 v[146:147], v[146:147], v[138:139]
    v_pk_add_f32 v[144:145], v[144:145], v[140:141]
    v_pk_add_f32 v[146:147], v[146:147], v[142:143]
    v_pk_add_f32 v[144:145], v[144:145], v[146:147]
    v_add_f32 v144, v144, v145
    s_nop 1
    v_add_f32_dpp v144, v144, v144 quad_perm:[2,3,0,1] row_mask:0xf bank_mask:0xf
    s_nop 1
    v_add_f32_dpp v144, v144, v144 row_ror:4 row_mask:0xf bank_mask:0xf
    s_nop 1
    v_add_f32_dpp v144, v144, v144 row_ror:8 row_mask:0xf bank_mask:0xf
    v_mov_b32 v145, v144
    s_nop 1
    v_permlane16_swap_b32 v144, v145
    v_add_f32 v144, v144, v145
    v_mov_b32 v145, v144
    s_nop 1
    v_permlane32_swap_b32 v144, v145
    v_add_f32 v144, v144, v145
    v_mul_f32 v144, s60, v144
    v_pk_add_f32 v[92:93], v[124:125], v[144:145] op_sel_hi:[1,0] neg_lo:[0,1] neg_hi:[0,1]
    v_pk_add_f32 v[94:95], v[126:127], v[144:145] op_sel_hi:[1,0] neg_lo:[0,1] neg_hi:[0,1]
    v_pk_add_f32 v[96:97], v[128:129], v[144:145] op_sel_hi:[1,0] neg_lo:[0,1] neg_hi:[0,1]
    v_pk_add_f32 v[98:99], v[130:131], v[144:145] op_sel_hi:[1,0] neg_lo:[0,1] neg_hi:[0,1]
    v_pk_add_f32 v[100:101], v[132:133], v[144:145] op_sel_hi:[1,0] neg_lo:[0,1] neg_hi:[0,1]
    v_pk_add_f32 v[102:103], v[134:135], v[144:145] op_sel_hi:[1,0] neg_lo:[0,1] neg_hi:[0,1]
    v_pk_add_f32 v[104:105], v[136:137], v[144:145] op_sel_hi:[1,0] neg_lo:[0,1] neg_hi:[0,1]
    v_pk_add_f32 v[106:107], v[138:139], v[144:145] op_sel_hi:[1,0] neg_lo:[0,1] neg_hi:[0,1]
    v_pk_add_f32 v[108:109], v[140:141], v[144:145] op_sel_hi:[1,0] neg_lo:[0,1] neg_hi:[0,1]
    v_pk_add_f32 v[110:111], v[142:143], v[144:145] op_sel_hi:[1,0] neg_lo:[0,1] neg_hi:[0,1]
    v_pk_mul_f32 v[108:109], v[108:109], v[148:149] op_sel_hi:[1,0]
    v_pk_mul_f32 v[110:111], v[110:111], v[148:149] op_sel_hi:[1,0]
    v_pk_mul_f32 v[146:147], v[92:93], v[92:93]
    v_pk_fma_f32 v[146:147], v[94:95], v[94:95], v[146:147]
    v_pk_fma_f32 v[146:147], v[96:97], v[96:97], v[146:147]
    v_pk_fma_f32 v[146:147], v[98:99], v[98:99], v[146:147]
    v_pk_fma_f32 v[146:147], v[100:101], v[100:101], v[146:147]
    v_pk_fma_f32 v[146:147], v[102:103], v[102:103], v[146:147]
    v_pk_fma_f32 v[146:147], v[104:105], v[104:105], v[146:147]
    v_pk_fma_f32 v[146:147], v[106:107], v[106:107], v[146:147]
    v_pk_fma_f32 v[146:147], v[108:109], v[108:109], v[146:147]
    v_pk_fma_f32 v[146:147], v[110:111], v[110:111], v[146:147]
    v_add_f32 v146, v146, v147
    s_nop 1
    v_add_f32_dpp v146, v146, v146 quad_perm:[2,3,0,1] row_mask:0xf bank_mask:0xf
    s_nop 1
    v_add_f32_dpp v146, v146, v146 row_ror:4 row_mask:0xf bank_mask:0xf
    s_nop 1
    v_add_f32_dpp v146, v146, v146 row_ror:8 row_mask:0xf bank_mask:0xf
    v_mov_b32 v147, v146
L_pg_main0:
    s_cbranch_execz L_wret
    s_nop 1
    v_permlane16_swap_b32 v146, v147
    v_add_f32 v146, v146, v147
    v_mov_b32 v147, v146
    s_nop 1
    v_permlane32_swap_b32 v146, v147
    v_add_f32 v146, v146, v147
    v_mul_f32 v146, s60, v146
    v_cvt_pk_bf16_f32 v145, v144, v146
    v_and_b32 v146, 0xffff0000, v145
    v_lshlrev_b32 v144, 16, v145
    v_add_f32 v146, 0x3727c5ac, v146
    v_cvt_pk_bf16_f32 v146, v146, v146
    v_and_b32 v146, 0xffff0000, v146
    v_sqrt_f32 v146, v146
    v_pk_add_f32 v[92:93], v[124:125], v[144:145] op_sel_hi:[1,0] neg_lo:[0,1] neg_hi:[0,1]
    v_pk_add_f32 v[94:95], v[126:127], v[144:145] op_sel_hi:[1,0] neg_lo:[0,1] neg_hi:[0,1]
    v_pk_add_f32 v[96:97], v[128:129], v[144:145] op_sel_hi:[1,0] neg_lo:[0,1] neg_hi:[0,1]
    v_pk_add_f32 v[98:99], v[130:131], v[144:145] op_sel_hi:[1,0] neg_lo:[0,1] neg_hi:[0,1]
    v_pk_add_f32 v[100:101], v[132:133], v[144:145] op_sel_hi:[1,0] neg_lo:[0,1] neg_hi:[0,1]
    v_pk_add_f32 v[102:103], v[134:135], v[144:145] op_sel_hi:[1,0] neg_lo:[0,1] neg_hi:[0,1]
    v_pk_add_f32 v[104:105], v[136:137], v[144:145] op_sel_hi:[1,0] neg_lo:[0,1] neg_hi:[0,1]
    v_pk_add_f32 v[106:107], v[138:139], v[144:145] op_sel_hi:[1,0] neg_lo:[0,1] neg_hi:[0,1]
    v_pk_add_f32 v[108:109], v[140:141], v[144:145] op_sel_hi:[1,0] neg_lo:[0,1] neg_hi:[0,1]
    v_pk_add_f32 v[110:111], v[142:143], v[144:145] op_sel_hi:[1,0] neg_lo:[0,1] neg_hi:[0,1]
    v_cvt_pk_bf16_f32 v146, v146, v146
    v_and_b32 v146, 0xffff0000, v146
    v_rcp_f32 v146, v146
    v_cvt_pk_bf16_f32 v112, v92, v93
    v_cvt_pk_bf16_f32 v113, v94, v95
    v_cvt_pk_bf16_f32 v114, v96, v97
    v_cvt_pk_bf16_f32 v115, v98, v99
    v_cvt_pk_bf16_f32 v116, v100, v101
    v_cvt_pk_bf16_f32 v117, v102, v103
    v_cvt_pk_bf16_f32 v118, v104, v105
    v_cvt_pk_bf16_f32 v119, v106, v107
    v_cvt_pk_bf16_f32 v120, v108, v109
    v_cvt_pk_bf16_f32 v121, v110, v111
    v_lshlrev_b32 v92, 16, v112
    v_and_b32 v93, 0xffff0000, v112
    v_lshlrev_b32 v94, 16, v113
    v_and_b32 v95, 0xffff0000, v113
    v_lshlrev_b32 v96, 16, v114
    v_and_b32 v97, 0xffff0000, v114
    v_lshlrev_b32 v98, 16, v115
    v_and_b32 v99, 0xffff0000, v115
    v_lshlrev_b32 v100, 16, v116
    v_and_b32 v101, 0xffff0000, v116
    v_lshlrev_b32 v102, 16, v117
    v_and_b32 v103, 0xffff0000, v117
    v_lshlrev_b32 v104, 16, v118
    v_and_b32 v105, 0xffff0000, v118
    v_lshlrev_b32 v106, 16, v119
    v_and_b32 v107, 0xffff0000, v119
    v_lshlrev_b32 v108, 16, v120
    v_and_b32 v109, 0xffff0000, v120
    v_lshlrev_b32 v110, 16, v121
    v_and_b32 v111, 0xffff0000, v121
    v_pk_mul_f32 v[92:93], v[92:93], v[146:147] op_sel_hi:[1,0]
    v_pk_mul_f32 v[94:95], v[94:95], v[146:147] op_sel_hi:[1,0]
    v_pk_mul_f32 v[96:97], v[96:97], v[146:147] op_sel_hi:[1,0]
    v_pk_mul_f32 v[98:99], v[98:99], v[146:147] op_sel_hi:[1,0]
    v_pk_mul_f32 v[100:101], v[100:101], v[146:147] op_sel_hi:[1,0]
    v_pk_mul_f32 v[102:103], v[102:103], v[146:147] op_sel_hi:[1,0]
    v_pk_mul_f32 v[104:105], v[104:105], v[146:147] op_sel_hi:[1,0]
    v_pk_mul_f32 v[106:107], v[106:107], v[146:147] op_sel_hi:[1,0]
    v_pk_mul_f32 v[108:109], v[108:109], v[146:147] op_sel_hi:[1,0]
    v_pk_mul_f32 v[110:111], v[110:111], v[146:147] op_sel_hi:[1,0]
    v_cvt_pk_bf16_f32 v112, v92, v93
    v_cvt_pk_bf16_f32 v113, v94, v95
    v_cvt_pk_bf16_f32 v114, v96, v97
    v_cvt_pk_bf16_f32 v115, v98, v99
    v_cvt_pk_bf16_f32 v116, v100, v101
    v_cvt_pk_bf16_f32 v117, v102, v103
    v_cvt_pk_bf16_f32 v118, v104, v105
    v_cvt_pk_bf16_f32 v119, v106, v107
    v_cvt_pk_bf16_f32 v120, v108, v109
    v_cvt_pk_bf16_f32 v121, v110, v111
    s_mov_b32 s8, s16
    s_add_u32 s9, s8, 8192
    s_add_u32 s55, s8, 16384
    v_permlane16_swap_b32 v112, v114
    v_permlane16_swap_b32 v113, v115
    v_permlane16_swap_b32 v116, v118
    v_permlane16_swap_b32 v117, v119
    v_permlane16_swap_b32 v120, v122
    v_permlane16_swap_b32 v121, v123
    buffer_store_dwordx4 v[112:115], v47, s[24:27], s8 offen sc1
    buffer_store_dwordx4 v[116:119], v47, s[24:27], s9 offen sc1
    buffer_store_dwordx4 v[120:123], v48, s[24:27], s55 offen sc1
    s_mov_b32 s9, s17
    s_add_u32 s8, s9, 18432
    s_mov_b32 s53, 0
    s_add_u32 s63, s66, 110592
    s_lshl_b32 s70, s58, 2
    s_add_u32 s70, s70, s48
    s_mul_i32 s70, s70, 18432
    s_sub_u32 s70, s70, 4096
    s_waitcnt vmcnt(12)
    s_barrier
    s_add_u32 s54, s66, 73728
    s_add_u32 m0, s50, 73728
    s_nop 0
    buffer_load_dwordx4 v16, s[12:15], s54 offen offset:0 lds
    buffer_load_dwordx4 v16, s[12:15], s54 offen offset:1024 lds
    buffer_load_dwordx4 v16, s[12:15], s54 offen offset:2048 lds
    buffer_load_dwordx4 v16, s[12:15], s54 offen offset:3072 lds
    s_add_u32 m0, s50, 77824
    s_nop 0
    buffer_load_dwordx4 v17, s[12:15], s54 offen offset:0 lds
    buffer_load_dwordx4 v17, s[12:15], s54 offen offset:1024 lds
    buffer_load_dwordx4 v17, s[12:15], s54 offen offset:2048 lds
    buffer_load_dwordx4 v17, s[12:15], s54 offen offset:3072 lds
    s_add_u32 m0, s50, 81920
    s_nop 0
    buffer_load_dwordx4 v18, s[12:15], s54 offen offset:0 lds
    s_add_u32 s54, s66, 110592
    s_add_u32 m0, s50, 110592
    s_nop 0
    buffer_load_dwordx4 v16, s[12:15], s54 offen offset:0 lds
    buffer_load_dwordx4 v16, s[12:15], s54 offen offset:1024 lds
    buffer_load_dwordx4 v16, s[12:15], s54 offen offset:2048 lds
    buffer_load_dwordx4 v16, s[12:15], s54 offen offset:3072 lds
    s_add_u32 m0, s50, 114688
    s_nop 0
    buffer_load_dwordx4 v17, s[12:15], s54 offen offset:0 lds
    buffer_load_dwordx4 v17, s[12:15], s54 offen offset:1024 lds
    buffer_load_dwordx4 v17, s[12:15], s54 offen offset:2048 lds
    buffer_load_dwordx4 v17, s[12:15], s54 offen offset:3072 lds
    s_add_u32 m0, s50, 118784
    s_nop 0
    buffer_load_dwordx4 v18, s[12:15], s54 offen offset:0 lds
    ds_read_b128 a[144:147], v1 offset:0
    ds_read_b128 a[148:151], v1 offset:1024
    ds_read_b128 a[152:155], v1 offset:2048
    ds_read_b128 a[156:159], v1 offset:3072
    ds_read_b128 a[160:163], v1 offset:4096
    ds_read_b128 a[164:167], v1 offset:5120
    ds_read_b128 a[168:171], v1 offset:6144
    ds_read_b128 a[172:175], v1 offset:7168
    ds_read_b128 a[176:179], v1 offset:8192
    s_mov_b32 s68, 1
    buffer_load_dwordx4 a[0:3], v38, s[24:27], s9 offen offset:0 sc1
    buffer_load_dwordx4 a[4:7], v38, s[24:27], s8 offen offset:0 sc1
    buffer_load_dwordx4 a[8:11], v38, s[24:27], s9 offen offset:1024 sc1
    buffer_load_dwordx4 a[12:15], v38, s[24:27], s8 offen offset:1024 sc1
    buffer_load_dwordx4 a[16:19], v38, s[24:27], s9 offen offset:2048 sc1
    buffer_load_dwordx4 a[20:23], v38, s[24:27], s8 offen offset:2048 sc1
    buffer_load_dwordx4 a[24:27], v38, s[24:27], s9 offen offset:3072 sc1
    buffer_load_dwordx4 a[28:31], v38, s[24:27], s8 offen offset:3072 sc1
    s_add_u32 s9, s9, 4096
    s_add_u32 s8, s8, 4096
    buffer_load_dwordx4 a[32:35], v38, s[24:27], s9 offen offset:0 sc1
    buffer_load_dwordx4 a[36:39], v38, s[24:27], s8 offen offset:0 sc1
    buffer_load_dwordx4 a[40:43], v38, s[24:27], s9 offen offset:1024 sc1
    buffer_load_dwordx4 a[44:47], v38, s[24:27], s8 offen offset:1024 sc1
    s_waitcnt vmcnt(10)
    v_accvgpr_read_b32 v52, a0
    v_accvgpr_read_b32 v53, a4
    v_max_u32 v224, v52, v53
    s_waitcnt vmcnt(8)
    v_accvgpr_read_b32 v54, a8
    v_accvgpr_read_b32 v55, a12
    v_max3_u32 v224, v54, v55, v224
    v_cmp_eq_u32 vcc, -1, v224
    s_cbranch_vccnz L_main_xp
L_main_xq:
    s_waitcnt lgkmcnt(3)
    v_mfma_f32_16x16x32_bf16 v[60:63], a[144:147], a[0:3], 0
    ds_read_b128 a[180:183], v1 offset:9216
    v_mfma_f32_16x16x32_bf16 v[64:67], a[144:147], a[4:7], 0
    buffer_load_dwordx4 a[48:51], v38, s[24:27], s9 offen offset:2048 sc1
    v_mfma_f32_16x16x32_bf16 v[68:71], a[148:151], a[0:3], 0
    ds_read_b128 a[184:187], v1 offset:10240
    v_mfma_f32_16x16x32_bf16 v[72:75], a[148:151], a[4:7], 0
    buffer_load_dwordx4 a[52:55], v38, s[24:27], s8 offen offset:2048 sc1
    v_mfma_f32_16x16x32_bf16 v[76:79], a[152:155], a[0:3], 0
    ds_read_b128 a[188:191], v1 offset:11264
    v_mfma_f32_16x16x32_bf16 v[80:83], a[152:155], a[4:7], 0
    buffer_load_dwordx4 a[56:59], v38, s[24:27], s9 offen offset:3072 sc1
    v_mfma_f32_16x16x32_bf16 v[84:87], a[156:159], a[0:3], 0
    ds_read_b128 a[144:147], v1 offset:12288
    v_mfma_f32_16x16x32_bf16 v[88:91], a[156:159], a[4:7], 0
    buffer_load_dwordx4 a[60:63], v38, s[24:27], s8 offen offset:3072 sc1
    v_mfma_f32_16x16x32_bf16 v[60:63], a[160:163], a[8:11], v[60:63]
    s_add_u32 s9, s9, 4096
    ds_read_b128 a[148:151], v1 offset:13312
    v_mfma_f32_16x16x32_bf16 v[64:67], a[160:163], a[12:15], v[64:67]
    s_add_u32 s8, s8, 4096
    buffer_load_dwordx4 a[64:67], v38, s[24:27], s9 offen offset:0 sc1
    v_mfma_f32_16x16x32_bf16 v[68:71], a[164:167], a[8:11], v[68:71]
    s_waitcnt vmcnt(11)
    ds_read_b128 a[152:155], v1 offset:14336
    v_accvgpr_read_b32 v52, a16
    v_mfma_f32_16x16x32_bf16 v[72:75], a[164:167], a[12:15], v[72:75]
    s_waitcnt lgkmcnt(3)
    buffer_load_dwordx4 a[68:71], v38, s[24:27], s8 offen offset:0 sc1
    v_accvgpr_read_b32 v53, a20
    v_mfma_f32_16x16x32_bf16 v[76:79], a[168:171], a[8:11], v[76:79]
    ds_read_b128 a[156:159], v1 offset:15360
    v_max_u32 v52, v52, v53
    v_mfma_f32_16x16x32_bf16 v[80:83], a[168:171], a[12:15], v[80:83]
    buffer_load_dwordx4 a[72:75], v38, s[24:27], s9 offen offset:1024 sc1
    v_cmp_eq_u32 vcc, -1, v52
    v_mfma_f32_16x16x32_bf16 v[84:87], a[172:175], a[8:11], v[84:87]
    ds_read_b128 a[160:163], v1 offset:16384
    v_mfma_f32_16x16x32_bf16 v[88:91], a[172:175], a[12:15], v[88:91]
    s_cbranch_vccnz L_xs2
L_xb2:
    buffer_load_dwordx4 a[76:79], v38, s[24:27], s8 offen offset:1024 sc1
    v_mfma_f32_16x16x32_bf16 v[60:63], a[176:179], a[16:19], v[60:63]
    ds_read_b128 a[164:167], v1 offset:17408
    v_mfma_f32_16x16x32_bf16 v[64:67], a[176:179], a[20:23], v[64:67]
    buffer_load_dwordx4 a[80:83], v38, s[24:27], s9 offen offset:2048 sc1
    v_mfma_f32_16x16x32_bf16 v[68:71], a[180:183], a[16:19], v[68:71]
    s_waitcnt vmcnt(13)
    ds_read_b128 a[168:171], v1 offset:18432
    v_accvgpr_read_b32 v56, a24
    v_mfma_f32_16x16x32_bf16 v[72:75], a[180:183], a[20:23], v[72:75]
    buffer_load_dwordx4 a[84:87], v38, s[24:27], s8 offen offset:2048 sc1
    v_accvgpr_read_b32 v57, a28
    v_mfma_f32_16x16x32_bf16 v[76:79], a[184:187], a[16:19], v[76:79]
    ds_read_b128 a[172:175], v1 offset:19456
    v_max_u32 v56, v56, v57
    v_mfma_f32_16x16x32_bf16 v[80:83], a[184:187], a[20:23], v[80:83]
    buffer_load_dwordx4 a[88:91], v38, s[24:27], s9 offen offset:3072 sc1
    v_cmp_eq_u32 vcc, -1, v56
    v_mfma_f32_16x16x32_bf16 v[84:87], a[188:191], a[16:19], v[84:87]
    ds_read_b128 a[176:179], v1 offset:20480
    v_mfma_f32_16x16x32_bf16 v[88:91], a[188:191], a[20:23], v[88:91]
    s_waitcnt lgkmcnt(3)
    s_cbranch_vccnz L_xs3
L_xb3:
    buffer_load_dwordx4 a[92:95], v38, s[24:27], s8 offen offset:3072 sc1
    v_mfma_f32_16x16x32_bf16 v[60:63], a[144:147], a[24:27], v[60:63]
    s_add_u32 s9, s9, 4096
    ds_read_b128 a[180:183], v1 offset:21504
    v_mfma_f32_16x16x32_bf16 v[64:67], a[144:147], a[28:31], v[64:67]
    s_add_u32 s8, s8, 4096
    buffer_load_dwordx4 a[96:99], v38, s[24:27], s9 offen offset:0 sc1
    v_mfma_f32_16x16x32_bf16 v[68:71], a[148:151], a[24:27], v[68:71]
    s_waitcnt vmcnt(15)
    ds_read_b128 a[184:187], v1 offset:22528
    v_accvgpr_read_b32 v52, a32
    v_mfma_f32_16x16x32_bf16 v[72:75], a[148:151], a[28:31], v[72:75]
    buffer_load_dwordx4 a[100:103], v38, s[24:27], s8 offen offset:0 sc1
    v_accvgpr_read_b32 v53, a36
    v_mfma_f32_16x16x32_bf16 v[76:79], a[152:155], a[24:27], v[76:79]
    ds_read_b128 a[188:191], v1 offset:23552
    v_max_u32 v52, v52, v53
    v_mfma_f32_16x16x32_bf16 v[80:83], a[152:155], a[28:31], v[80:83]
    buffer_load_dwordx4 a[104:107], v38, s[24:27], s9 offen offset:1024 sc1
    v_cmp_eq_u32 vcc, -1, v52
    v_mfma_f32_16x16x32_bf16 v[84:87], a[156:159], a[24:27], v[84:87]
    ds_read_b128 a[144:147], v1 offset:24576
    v_mfma_f32_16x16x32_bf16 v[88:91], a[156:159], a[28:31], v[88:91]
    s_cbranch_vccnz L_xs4
L_xb4:
    buffer_load_dwordx4 a[108:111], v38, s[24:27], s8 offen offset:1024 sc1
    v_mfma_f32_16x16x32_bf16 v[60:63], a[160:163], a[32:35], v[60:63]
    ds_read_b128 a[148:151], v1 offset:25600
    v_mfma_f32_16x16x32_bf16 v[64:67], a[160:163], a[36:39], v[64:67]
    buffer_load_dwordx4 a[112:115], v38, s[24:27], s9 offen offset:2048 sc1
    v_mfma_f32_16x16x32_bf16 v[68:71], a[164:167], a[32:35], v[68:71]
    s_waitcnt vmcnt(17)
    ds_read_b128 a[152:155], v1 offset:26624
    v_accvgpr_read_b32 v56, a40
    v_mfma_f32_16x16x32_bf16 v[72:75], a[164:167], a[36:39], v[72:75]
    s_waitcnt lgkmcnt(3)
    buffer_load_dwordx4 a[116:119], v38, s[24:27], s8 offen offset:2048 sc1
    v_accvgpr_read_b32 v57, a44
    v_mfma_f32_16x16x32_bf16 v[76:79], a[168:171], a[32:35], v[76:79]
    ds_read_b128 a[156:159], v1 offset:27648
    v_max_u32 v56, v56, v57
    v_mfma_f32_16x16x32_bf16 v[80:83], a[168:171], a[36:39], v[80:83]
    buffer_load_dwordx4 a[120:123], v38, s[24:27], s9 offen offset:3072 sc1
    v_cmp_eq_u32 vcc, -1, v56
    v_mfma_f32_16x16x32_bf16 v[84:87], a[172:175], a[32:35], v[84:87]
    ds_read_b128 a[160:163], v1 offset:28672
    v_mfma_f32_16x16x32_bf16 v[88:91], a[172:175], a[36:39], v[88:91]
    s_cbranch_vccnz L_xs5
L_xb5:
    buffer_load_dwordx4 a[124:127], v38, s[24:27], s8 offen offset:3072 sc1
    v_mfma_f32_16x16x32_bf16 v[60:63], a[176:179], a[40:43], v[60:63]
    s_add_u32 s9, s9, 4096
    ds_read_b128 a[164:167], v1 offset:29696
    v_mfma_f32_16x16x32_bf16 v[64:67], a[176:179], a[44:47], v[64:67]
    s_add_u32 s8, s8, 4096
    buffer_load_dwordx4 a[128:131], v38, s[24:27], s9 offen offset:0 sc1
    v_mfma_f32_16x16x32_bf16 v[68:71], a[180:183], a[40:43], v[68:71]
    s_waitcnt vmcnt(19)
    ds_read_b128 a[168:171], v1 offset:30720
    v_accvgpr_read_b32 v52, a48
    v_mfma_f32_16x16x32_bf16 v[72:75], a[180:183], a[44:47], v[72:75]
    buffer_load_dwordx4 a[132:135], v38, s[24:27], s8 offen offset:0 sc1
    v_accvgpr_read_b32 v53, a52
    v_mfma_f32_16x16x32_bf16 v[76:79], a[184:187], a[40:43], v[76:79]
    ds_read_b128 a[172:175], v1 offset:31744
    v_max_u32 v52, v52, v53
    v_mfma_f32_16x16x32_bf16 v[80:83], a[184:187], a[44:47], v[80:83]
    buffer_load_dwordx4 a[136:139], v38, s[24:27], s9 offen offset:1024 sc1
    v_cmp_eq_u32 vcc, -1, v52
    v_mfma_f32_16x16x32_bf16 v[84:87], a[188:191], a[40:43], v[84:87]
    ds_read_b128 a[176:179], v1 offset:32768
    v_mfma_f32_16x16x32_bf16 v[88:91], a[188:191], a[44:47], v[88:91]
    s_waitcnt lgkmcnt(3)
    s_cbranch_vccnz L_xs6
L_xb6:
    buffer_load_dwordx4 a[140:143], v38, s[24:27], s8 offen offset:1024 sc1
    v_mfma_f32_16x16x32_bf16 v[60:63], a[144:147], a[48:51], v[60:63]
    ds_read_b128 a[180:183], v1 offset:33792
    v_mfma_f32_16x16x32_bf16 v[64:67], a[144:147], a[52:55], v[64:67]
    v_mfma_f32_16x16x32_bf16 v[68:71], a[148:151], a[48:51], v[68:71]
    s_waitcnt vmcnt(20)
    ds_read_b128 a[184:187], v1 offset:34816
    v_accvgpr_read_b32 v56, a56
    v_mfma_f32_16x16x32_bf16 v[72:75], a[148:151], a[52:55], v[72:75]
    v_accvgpr_read_b32 v57, a60
    v_mfma_f32_16x16x32_bf16 v[76:79], a[152:155], a[48:51], v[76:79]
    ds_read_b128 a[188:191], v1 offset:35840
    v_max_u32 v56, v56, v57
    v_mfma_f32_16x16x32_bf16 v[80:83], a[152:155], a[52:55], v[80:83]
    v_cmp_eq_u32 vcc, -1, v56
    v_mfma_f32_16x16x32_bf16 v[84:87], a[156:159], a[48:51], v[84:87]
    s_barrier
    ds_read_b128 a[144:147], v1 offset:36864
    v_mfma_f32_16x16x32_bf16 v[88:91], a[156:159], a[52:55], v[88:91]
    s_cbranch_vccnz L_xs7
L_xb7:
    v_mfma_f32_16x16x32_bf16 v[60:63], a[160:163], a[56:59], v[60:63]
    ds_read_b128 a[148:151], v1 offset:37888
    v_mfma_f32_16x16x32_bf16 v[64:67], a[160:163], a[60:63], v[64:67]
    v_mfma_f32_16x16x32_bf16 v[68:71], a[164:167], a[56:59], v[68:71]
    s_waitcnt vmcnt(18)
    ds_read_b128 a[152:155], v1 offset:38912
    v_accvgpr_read_b32 v52, a64
    v_mfma_f32_16x16x32_bf16 v[72:75], a[164:167], a[60:63], v[72:75]
    s_waitcnt lgkmcnt(3)
    v_accvgpr_read_b32 v53, a68
    v_mfma_f32_16x16x32_bf16 v[76:79], a[168:171], a[56:59], v[76:79]
    ds_read_b128 a[156:159], v1 offset:39936
    v_max_u32 v52, v52, v53
    v_mfma_f32_16x16x32_bf16 v[80:83], a[168:171], a[60:63], v[80:83]
    v_cmp_eq_u32 vcc, -1, v52
    v_mfma_f32_16x16x32_bf16 v[84:87], a[172:175], a[56:59], v[84:87]
    ds_read_b128 a[160:163], v1 offset:40960
    v_mfma_f32_16x16x32_bf16 v[88:91], a[172:175], a[60:63], v[88:91]
    s_cbranch_vccnz L_xs8
L_xb8:
    v_mfma_f32_16x16x32_bf16 v[60:63], a[176:179], a[64:67], v[60:63]
    ds_read_b128 a[164:167], v1 offset:41984
    v_mfma_f32_16x16x32_bf16 v[64:67], a[176:179], a[68:71], v[64:67]
    v_mfma_f32_16x16x32_bf16 v[68:71], a[180:183], a[64:67], v[68:71]
    s_waitcnt vmcnt(16)
    ds_read_b128 a[168:171], v1 offset:43008
    v_accvgpr_read_b32 v56, a72
    v_mfma_f32_16x16x32_bf16 v[72:75], a[180:183], a[68:71], v[72:75]
    v_accvgpr_read_b32 v57, a76
    v_mfma_f32_16x16x32_bf16 v[76:79], a[184:187], a[64:67], v[76:79]
    ds_read_b128 a[172:175], v1 offset:44032
    v_max_u32 v56, v56, v57
    v_mfma_f32_16x16x32_bf16 v[80:83], a[184:187], a[68:71], v[80:83]
    v_cmp_eq_u32 vcc, -1, v56
    v_mfma_f32_16x16x32_bf16 v[84:87], a[188:191], a[64:67], v[84:87]
    ds_read_b128 a[176:179], v1 offset:45056
    v_mfma_f32_16x16x32_bf16 v[88:91], a[188:191], a[68:71], v[88:91]
    s_waitcnt lgkmcnt(3)
    s_cbranch_vccnz L_xs9
L_xb9:
    v_mfma_f32_16x16x32_bf16 v[60:63], a[144:147], a[72:75], v[60:63]
    ds_read_b128 a[180:183], v1 offset:46080
    v_mfma_f32_16x16x32_bf16 v[64:67], a[144:147], a[76:79], v[64:67]
    buffer_store_dwordx4 v[228:231], v38, s[24:27], s21 offen offset:0 sc1
    v_mfma_f32_16x16x32_bf16 v[68:71], a[148:151], a[72:75], v[68:71]
    s_waitcnt vmcnt(15)
    ds_read_b128 a[184:187], v1 offset:47104
    v_accvgpr_read_b32 v52, a80
    v_mfma_f32_16x16x32_bf16 v[72:75], a[148:151], a[76:79], v[72:75]
    buffer_store_dwordx4 v[228:231], v38, s[24:27], s21 offen offset:1024 sc1
    v_accvgpr_read_b32 v53, a84
    v_mfma_f32_16x16x32_bf16 v[76:79], a[152:155], a[72:75], v[76:79]
    ds_read_b128 a[188:191], v1 offset:48128
    v_max_u32 v52, v52, v53
    v_mfma_f32_16x16x32_bf16 v[80:83], a[152:155], a[76:79], v[80:83]
    buffer_store_dwordx4 v[228:231], v9, s[24:27], s21 offen offset:2048 sc1
    v_cmp_eq_u32 vcc, -1, v52
    v_mfma_f32_16x16x32_bf16 v[84:87], a[156:159], a[72:75], v[84:87]
    ds_read_b128 a[144:147], v2 offset:0
    v_mfma_f32_16x16x32_bf16 v[88:91], a[156:159], a[76:79], v[88:91]
    s_cbranch_vccnz L_xs10
L_xb10:
    buffer_store_dwordx4 a[192:195], v38, s[12:15], s38 offen sc1
    v_mfma_f32_16x16x32_bf16 v[60:63], a[160:163], a[80:83], v[60:63]
    s_add_u32 s36, s36, s37
    ds_read_b128 a[148:151], v2 offset:1024
    v_mfma_f32_16x16x32_bf16 v[64:67], a[160:163], a[84:87], v[64:67]
    buffer_store_dwordx4 a[196:199], v38, s[12:15], s36 offen sc1
    v_mfma_f32_16x16x32_bf16 v[68:71], a[164:167], a[80:83], v[68:71]
    s_waitcnt vmcnt(17)
    s_add_u32 s36, s36, s37
    ds_read_b128 a[152:155], v2 offset:2048
    v_accvgpr_read_b32 v56, a88
    v_mfma_f32_16x16x32_bf16 v[72:75], a[164:167], a[84:87], v[72:75]
    s_waitcnt lgkmcnt(3)
    buffer_store_dwordx4 a[200:203], v38, s[12:15], s36 offen sc1
    v_accvgpr_read_b32 v57, a92
    v_mfma_f32_16x16x32_bf16 v[76:79], a[168:171], a[80:83], v[76:79]
    s_add_u32 s36, s36, s37
    ds_read_b128 a[156:159], v2 offset:3072
    v_max_u32 v56, v56, v57
    v_mfma_f32_16x16x32_bf16 v[80:83], a[168:171], a[84:87], v[80:83]
    buffer_store_dwordx4 a[204:207], v38, s[12:15], s36 offen sc1
    v_cmp_eq_u32 vcc, -1, v56
    v_mfma_f32_16x16x32_bf16 v[84:87], a[172:175], a[80:83], v[84:87]
    s_add_u32 s36, s36, s37
    ds_read_b128 a[160:163], v2 offset:4096
    v_mfma_f32_16x16x32_bf16 v[88:91], a[172:175], a[84:87], v[88:91]
    s_cbranch_vccnz L_xs11
L_xb11:
    buffer_store_dwordx4 a[208:211], v38, s[12:15], s36 offen sc1
    v_mfma_f32_16x16x32_bf16 v[60:63], a[176:179], a[88:91], v[60:63]
    s_add_u32 s36, s36, s37
    ds_read_b128 a[164:167], v2 offset:5120
    v_mfma_f32_16x16x32_bf16 v[64:67], a[176:179], a[92:95], v[64:67]
    buffer_store_dwordx4 a[212:215], v38, s[12:15], s36 offen sc1
    v_mfma_f32_16x16x32_bf16 v[68:71], a[180:183], a[88:91], v[68:71]
    s_waitcnt vmcnt(19)
    s_add_u32 s36, s36, s37
    ds_read_b128 a[168:171], v2 offset:6144
    v_accvgpr_read_b32 v52, a96
    v_mfma_f32_16x16x32_bf16 v[72:75], a[180:183], a[92:95], v[72:75]
    s_add_u32 s63, s63, 36864
    buffer_store_dwordx4 a[216:219], v38, s[12:15], s36 offen sc1
    v_accvgpr_read_b32 v53, a100
    v_mfma_f32_16x16x32_bf16 v[76:79], a[184:187], a[88:91], v[76:79]
    s_add_u32 m0, s50, 0
    s_add_u32 s36, s36, s37
    ds_read_b128 a[172:175], v2 offset:7168
    v_max_u32 v52, v52, v53
    v_mfma_f32_16x16x32_bf16 v[80:83], a[184:187], a[92:95], v[80:83]
    buffer_load_dwordx4 v16, s[12:15], s63 offen offset:0 lds
    buffer_store_dwordx4 a[220:223], v38, s[12:15], s36 offen sc1
    v_cmp_eq_u32 vcc, -1, v52
    v_mfma_f32_16x16x32_bf16 v[84:87], a[188:191], a[88:91], v[84:87]
    s_add_u32 s36, s36, s37
    ds_read_b128 a[176:179], v2 offset:8192
    v_mfma_f32_16x16x32_bf16 v[88:91], a[188:191], a[92:95], v[88:91]
    s_waitcnt lgkmcnt(3)
    s_cbranch_vccnz L_xs12
L_xb12:
    buffer_store_dwordx4 a[224:227], v38, s[12:15], s36 offen sc1
    v_mfma_f32_16x16x32_bf16 v[60:63], a[144:147], a[96:99], v[60:63]
    ds_read_b128 a[180:183], v2 offset:9216
    v_mfma_f32_16x16x32_bf16 v[64:67], a[144:147], a[100:103], v[64:67]
    v_mfma_f32_16x16x32_bf16 v[68:71], a[148:151], a[96:99], v[68:71]
    s_waitcnt vmcnt(21)
    ds_read_b128 a[184:187], v2 offset:10240
    v_accvgpr_read_b32 v56, a104
    v_mfma_f32_16x16x32_bf16 v[72:75], a[148:151], a[100:103], v[72:75]
    buffer_load_dwordx4 v16, s[12:15], s63 offen offset:1024 lds
    v_accvgpr_read_b32 v57, a108
    v_mfma_f32_16x16x32_bf16 v[76:79], a[152:155], a[96:99], v[76:79]
    ds_read_b128 a[188:191], v2 offset:11264
    v_max_u32 v56, v56, v57
    v_mfma_f32_16x16x32_bf16 v[80:83], a[152:155], a[100:103], v[80:83]
    v_cmp_eq_u32 vcc, -1, v56
    v_mfma_f32_16x16x32_bf16 v[84:87], a[156:159], a[96:99], v[84:87]
    ds_read_b128 a[144:147], v2 offset:12288
    v_mfma_f32_16x16x32_bf16 v[88:91], a[156:159], a[100:103], v[88:91]
    s_cbranch_vccnz L_xs13
L_xb13:
    v_mfma_f32_16x16x32_bf16 v[60:63], a[160:163], a[104:107], v[60:63]
    ds_read_b128 a[148:151], v2 offset:13312
    v_mfma_f32_16x16x32_bf16 v[64:67], a[160:163], a[108:111], v[64:67]
    buffer_load_dwordx4 v16, s[12:15], s63 offen offset:2048 lds
    v_mfma_f32_16x16x32_bf16 v[68:71], a[164:167], a[104:107], v[68:71]
    s_waitcnt vmcnt(21)
    ds_read_b128 a[152:155], v2 offset:14336
    v_accvgpr_read_b32 v52, a112
    v_mfma_f32_16x16x32_bf16 v[72:75], a[164:167], a[108:111], v[72:75]
    s_waitcnt lgkmcnt(3)
    v_accvgpr_read_b32 v53, a116
    v_mfma_f32_16x16x32_bf16 v[76:79], a[168:171], a[104:107], v[76:79]
    ds_read_b128 a[156:159], v2 offset:15360
    v_max_u32 v52, v52, v53
    v_mfma_f32_16x16x32_bf16 v[80:83], a[168:171], a[108:111], v[80:83]
    v_cmp_eq_u32 vcc, -1, v52
    v_mfma_f32_16x16x32_bf16 v[84:87], a[172:175], a[104:107], v[84:87]
    ds_read_b128 a[160:163], v2 offset:16384
    v_mfma_f32_16x16x32_bf16 v[88:91], a[172:175], a[108:111], v[88:91]
    s_cbranch_vccnz L_xs14
L_xb14:
    buffer_load_dwordx4 v16, s[12:15], s63 offen offset:3072 lds
    v_mfma_f32_16x16x32_bf16 v[60:63], a[176:179], a[112:115], v[60:63]
    ds_read_b128 a[164:167], v2 offset:17408
    v_mfma_f32_16x16x32_bf16 v[64:67], a[176:179], a[116:119], v[64:67]
    v_mfma_f32_16x16x32_bf16 v[68:71], a[180:183], a[112:115], v[68:71]
    s_waitcnt vmcnt(20)
    ds_read_b128 a[168:171], v2 offset:18432
    v_accvgpr_read_b32 v56, a120
    v_mfma_f32_16x16x32_bf16 v[72:75], a[180:183], a[116:119], v[72:75]
    v_accvgpr_read_b32 v57, a124
    v_mfma_f32_16x16x32_bf16 v[76:79], a[184:187], a[112:115], v[76:79]
    s_add_u32 m0, s50, 4096
    ds_read_b128 a[172:175], v2 offset:19456
    v_max_u32 v56, v56, v57
    v_mfma_f32_16x16x32_bf16 v[80:83], a[184:187], a[116:119], v[80:83]
    buffer_load_dwordx4 v17, s[12:15], s63 offen offset:0 lds
    v_cmp_eq_u32 vcc, -1, v56
    v_mfma_f32_16x16x32_bf16 v[84:87], a[188:191], a[112:115], v[84:87]
    ds_read_b128 a[176:179], v2 offset:20480
    v_mfma_f32_16x16x32_bf16 v[88:91], a[188:191], a[116:119], v[88:91]
    s_waitcnt lgkmcnt(3)
    s_cbranch_vccnz L_xs15
L_xb15:
    v_mfma_f32_16x16x32_bf16 v[60:63], a[144:147], a[120:123], v[60:63]
    ds_read_b128 a[180:183], v2 offset:21504
    v_mfma_f32_16x16x32_bf16 v[64:67], a[144:147], a[124:127], v[64:67]
    v_mfma_f32_16x16x32_bf16 v[68:71], a[148:151], a[120:123], v[68:71]
    s_waitcnt vmcnt(19)
    ds_read_b128 a[184:187], v2 offset:22528
    v_accvgpr_read_b32 v52, a128
    v_mfma_f32_16x16x32_bf16 v[72:75], a[148:151], a[124:127], v[72:75]
    buffer_load_dwordx4 v17, s[12:15], s63 offen offset:1024 lds
    v_accvgpr_read_b32 v53, a132
    v_mfma_f32_16x16x32_bf16 v[76:79], a[152:155], a[120:123], v[76:79]
    ds_read_b128 a[188:191], v2 offset:23552
    v_max_u32 v52, v52, v53
    v_mfma_f32_16x16x32_bf16 v[80:83], a[152:155], a[124:127], v[80:83]
    s_waitcnt vmcnt(42)
    v_cmp_eq_u32 vcc, -1, v52
    v_mfma_f32_16x16x32_bf16 v[84:87], a[156:159], a[120:123], v[84:87]
    s_barrier
    ds_read_b128 a[144:147], v2 offset:24576
    v_mfma_f32_16x16x32_bf16 v[88:91], a[156:159], a[124:127], v[88:91]
    s_cbranch_vccnz L_xs16
L_xb16:
    v_mfma_f32_16x16x32_bf16 v[60:63], a[160:163], a[128:131], v[60:63]
    ds_read_b128 a[148:151], v2 offset:25600
    v_mfma_f32_16x16x32_bf16 v[64:67], a[160:163], a[132:135], v[64:67]
    buffer_load_dwordx4 v17, s[12:15], s63 offen offset:2048 lds
    v_mfma_f32_16x16x32_bf16 v[68:71], a[164:167], a[128:131], v[68:71]
    s_waitcnt vmcnt(19)
    ds_read_b128 a[152:155], v2 offset:26624
    v_accvgpr_read_b32 v56, a136
    v_mfma_f32_16x16x32_bf16 v[72:75], a[164:167], a[132:135], v[72:75]
    s_waitcnt lgkmcnt(3)
    v_accvgpr_read_b32 v57, a140
    v_mfma_f32_16x16x32_bf16 v[76:79], a[168:171], a[128:131], v[76:79]
    ds_read_b128 a[156:159], v2 offset:27648
    v_max_u32 v56, v56, v57
    v_mfma_f32_16x16x32_bf16 v[80:83], a[168:171], a[132:135], v[80:83]
    v_cmp_eq_u32 vcc, -1, v56
    v_mfma_f32_16x16x32_bf16 v[84:87], a[172:175], a[128:131], v[84:87]
    ds_read_b128 a[160:163], v2 offset:28672
    v_mfma_f32_16x16x32_bf16 v[88:91], a[172:175], a[132:135], v[88:91]
    s_cbranch_vccnz L_xs17
L_xb17:
    buffer_load_dwordx4 v17, s[12:15], s63 offen offset:3072 lds
    v_mfma_f32_16x16x32_bf16 v[92:95], a[176:179], a[136:139], v[60:63]
    ds_read_b128 a[164:167], v2 offset:29696
    v_mfma_f32_16x16x32_bf16 v[96:99], a[176:179], a[140:143], v[64:67]
    v_mfma_f32_16x16x32_bf16 v[100:103], a[180:183], a[136:139], v[68:71]
    ds_read_b128 a[168:171], v2 offset:30720
    v_mfma_f32_16x16x32_bf16 v[104:107], a[180:183], a[140:143], v[72:75]
    v_mfma_f32_16x16x32_bf16 v[108:111], a[184:187], a[136:139], v[76:79]
    ds_read_b128 a[172:175], v2 offset:31744
    v_mfma_f32_16x16x32_bf16 v[112:115], a[184:187], a[140:143], v[80:83]
    v_mfma_f32_16x16x32_bf16 v[116:119], a[188:191], a[136:139], v[84:87]
    s_add_u32 m0, s50, 8192
    ds_read_b128 a[176:179], v2 offset:32768
    v_mfma_f32_16x16x32_bf16 v[120:123], a[188:191], a[140:143], v[88:91]
    s_waitcnt lgkmcnt(3)
    buffer_load_dwordx4 v18, s[12:15], s63 offen offset:0 lds
    s_branch L_main_p1m
.p2align 6
L_main_p1:
    v_mfma_f32_16x16x32_bf16 v[60:63], a[144:147], a[0:3], 0
L_pm_p1:
    s_cbranch_execz L_wret
    ds_read_b128 a[180:183], v1 offset:9216
    v_mul_f32 v124, v92, v124
    v_mfma_f32_16x16x32_bf16 v[64:67], a[144:147], a[4:7], 0
    s_add_u32 s63, s63, 36864
    v_exp_f32 v59, v59
    v_mfma_f32_16x16x32_bf16 v[68:71], a[148:151], a[0:3], 0
    s_add_u32 m0, s50, 110592
    ds_read_b128 a[184:187], v1 offset:10240
    v_mul_f32 v125, v93, v125
    v_mfma_f32_16x16x32_bf16 v[72:75], a[148:151], a[4:7], 0
    buffer_load_dwordx4 v16, s[12:15], s63 offen offset:0 lds
    v_mfma_f32_16x16x32_bf16 v[76:79], a[152:155], a[0:3], 0
    ds_read_b128 a[188:191], v1 offset:11264
    v_mul_f32 v126, v94, v126
    v_mfma_f32_16x16x32_bf16 v[80:83], a[152:155], a[4:7], 0
    v_mul_f32 v127, v95, v127
    v_cvt_pk_bf16_f32 v212, v124, v125
    v_mfma_f32_16x16x32_bf16 v[84:87], a[156:159], a[0:3], 0
    ds_read_b128 a[144:147], v1 offset:12288
    v_cvt_pk_bf16_f32 v213, v126, v127
    v_mfma_f32_16x16x32_bf16 v[88:91], a[156:159], a[4:7], 0
L_pg_main1:
    s_cbranch_execz L_wret
    v_mul_f32 v128, v96, v128
    v_mul_f32 v129, v97, v129
    v_mfma_f32_16x16x32_bf16 v[60:63], a[160:163], a[8:11], v[60:63]
    ds_read_b128 a[148:151], v1 offset:13312
    v_mul_f32 v130, v98, v130
    v_mfma_f32_16x16x32_bf16 v[64:67], a[160:163], a[12:15], v[64:67]
    buffer_load_dwordx4 v16, s[12:15], s63 offen offset:1024 lds
    v_mfma_f32_16x16x32_bf16 v[68:71], a[164:167], a[8:11], v[68:71]
    ds_read_b128 a[152:155], v1 offset:14336
    v_mul_f32 v131, v99, v131
    v_mfma_f32_16x16x32_bf16 v[72:75], a[164:167], a[12:15], v[72:75]
    s_waitcnt lgkmcnt(3)
    v_cvt_pk_bf16_f32 v216, v128, v129
    v_cvt_pk_bf16_f32 v217, v130, v131
    v_mfma_f32_16x16x32_bf16 v[76:79], a[168:171], a[8:11], v[76:79]
    ds_read_b128 a[156:159], v1 offset:15360
    v_mul_f32 v132, v100, v132
    v_mfma_f32_16x16x32_bf16 v[80:83], a[168:171], a[12:15], v[80:83]
    v_mul_f32 v133, v101, v133
    v_mul_f32 v134, v102, v134
    v_mfma_f32_16x16x32_bf16 v[84:87], a[172:175], a[8:11], v[84:87]
    ds_read_b128 a[160:163], v1 offset:16384
    v_mul_f32 v135, v103, v135
    v_mfma_f32_16x16x32_bf16 v[88:91], a[172:175], a[12:15], v[88:91]
    buffer_load_dwordx4 v16, s[12:15], s63 offen offset:2048 lds
    v_mfma_f32_16x16x32_bf16 v[60:63], a[176:179], a[16:19], v[60:63]
    ds_read_b128 a[164:167], v1 offset:17408
    v_cvt_pk_bf16_f32 v214, v132, v133
    v_mfma_f32_16x16x32_bf16 v[64:67], a[176:179], a[20:23], v[64:67]
    v_cvt_pk_bf16_f32 v215, v134, v135
    v_mul_f32 v136, v104, v136
    v_mfma_f32_16x16x32_bf16 v[68:71], a[180:183], a[16:19], v[68:71]
    ds_read_b128 a[168:171], v1 offset:18432
    v_mul_f32 v137, v105, v137
    v_mfma_f32_16x16x32_bf16 v[72:75], a[180:183], a[20:23], v[72:75]
    buffer_store_dwordx4 v[212:215], v38, s[40:43], s70 offen offset:0 sc1
    v_mul_f32 v138, v106, v138
    v_mfma_f32_16x16x32_bf16 v[76:79], a[184:187], a[16:19], v[76:79]
    ds_read_b128 a[172:175], v1 offset:19456
    v_mul_f32 v139, v107, v139
    v_mfma_f32_16x16x32_bf16 v[80:83], a[184:187], a[20:23], v[80:83]
    buffer_load_dwordx4 v16, s[12:15], s63 offen offset:3072 lds
    v_mfma_f32_16x16x32_bf16 v[84:87], a[188:191], a[16:19], v[84:87]
    ds_read_b128 a[176:179], v1 offset:20480
    v_cvt_pk_bf16_f32 v218, v136, v137
    v_mfma_f32_16x16x32_bf16 v[88:91], a[188:191], a[20:23], v[88:91]
    s_waitcnt lgkmcnt(3)
    v_cvt_pk_bf16_f32 v219, v138, v139
    v_add_f32 v59, 1.0, v59
    v_mfma_f32_16x16x32_bf16 v[60:63], a[144:147], a[24:27], v[60:63]
    ds_read_b128 a[180:183], v1 offset:21504
    v_mul_f32 v140, v108, v140
    v_mfma_f32_16x16x32_bf16 v[64:67], a[144:147], a[28:31], v[64:67]
    buffer_store_dwordx4 v[216:219], v38, s[40:43], s70 offen offset:1024 sc1
    v_mul_f32 v141, v109, v141
    v_mfma_f32_16x16x32_bf16 v[68:71], a[148:151], a[24:27], v[68:71]
    s_add_u32 m0, s50, 114688
    ds_read_b128 a[184:187], v1 offset:22528
    v_mul_f32 v142, v110, v142
    v_mfma_f32_16x16x32_bf16 v[72:75], a[148:151], a[28:31], v[72:75]
    buffer_load_dwordx4 v17, s[12:15], s63 offen offset:0 lds
    v_mfma_f32_16x16x32_bf16 v[76:79], a[152:155], a[24:27], v[76:79]
    ds_read_b128 a[188:191], v1 offset:23552
    v_cvt_pk_bf16_f32 v220, v140, v141
    v_mfma_f32_16x16x32_bf16 v[80:83], a[152:155], a[28:31], v[80:83]
    v_rcp_f32 v59, v59
    v_mfma_f32_16x16x32_bf16 v[84:87], a[156:159], a[24:27], v[84:87]
    ds_read_b128 a[144:147], v1 offset:24576
    v_mul_f32 v19, v19, v112
    v_mfma_f32_16x16x32_bf16 v[88:91], a[156:159], a[28:31], v[88:91]
    v_exp_f32 v19, v19
    v_mfma_f32_16x16x32_bf16 v[60:63], a[160:163], a[32:35], v[60:63]
    ds_read_b128 a[148:151], v1 offset:25600
    v_mul_f32 v111, v111, v59
    v_mfma_f32_16x16x32_bf16 v[64:67], a[160:163], a[36:39], v[64:67]
    buffer_load_dwordx4 v17, s[12:15], s63 offen offset:1024 lds
    v_mfma_f32_16x16x32_bf16 v[68:71], a[164:167], a[32:35], v[68:71]
    ds_read_b128 a[152:155], v1 offset:26624
    v_mul_f32 v143, v111, v143
    v_mfma_f32_16x16x32_bf16 v[72:75], a[164:167], a[36:39], v[72:75]
    s_waitcnt lgkmcnt(3)
    v_cvt_pk_bf16_f32 v221, v142, v143
    v_add_f32 v19, 1.0, v19
    v_mfma_f32_16x16x32_bf16 v[76:79], a[168:171], a[32:35], v[76:79]
    ds_read_b128 a[156:159], v1 offset:27648
    v_mul_f32 v20, v113, v113
    v_mfma_f32_16x16x32_bf16 v[80:83], a[168:171], a[36:39], v[80:83]
    v_rcp_f32 v19, v19
    v_mfma_f32_16x16x32_bf16 v[84:87], a[172:175], a[32:35], v[84:87]
    ds_read_b128 a[160:163], v1 offset:28672
    v_fma_f32 v20, v20, v37, s49
    v_mfma_f32_16x16x32_bf16 v[88:91], a[172:175], a[36:39], v[88:91]
    buffer_load_dwordx4 v17, s[12:15], s63 offen offset:2048 lds
    v_mfma_f32_16x16x32_bf16 v[60:63], a[176:179], a[40:43], v[60:63]
    s_cmp_eq_u32 s53, s75
    ds_read_b128 a[164:167], v1 offset:29696
    v_mul_f32 v112, v112, v19
    v_mfma_f32_16x16x32_bf16 v[64:67], a[176:179], a[44:47], v[64:67]
    s_cselect_b32 s39, 0, 2130706432
    v_mul_f32 v20, v20, v113
    v_mul_f32 v21, v114, v114
    v_mfma_f32_16x16x32_bf16 v[68:71], a[180:183], a[40:43], v[68:71]
    s_cselect_b64 s[98:99], s[100:101], 0
    ds_read_b128 a[168:171], v1 offset:30720
    v_fma_f32 v21, v21, v37, s49
    v_mfma_f32_16x16x32_bf16 v[72:75], a[180:183], a[44:47], v[72:75]
    v_exp_f32 v20, v20
    v_mfma_f32_16x16x32_bf16 v[76:79], a[184:187], a[40:43], v[76:79]
    ds_read_b128 a[172:175], v1 offset:31744
    v_mul_f32 v21, v21, v114
    v_mfma_f32_16x16x32_bf16 v[80:83], a[184:187], a[44:47], v[80:83]
    buffer_load_dwordx4 v17, s[12:15], s63 offen offset:3072 lds
    v_mfma_f32_16x16x32_bf16 v[84:87], a[188:191], a[40:43], v[84:87]
    ds_read_b128 a[176:179], v1 offset:32768
    v_add_f32 v20, 1.0, v20
    v_mfma_f32_16x16x32_bf16 v[88:91], a[188:191], a[44:47], v[88:91]
    s_waitcnt lgkmcnt(3)
    buffer_load_dwordx2 v[14:15], v50, s[32:35], s39 offen sc1
    v_mfma_f32_16x16x32_bf16 v[60:63], a[144:147], a[48:51], v[60:63]
    ds_read_b128 a[180:183], v1 offset:33792
    v_mul_f32 v22, v115, v115
    v_mfma_f32_16x16x32_bf16 v[64:67], a[144:147], a[52:55], v[64:67]
    v_rcp_f32 v20, v20
    v_mfma_f32_16x16x32_bf16 v[68:71], a[148:151], a[48:51], v[68:71]
    s_add_u32 m0, s50, 118784
    ds_read_b128 a[184:187], v1 offset:34816
    v_fma_f32 v22, v22, v37, s49
    v_mfma_f32_16x16x32_bf16 v[72:75], a[148:151], a[52:55], v[72:75]
    buffer_load_dwordx4 v18, s[12:15], s63 offen offset:0 lds
    v_mfma_f32_16x16x32_bf16 v[76:79], a[152:155], a[48:51], v[76:79]
    ds_read_b128 a[188:191], v1 offset:35840
    v_mul_f32 v113, v113, v20
    v_mfma_f32_16x16x32_bf16 v[80:83], a[152:155], a[52:55], v[80:83]
    s_waitcnt vmcnt(22)
    v_exp_f32 v21, v21
    v_mfma_f32_16x16x32_bf16 v[84:87], a[156:159], a[48:51], v[84:87]
    s_barrier
    ds_read_b128 a[144:147], v1 offset:36864
    v_mul_f32 v22, v22, v115
    v_mfma_f32_16x16x32_bf16 v[88:91], a[156:159], a[52:55], v[88:91]
    v_exp_f32 v22, v22
    v_mfma_f32_16x16x32_bf16 v[60:63], a[160:163], a[56:59], v[60:63]
    ds_read_b128 a[148:151], v1 offset:37888
    v_add_f32 v21, 1.0, v21
    v_mfma_f32_16x16x32_bf16 v[64:67], a[160:163], a[60:63], v[64:67]
    v_rcp_f32 v21, v21
    v_mfma_f32_16x16x32_bf16 v[68:71], a[164:167], a[56:59], v[68:71]
    ds_read_b128 a[152:155], v1 offset:38912
    v_add_f32 v22, 1.0, v22
    v_mfma_f32_16x16x32_bf16 v[72:75], a[164:167], a[60:63], v[72:75]
    s_waitcnt lgkmcnt(3)
    v_rcp_f32 v22, v22
    v_mfma_f32_16x16x32_bf16 v[76:79], a[168:171], a[56:59], v[76:79]
    ds_read_b128 a[156:159], v1 offset:39936
    v_mul_f32 v114, v114, v21
    v_mfma_f32_16x16x32_bf16 v[80:83], a[168:171], a[60:63], v[80:83]
    v_mul_f32 v115, v115, v22
    v_mul_f32 v144, v112, v144
    v_mfma_f32_16x16x32_bf16 v[84:87], a[172:175], a[56:59], v[84:87]
    ds_read_b128 a[160:163], v1 offset:40960
    v_mul_f32 v145, v113, v145
    v_mfma_f32_16x16x32_bf16 v[88:91], a[172:175], a[60:63], v[88:91]
    v_mul_f32 v146, v114, v146
    v_mul_f32 v147, v115, v147
    v_mfma_f32_16x16x32_bf16 v[60:63], a[176:179], a[64:67], v[60:63]
    ds_read_b128 a[164:167], v1 offset:41984
    v_cvt_pk_bf16_f32 v224, v144, v145
    v_mfma_f32_16x16x32_bf16 v[64:67], a[176:179], a[68:71], v[64:67]
    v_cvt_pk_bf16_f32 v225, v146, v147
    v_mul_f32 v52, v116, v116
    v_mfma_f32_16x16x32_bf16 v[68:71], a[180:183], a[64:67], v[68:71]
    ds_read_b128 a[168:171], v1 offset:43008
    v_fma_f32 v52, v52, v37, s49
    v_mfma_f32_16x16x32_bf16 v[72:75], a[180:183], a[68:71], v[72:75]
    v_mul_f32 v52, v52, v116
    v_mul_f32 v53, v117, v117
    v_mfma_f32_16x16x32_bf16 v[76:79], a[184:187], a[64:67], v[76:79]
    ds_read_b128 a[172:175], v1 offset:44032
    v_fma_f32 v53, v53, v37, s49
    v_mfma_f32_16x16x32_bf16 v[80:83], a[184:187], a[68:71], v[80:83]
    v_exp_f32 v52, v52
    v_mfma_f32_16x16x32_bf16 v[84:87], a[188:191], a[64:67], v[84:87]
    ds_read_b128 a[176:179], v1 offset:45056
    v_mul_f32 v53, v53, v117
    v_mfma_f32_16x16x32_bf16 v[88:91], a[188:191], a[68:71], v[88:91]
    s_waitcnt lgkmcnt(3)
    v_exp_f32 v53, v53
    v_mfma_f32_16x16x32_bf16 v[60:63], a[144:147], a[72:75], v[60:63]
    ds_read_b128 a[180:183], v1 offset:46080
    v_add_f32 v52, 1.0, v52
    v_mfma_f32_16x16x32_bf16 v[64:67], a[144:147], a[76:79], v[64:67]
    s_add_u32 s63, s63, 36864
    v_rcp_f32 v52, v52
    v_mfma_f32_16x16x32_bf16 v[68:71], a[148:151], a[72:75], v[68:71]
    s_add_u32 m0, s50, 0
    ds_read_b128 a[184:187], v1 offset:47104
    v_add_f32 v53, 1.0, v53
    v_mfma_f32_16x16x32_bf16 v[72:75], a[148:151], a[76:79], v[72:75]
    buffer_load_dwordx4 v16, s[12:15], s63 offen offset:0 lds
    v_mfma_f32_16x16x32_bf16 v[76:79], a[152:155], a[72:75], v[76:79]
    ds_read_b128 a[188:191], v1 offset:48128
    v_mul_f32 v116, v116, v52
    v_mfma_f32_16x16x32_bf16 v[80:83], a[152:155], a[76:79], v[80:83]
    v_rcp_f32 v53, v53
    v_mfma_f32_16x16x32_bf16 v[84:87], a[156:159], a[72:75], v[84:87]
    ds_read_b128 a[144:147], v2 offset:0
    v_mul_f32 v54, v118, v118
    v_mfma_f32_16x16x32_bf16 v[88:91], a[156:159], a[76:79], v[88:91]
    v_mul_f32 v117, v117, v53
    v_fma_f32 v54, v54, v37, s49
    v_mfma_f32_16x16x32_bf16 v[60:63], a[160:163], a[80:83], v[60:63]
    ds_read_b128 a[148:151], v2 offset:1024
    v_mul_f32 v54, v54, v118
    v_mfma_f32_16x16x32_bf16 v[64:67], a[160:163], a[84:87], v[64:67]
    buffer_load_dwordx4 v16, s[12:15], s63 offen offset:1024 lds
    v_mfma_f32_16x16x32_bf16 v[68:71], a[164:167], a[80:83], v[68:71]
    ds_read_b128 a[152:155], v2 offset:2048
    v_mul_f32 v55, v119, v119
    v_mfma_f32_16x16x32_bf16 v[72:75], a[164:167], a[84:87], v[72:75]
    s_waitcnt lgkmcnt(3)
    v_exp_f32 v54, v54
    v_mfma_f32_16x16x32_bf16 v[76:79], a[168:171], a[80:83], v[76:79]
    ds_read_b128 a[156:159], v2 offset:3072
    v_fma_f32 v55, v55, v37, s49
    v_mfma_f32_16x16x32_bf16 v[80:83], a[168:171], a[84:87], v[80:83]
    v_add_f32 v54, 1.0, v54
    v_mul_f32 v55, v55, v119
    v_mfma_f32_16x16x32_bf16 v[84:87], a[172:175], a[80:83], v[84:87]
    ds_read_b128 a[160:163], v2 offset:4096
    v_mul_f32 v148, v116, v148
    v_mfma_f32_16x16x32_bf16 v[88:91], a[172:175], a[84:87], v[88:91]
    buffer_load_dwordx4 v16, s[12:15], s63 offen offset:2048 lds
    v_mfma_f32_16x16x32_bf16 v[60:63], a[176:179], a[88:91], v[60:63]
    ds_read_b128 a[164:167], v2 offset:5120
    v_mul_f32 v149, v117, v149
    v_mfma_f32_16x16x32_bf16 v[64:67], a[176:179], a[92:95], v[64:67]
    v_rcp_f32 v54, v54
    v_mfma_f32_16x16x32_bf16 v[68:71], a[180:183], a[88:91], v[68:71]
    ds_read_b128 a[168:171], v2 offset:6144
    v_cvt_pk_bf16_f32 v222, v148, v149
    v_mfma_f32_16x16x32_bf16 v[72:75], a[180:183], a[92:95], v[72:75]
    v_exp_f32 v55, v55
    v_mfma_f32_16x16x32_bf16 v[76:79], a[184:187], a[88:91], v[76:79]
    ds_read_b128 a[172:175], v2 offset:7168
    v_mul_f32 v118, v118, v54
    v_mfma_f32_16x16x32_bf16 v[80:83], a[184:187], a[92:95], v[80:83]
    buffer_load_dwordx4 v16, s[12:15], s63 offen offset:3072 lds
    v_mfma_f32_16x16x32_bf16 v[84:87], a[188:191], a[88:91], v[84:87]
    ds_read_b128 a[176:179], v2 offset:8192
    v_add_f32 v55, 1.0, v55
    v_mfma_f32_16x16x32_bf16 v[88:91], a[188:191], a[92:95], v[88:91]
    s_waitcnt lgkmcnt(3)
    v_rcp_f32 v55, v55
    v_mfma_f32_16x16x32_bf16 v[60:63], a[144:147], a[96:99], v[60:63]
    ds_read_b128 a[180:183], v2 offset:9216
    v_mul_f32 v150, v118, v150
    v_mfma_f32_16x16x32_bf16 v[64:67], a[144:147], a[100:103], v[64:67]
    v_mul_f32 v119, v119, v55
    v_mul_f32 v56, v120, v120
    v_mfma_f32_16x16x32_bf16 v[68:71], a[148:151], a[96:99], v[68:71]
    s_add_u32 m0, s50, 4096
    ds_read_b128 a[184:187], v2 offset:10240
    v_mul_f32 v151, v119, v151
    v_mfma_f32_16x16x32_bf16 v[72:75], a[148:151], a[100:103], v[72:75]
    buffer_load_dwordx4 v17, s[12:15], s63 offen offset:0 lds
    v_mfma_f32_16x16x32_bf16 v[76:79], a[152:155], a[96:99], v[76:79]
    ds_read_b128 a[188:191], v2 offset:11264
    v_cvt_pk_bf16_f32 v223, v150, v151
    v_mfma_f32_16x16x32_bf16 v[80:83], a[152:155], a[100:103], v[80:83]
    buffer_store_dwordx4 v[220:223], v38, s[40:43], s70 offen offset:2048 sc1
    v_fma_f32 v56, v56, v37, s49
    v_mfma_f32_16x16x32_bf16 v[84:87], a[156:159], a[96:99], v[84:87]
    ds_read_b128 a[144:147], v2 offset:12288
    v_mul_f32 v56, v56, v120
    v_mfma_f32_16x16x32_bf16 v[88:91], a[156:159], a[100:103], v[88:91]
    v_exp_f32 v56, v56
    v_mfma_f32_16x16x32_bf16 v[60:63], a[160:163], a[104:107], v[60:63]
    ds_read_b128 a[148:151], v2 offset:13312
    v_mul_f32 v57, v121, v121
    v_mfma_f32_16x16x32_bf16 v[64:67], a[160:163], a[108:111], v[64:67]
    buffer_load_dwordx4 v17, s[12:15], s63 offen offset:1024 lds
    v_mfma_f32_16x16x32_bf16 v[68:71], a[164:167], a[104:107], v[68:71]
    ds_read_b128 a[152:155], v2 offset:14336
    v_add_f32 v56, 1.0, v56
    v_mfma_f32_16x16x32_bf16 v[72:75], a[164:167], a[108:111], v[72:75]
    s_waitcnt lgkmcnt(3)
    v_rcp_f32 v56, v56
    v_mfma_f32_16x16x32_bf16 v[76:79], a[168:171], a[104:107], v[76:79]
    ds_read_b128 a[156:159], v2 offset:15360
    v_fma_f32 v57, v57, v37, s49
    v_mfma_f32_16x16x32_bf16 v[80:83], a[168:171], a[108:111], v[80:83]
    v_mul_f32 v120, v120, v56
    v_mul_f32 v57, v57, v121
    v_mfma_f32_16x16x32_bf16 v[84:87], a[172:175], a[104:107], v[84:87]
    ds_read_b128 a[160:163], v2 offset:16384
    v_mul_f32 v58, v122, v122
    v_mfma_f32_16x16x32_bf16 v[88:91], a[172:175], a[108:111], v[88:91]
    buffer_load_dwordx4 v17, s[12:15], s63 offen offset:2048 lds
    v_mfma_f32_16x16x32_bf16 v[60:63], a[176:179], a[112:115], v[60:63]
    ds_read_b128 a[164:167], v2 offset:17408
    v_fma_f32 v58, v58, v37, s49
    v_mfma_f32_16x16x32_bf16 v[64:67], a[176:179], a[116:119], v[64:67]
    v_exp_f32 v57, v57
    v_mfma_f32_16x16x32_bf16 v[68:71], a[180:183], a[112:115], v[68:71]
    ds_read_b128 a[168:171], v2 offset:18432
    v_mul_f32 v58, v58, v122
    v_mfma_f32_16x16x32_bf16 v[72:75], a[180:183], a[116:119], v[72:75]
    v_exp_f32 v58, v58
    v_mfma_f32_16x16x32_bf16 v[76:79], a[184:187], a[112:115], v[76:79]
    ds_read_b128 a[172:175], v2 offset:19456
    v_add_f32 v57, 1.0, v57
    v_mfma_f32_16x16x32_bf16 v[80:83], a[184:187], a[116:119], v[80:83]
    buffer_load_dwordx4 v17, s[12:15], s63 offen offset:3072 lds
    v_mfma_f32_16x16x32_bf16 v[84:87], a[188:191], a[112:115], v[84:87]
    ds_read_b128 a[176:179], v2 offset:20480
    v_add_f32 v58, 1.0, v58
    v_mfma_f32_16x16x32_bf16 v[88:91], a[188:191], a[116:119], v[88:91]
    s_waitcnt lgkmcnt(3)
    v_rcp_f32 v57, v57
    v_mfma_f32_16x16x32_bf16 v[60:63], a[144:147], a[120:123], v[60:63]
    ds_read_b128 a[180:183], v2 offset:21504
    v_mul_f32 v59, v123, v123
    v_mfma_f32_16x16x32_bf16 v[64:67], a[144:147], a[124:127], v[64:67]
    v_rcp_f32 v58, v58
    v_mfma_f32_16x16x32_bf16 v[68:71], a[148:151], a[120:123], v[68:71]
    s_add_u32 m0, s50, 8192
    ds_read_b128 a[184:187], v2 offset:22528
    v_mul_f32 v121, v121, v57
    v_mfma_f32_16x16x32_bf16 v[72:75], a[148:151], a[124:127], v[72:75]
    buffer_load_dwordx4 v18, s[12:15], s63 offen offset:0 lds
    v_mfma_f32_16x16x32_bf16 v[76:79], a[152:155], a[120:123], v[76:79]
    ds_read_b128 a[188:191], v2 offset:23552
    v_mul_f32 v122, v122, v58
    v_mfma_f32_16x16x32_bf16 v[80:83], a[152:155], a[124:127], v[80:83]
    s_waitcnt vmcnt(23)
    v_fma_f32 v59, v59, v37, s49
    v_mul_f32 v152, v120, v152
    v_mfma_f32_16x16x32_bf16 v[84:87], a[156:159], a[120:123], v[84:87]
    s_barrier
    ds_read_b128 a[144:147], v2 offset:24576
    v_mul_f32 v59, v59, v123
    v_mfma_f32_16x16x32_bf16 v[88:91], a[156:159], a[124:127], v[88:91]
    v_exp_f32 v59, v59
    v_mfma_f32_16x16x32_bf16 v[60:63], a[160:163], a[128:131], v[60:63]
    ds_read_b128 a[148:151], v2 offset:25600
    v_mul_f32 v153, v121, v153
    v_mfma_f32_16x16x32_bf16 v[64:67], a[160:163], a[132:135], v[64:67]
    v_add_f32 v59, 1.0, v59
    v_mul_f32 v154, v122, v154
    v_mfma_f32_16x16x32_bf16 v[68:71], a[164:167], a[128:131], v[68:71]
    ds_read_b128 a[152:155], v2 offset:26624
    v_cvt_pk_bf16_f32 v226, v152, v153
    v_mfma_f32_16x16x32_bf16 v[72:75], a[164:167], a[132:135], v[72:75]
    s_waitcnt lgkmcnt(3)
    v_rcp_f32 v59, v59
    v_mfma_f32_16x16x32_bf16 v[76:79], a[168:171], a[128:131], v[76:79]
    ds_read_b128 a[156:159], v2 offset:27648
    v_mfma_f32_16x16x32_bf16 v[80:83], a[168:171], a[132:135], v[80:83]
    v_mul_f32 v123, v123, v59
    v_mfma_f32_16x16x32_bf16 v[84:87], a[172:175], a[128:131], v[84:87]
    ds_read_b128 a[160:163], v2 offset:28672
    v_mul_f32 v155, v123, v155
    v_mfma_f32_16x16x32_bf16 v[88:91], a[172:175], a[132:135], v[88:91]
    v_cvt_pk_bf16_f32 v227, v154, v155
    v_mfma_f32_16x16x32_bf16 v[92:95], a[176:179], a[136:139], v[60:63]
    ds_read_b128 a[164:167], v2 offset:29696
    v_mfma_f32_16x16x32_bf16 v[96:99], a[176:179], a[140:143], v[64:67]
    buffer_store_dwordx4 v[224:227], v38, s[40:43], s70 offen offset:3072 sc1
    v_mfma_f32_16x16x32_bf16 v[100:103], a[180:183], a[136:139], v[68:71]
    ds_read_b128 a[168:171], v2 offset:30720
    v_mfma_f32_16x16x32_bf16 v[104:107], a[180:183], a[140:143], v[72:75]
    v_mfma_f32_16x16x32_bf16 v[108:111], a[184:187], a[136:139], v[76:79]
    ds_read_b128 a[172:175], v2 offset:31744
    v_mfma_f32_16x16x32_bf16 v[112:115], a[184:187], a[140:143], v[80:83]
    v_mfma_f32_16x16x32_bf16 v[116:119], a[188:191], a[136:139], v[84:87]
    ds_read_b128 a[176:179], v2 offset:32768
    v_mfma_f32_16x16x32_bf16 v[120:123], a[188:191], a[140:143], v[88:91]
    s_waitcnt lgkmcnt(3)
L_main_p1m:
    v_mfma_f32_16x16x32_bf16 v[124:127], a[144:147], a[0:3], 0
L_pm_p1m:
    s_cbranch_execz L_wret
    ds_read_b128 a[180:183], v2 offset:33792
    v_mul_f32 v52, v92, v92
    v_mfma_f32_16x16x32_bf16 v[128:131], a[144:147], a[4:7], 0
    s_add_u32 s63, s63, 36864
    v_fma_f32 v52, v52, v37, s49
    v_mul_f32 v53, v93, v93
    v_mfma_f32_16x16x32_bf16 v[132:135], a[148:151], a[0:3], 0
    s_add_u32 m0, s50, 36864
    ds_read_b128 a[184:187], v2 offset:34816
    v_mul_f32 v52, v52, v92
    v_mfma_f32_16x16x32_bf16 v[136:139], a[148:151], a[4:7], 0
    buffer_load_dwordx4 v16, s[12:15], s63 offen offset:0 lds
    v_mfma_f32_16x16x32_bf16 v[140:143], a[152:155], a[0:3], 0
    ds_read_b128 a[188:191], v2 offset:35840
    v_fma_f32 v53, v53, v37, s49
    v_mfma_f32_16x16x32_bf16 v[144:147], a[152:155], a[4:7], 0
    v_exp_f32 v52, v52
    v_mfma_f32_16x16x32_bf16 v[148:151], a[156:159], a[0:3], 0
    ds_read_b128 a[144:147], v2 offset:36864
    v_mul_f32 v53, v53, v93
    v_mfma_f32_16x16x32_bf16 v[152:155], a[156:159], a[4:7], 0
    v_exp_f32 v53, v53
    v_mfma_f32_16x16x32_bf16 v[124:127], a[160:163], a[8:11], v[124:127]
    ds_read_b128 a[148:151], v2 offset:37888
    v_add_f32 v52, 1.0, v52
    v_mfma_f32_16x16x32_bf16 v[128:131], a[160:163], a[12:15], v[128:131]
    buffer_load_dwordx4 v16, s[12:15], s63 offen offset:1024 lds
    v_mfma_f32_16x16x32_bf16 v[132:135], a[164:167], a[8:11], v[132:135]
    ds_read_b128 a[152:155], v2 offset:38912
    v_add_f32 v53, 1.0, v53
    v_mfma_f32_16x16x32_bf16 v[136:139], a[164:167], a[12:15], v[136:139]
    s_waitcnt lgkmcnt(3)
    v_rcp_f32 v52, v52
    v_mfma_f32_16x16x32_bf16 v[140:143], a[168:171], a[8:11], v[140:143]
    ds_read_b128 a[156:159], v2 offset:39936
    v_mul_f32 v54, v94, v94
    v_mfma_f32_16x16x32_bf16 v[144:147], a[168:171], a[12:15], v[144:147]
    v_rcp_f32 v53, v53
    v_mfma_f32_16x16x32_bf16 v[148:151], a[172:175], a[8:11], v[148:151]
    ds_read_b128 a[160:163], v2 offset:40960
    v_mul_f32 v92, v92, v52
    v_mfma_f32_16x16x32_bf16 v[152:155], a[172:175], a[12:15], v[152:155]
    buffer_load_dwordx4 v16, s[12:15], s63 offen offset:2048 lds
    v_mfma_f32_16x16x32_bf16 v[124:127], a[176:179], a[16:19], v[124:127]
    ds_read_b128 a[164:167], v2 offset:41984
    v_mul_f32 v93, v93, v53
    v_mfma_f32_16x16x32_bf16 v[128:131], a[176:179], a[20:23], v[128:131]
    v_fma_f32 v54, v54, v37, s49
    v_mul_f32 v55, v95, v95
    v_mfma_f32_16x16x32_bf16 v[132:135], a[180:183], a[16:19], v[132:135]
    ds_read_b128 a[168:171], v2 offset:43008
    v_mul_f32 v54, v54, v94
    v_mfma_f32_16x16x32_bf16 v[136:139], a[180:183], a[20:23], v[136:139]
    v_exp_f32 v54, v54
    v_mfma_f32_16x16x32_bf16 v[140:143], a[184:187], a[16:19], v[140:143]
    ds_read_b128 a[172:175], v2 offset:44032
    v_fma_f32 v55, v55, v37, s49
    v_mfma_f32_16x16x32_bf16 v[144:147], a[184:187], a[20:23], v[144:147]
    buffer_load_dwordx4 v16, s[12:15], s63 offen offset:3072 lds
    v_mfma_f32_16x16x32_bf16 v[148:151], a[188:191], a[16:19], v[148:151]
    ds_read_b128 a[176:179], v2 offset:45056
    v_add_f32 v54, 1.0, v54
    v_mfma_f32_16x16x32_bf16 v[152:155], a[188:191], a[20:23], v[152:155]
    s_waitcnt lgkmcnt(3)
    v_rcp_f32 v54, v54
    v_mfma_f32_16x16x32_bf16 v[124:127], a[144:147], a[24:27], v[124:127]
    ds_read_b128 a[180:183], v2 offset:46080
    v_mul_f32 v55, v55, v95
    v_mfma_f32_16x16x32_bf16 v[128:131], a[144:147], a[28:31], v[128:131]
    v_exp_f32 v55, v55
    v_mfma_f32_16x16x32_bf16 v[132:135], a[148:151], a[24:27], v[132:135]
    s_add_u32 m0, s50, 40960
    ds_read_b128 a[184:187], v2 offset:47104
    v_mul_f32 v94, v94, v54
    v_mfma_f32_16x16x32_bf16 v[136:139], a[148:151], a[28:31], v[136:139]
    buffer_load_dwordx4 v17, s[12:15], s63 offen offset:0 lds
    v_mfma_f32_16x16x32_bf16 v[140:143], a[152:155], a[24:27], v[140:143]
    ds_read_b128 a[188:191], v2 offset:48128
    v_add_f32 v55, 1.0, v55
    v_mfma_f32_16x16x32_bf16 v[144:147], a[152:155], a[28:31], v[144:147]
    v_rcp_f32 v55, v55
    v_mfma_f32_16x16x32_bf16 v[148:151], a[156:159], a[24:27], v[148:151]
    ds_read_b128 a[144:147], v3 offset:0
    v_mul_f32 v56, v96, v96
    v_mfma_f32_16x16x32_bf16 v[152:155], a[156:159], a[28:31], v[152:155]
    v_mul_f32 v95, v95, v55
    v_fma_f32 v56, v56, v37, s49
    v_mfma_f32_16x16x32_bf16 v[124:127], a[160:163], a[32:35], v[124:127]
    ds_read_b128 a[148:151], v3 offset:1024
    v_mul_f32 v56, v56, v96
    v_mfma_f32_16x16x32_bf16 v[128:131], a[160:163], a[36:39], v[128:131]
    buffer_load_dwordx4 v17, s[12:15], s63 offen offset:1024 lds
    v_mfma_f32_16x16x32_bf16 v[132:135], a[164:167], a[32:35], v[132:135]
    ds_read_b128 a[152:155], v3 offset:2048
    v_mul_f32 v57, v97, v97
    v_mfma_f32_16x16x32_bf16 v[136:139], a[164:167], a[36:39], v[136:139]
    s_waitcnt lgkmcnt(3)
    v_exp_f32 v56, v56
    v_mfma_f32_16x16x32_bf16 v[140:143], a[168:171], a[32:35], v[140:143]
    ds_read_b128 a[156:159], v3 offset:3072
    v_fma_f32 v57, v57, v37, s49
    v_mfma_f32_16x16x32_bf16 v[144:147], a[168:171], a[36:39], v[144:147]
    v_add_f32 v56, 1.0, v56
    v_mul_f32 v57, v57, v97
    v_mfma_f32_16x16x32_bf16 v[148:151], a[172:175], a[32:35], v[148:151]
    ds_read_b128 a[160:163], v3 offset:4096
    v_mul_f32 v58, v98, v98
    v_mfma_f32_16x16x32_bf16 v[152:155], a[172:175], a[36:39], v[152:155]
    buffer_load_dwordx4 v17, s[12:15], s63 offen offset:2048 lds
    v_mfma_f32_16x16x32_bf16 v[124:127], a[176:179], a[40:43], v[124:127]
    ds_read_b128 a[164:167], v3 offset:5120
    v_fma_f32 v58, v58, v37, s49
    v_mfma_f32_16x16x32_bf16 v[128:131], a[176:179], a[44:47], v[128:131]
    v_rcp_f32 v56, v56
    v_mfma_f32_16x16x32_bf16 v[132:135], a[180:183], a[40:43], v[132:135]
    ds_read_b128 a[168:171], v3 offset:6144
    v_mul_f32 v58, v58, v98
    v_mfma_f32_16x16x32_bf16 v[136:139], a[180:183], a[44:47], v[136:139]
    v_exp_f32 v57, v57
    v_mfma_f32_16x16x32_bf16 v[140:143], a[184:187], a[40:43], v[140:143]
    ds_read_b128 a[172:175], v3 offset:7168
    v_mul_f32 v96, v96, v56
    v_mfma_f32_16x16x32_bf16 v[144:147], a[184:187], a[44:47], v[144:147]
    buffer_load_dwordx4 v17, s[12:15], s63 offen offset:3072 lds
    v_mfma_f32_16x16x32_bf16 v[148:151], a[188:191], a[40:43], v[148:151]
    ds_read_b128 a[176:179], v3 offset:8192
    v_add_f32 v57, 1.0, v57
    v_mfma_f32_16x16x32_bf16 v[152:155], a[188:191], a[44:47], v[152:155]
    s_waitcnt lgkmcnt(3)
    v_rcp_f32 v57, v57
    v_mfma_f32_16x16x32_bf16 v[124:127], a[144:147], a[48:51], v[124:127]
    ds_read_b128 a[180:183], v3 offset:9216
    v_mul_f32 v59, v99, v99
    v_mfma_f32_16x16x32_bf16 v[128:131], a[144:147], a[52:55], v[128:131]
    v_exp_f32 v58, v58
    v_mfma_f32_16x16x32_bf16 v[132:135], a[148:151], a[48:51], v[132:135]
    s_add_u32 m0, s50, 45056
    ds_read_b128 a[184:187], v3 offset:10240
    v_mul_f32 v97, v97, v57
    v_mfma_f32_16x16x32_bf16 v[136:139], a[148:151], a[52:55], v[136:139]
    buffer_load_dwordx4 v18, s[12:15], s63 offen offset:0 lds
    v_mfma_f32_16x16x32_bf16 v[140:143], a[152:155], a[48:51], v[140:143]
    ds_read_b128 a[188:191], v3 offset:11264
    v_add_f32 v58, 1.0, v58
    v_mfma_f32_16x16x32_bf16 v[144:147], a[152:155], a[52:55], v[144:147]
    s_waitcnt vmcnt(20)
    v_rcp_f32 v58, v58
    v_mfma_f32_16x16x32_bf16 v[148:151], a[156:159], a[48:51], v[148:151]
    s_barrier
    ds_read_b128 a[144:147], v3 offset:12288
    v_fma_f32 v59, v59, v37, s49
    v_mfma_f32_16x16x32_bf16 v[152:155], a[156:159], a[52:55], v[152:155]
    v_mul_f32 v98, v98, v58
    v_mul_f32 v59, v59, v99
    v_mfma_f32_16x16x32_bf16 v[124:127], a[160:163], a[56:59], v[124:127]
    ds_read_b128 a[148:151], v3 offset:13312
    v_mul_f32 v19, v100, v100
    v_mfma_f32_16x16x32_bf16 v[128:131], a[160:163], a[60:63], v[128:131]
    v_exp_f32 v59, v59
    v_mfma_f32_16x16x32_bf16 v[132:135], a[164:167], a[56:59], v[132:135]
    ds_read_b128 a[152:155], v3 offset:14336
    v_cmp_ne_u64 vcc, s[98:99], v[14:15]
    v_mfma_f32_16x16x32_bf16 v[136:139], a[164:167], a[60:63], v[136:139]
    s_waitcnt lgkmcnt(3)
    v_add_f32 v59, 1.0, v59
    v_fma_f32 v19, v19, v37, s49
    v_mfma_f32_16x16x32_bf16 v[140:143], a[168:171], a[56:59], v[140:143]
    s_cbranch_vccnz L_fw_slow
L_fw_back:
    ds_read_b128 a[156:159], v3 offset:15360
    v_mul_f32 v19, v19, v100
    v_mfma_f32_16x16x32_bf16 v[144:147], a[168:171], a[60:63], v[144:147]
    v_rcp_f32 v59, v59
    v_mfma_f32_16x16x32_bf16 v[148:151], a[172:175], a[56:59], v[148:151]
    ds_read_b128 a[160:163], v3 offset:16384
    v_mul_f32 v20, v101, v101
    v_mfma_f32_16x16x32_bf16 v[152:155], a[172:175], a[60:63], v[152:155]
    v_exp_f32 v19, v19
    v_mfma_f32_16x16x32_bf16 v[124:127], a[176:179], a[64:67], v[124:127]
    ds_read_b128 a[164:167], v3 offset:17408
    v_mul_f32 v99, v99, v59
    v_mfma_f32_16x16x32_bf16 v[128:131], a[176:179], a[68:71], v[128:131]
    v_add_f32 v19, 1.0, v19
    v_fma_f32 v20, v20, v37, s49
    v_mfma_f32_16x16x32_bf16 v[132:135], a[180:183], a[64:67], v[132:135]
    ds_read_b128 a[168:171], v3 offset:18432
    v_mul_f32 v20, v20, v101
    v_mfma_f32_16x16x32_bf16 v[136:139], a[180:183], a[68:71], v[136:139]
    v_rcp_f32 v19, v19
    v_mfma_f32_16x16x32_bf16 v[140:143], a[184:187], a[64:67], v[140:143]
    ds_read_b128 a[172:175], v3 offset:19456
    v_mul_f32 v21, v102, v102
    v_mfma_f32_16x16x32_bf16 v[144:147], a[184:187], a[68:71], v[144:147]
    v_exp_f32 v20, v20
    v_mfma_f32_16x16x32_bf16 v[148:151], a[188:191], a[64:67], v[148:151]
    ds_read_b128 a[176:179], v3 offset:20480
    v_mul_f32 v100, v100, v19
    v_mfma_f32_16x16x32_bf16 v[152:155], a[188:191], a[68:71], v[152:155]
    s_waitcnt lgkmcnt(3)
    v_add_f32 v20, 1.0, v20
    v_fma_f32 v21, v21, v37, s49
    v_mfma_f32_16x16x32_bf16 v[124:127], a[144:147], a[72:75], v[124:127]
    ds_read_b128 a[180:183], v3 offset:21504
    v_mul_f32 v21, v21, v102
    v_mfma_f32_16x16x32_bf16 v[128:131], a[144:147], a[76:79], v[128:131]
    s_add_u32 s63, s63, 36864
    v_rcp_f32 v20, v20
    v_mfma_f32_16x16x32_bf16 v[132:135], a[148:151], a[72:75], v[132:135]
    s_add_u32 m0, s50, 73728
    ds_read_b128 a[184:187], v3 offset:22528
    v_mul_f32 v22, v103, v103
    v_mfma_f32_16x16x32_bf16 v[136:139], a[148:151], a[76:79], v[136:139]
    buffer_load_dwordx4 v16, s[12:15], s63 offen offset:0 lds
    v_mfma_f32_16x16x32_bf16 v[140:143], a[152:155], a[72:75], v[140:143]
    ds_read_b128 a[188:191], v3 offset:23552
    v_mul_f32 v101, v101, v20
    v_mfma_f32_16x16x32_bf16 v[144:147], a[152:155], a[76:79], v[144:147]
    v_exp_f32 v21, v21
    v_mfma_f32_16x16x32_bf16 v[148:151], a[156:159], a[72:75], v[148:151]
    ds_read_b128 a[144:147], v3 offset:24576
    v_fma_f32 v22, v22, v37, s49
    v_mfma_f32_16x16x32_bf16 v[152:155], a[156:159], a[76:79], v[152:155]
    v_add_f32 v21, 1.0, v21
    v_mul_f32 v22, v22, v103
    v_mfma_f32_16x16x32_bf16 v[124:127], a[160:163], a[80:83], v[124:127]
    ds_read_b128 a[148:151], v3 offset:25600
    v_mul_f32 v52, v104, v104
    v_mfma_f32_16x16x32_bf16 v[128:131], a[160:163], a[84:87], v[128:131]
    buffer_load_dwordx4 v16, s[12:15], s63 offen offset:1024 lds
    v_mfma_f32_16x16x32_bf16 v[132:135], a[164:167], a[80:83], v[132:135]
L_pg_main2:
    s_cbranch_execz L_wret
    ds_read_b128 a[152:155], v3 offset:26624
    v_fma_f32 v52, v52, v37, s49
    v_mfma_f32_16x16x32_bf16 v[136:139], a[164:167], a[84:87], v[136:139]
    s_waitcnt lgkmcnt(3)
    v_rcp_f32 v21, v21
    v_mfma_f32_16x16x32_bf16 v[140:143], a[168:171], a[80:83], v[140:143]
    ds_read_b128 a[156:159], v3 offset:27648
    v_mul_f32 v52, v52, v104
    v_mfma_f32_16x16x32_bf16 v[144:147], a[168:171], a[84:87], v[144:147]
    v_exp_f32 v22, v22
    v_mfma_f32_16x16x32_bf16 v[148:151], a[172:175], a[80:83], v[148:151]
    ds_read_b128 a[160:163], v3 offset:28672
    v_mul_f32 v102, v102, v21
    v_mfma_f32_16x16x32_bf16 v[152:155], a[172:175], a[84:87], v[152:155]
    buffer_load_dwordx4 v16, s[12:15], s63 offen offset:2048 lds
    v_mfma_f32_16x16x32_bf16 v[124:127], a[176:179], a[88:91], v[124:127]
    ds_read_b128 a[164:167], v3 offset:29696
    v_add_f32 v22, 1.0, v22
    v_mfma_f32_16x16x32_bf16 v[128:131], a[176:179], a[92:95], v[128:131]
    v_rcp_f32 v22, v22
    v_mfma_f32_16x16x32_bf16 v[132:135], a[180:183], a[88:91], v[132:135]
    ds_read_b128 a[168:171], v3 offset:30720
    v_mul_f32 v53, v105, v105
    v_mfma_f32_16x16x32_bf16 v[136:139], a[180:183], a[92:95], v[136:139]
    v_exp_f32 v52, v52
    v_mfma_f32_16x16x32_bf16 v[140:143], a[184:187], a[88:91], v[140:143]
    ds_read_b128 a[172:175], v3 offset:31744
    v_mul_f32 v103, v103, v22
    v_mfma_f32_16x16x32_bf16 v[144:147], a[184:187], a[92:95], v[144:147]
    buffer_load_dwordx4 v16, s[12:15], s63 offen offset:3072 lds
    v_mfma_f32_16x16x32_bf16 v[148:151], a[188:191], a[88:91], v[148:151]
    ds_read_b128 a[176:179], v3 offset:32768
    v_add_f32 v52, 1.0, v52
    v_mfma_f32_16x16x32_bf16 v[152:155], a[188:191], a[92:95], v[152:155]
    s_waitcnt lgkmcnt(3)
    v_rcp_f32 v52, v52
    v_mfma_f32_16x16x32_bf16 v[124:127], a[144:147], a[96:99], v[124:127]
    ds_read_b128 a[180:183], v3 offset:33792
    v_fma_f32 v53, v53, v37, s49
    v_mfma_f32_16x16x32_bf16 v[128:131], a[144:147], a[100:103], v[128:131]
    v_mul_f32 v104, v104, v52
    v_mul_f32 v53, v53, v105
    v_mfma_f32_16x16x32_bf16 v[132:135], a[148:151], a[96:99], v[132:135]
    s_add_u32 m0, s50, 77824
    ds_read_b128 a[184:187], v3 offset:34816
    v_mul_f32 v54, v106, v106
    v_mfma_f32_16x16x32_bf16 v[136:139], a[148:151], a[100:103], v[136:139]
    buffer_load_dwordx4 v17, s[12:15], s63 offen offset:0 lds
    v_mfma_f32_16x16x32_bf16 v[140:143], a[152:155], a[96:99], v[140:143]
    ds_read_b128 a[188:191], v3 offset:35840
    v_fma_f32 v54, v54, v37, s49
    v_mfma_f32_16x16x32_bf16 v[144:147], a[152:155], a[100:103], v[144:147]
    v_exp_f32 v53, v53
    v_mfma_f32_16x16x32_bf16 v[148:151], a[156:159], a[96:99], v[148:151]
    ds_read_b128 a[144:147], v3 offset:36864
    v_mul_f32 v54, v54, v106
    v_mfma_f32_16x16x32_bf16 v[152:155], a[156:159], a[100:103], v[152:155]
    v_exp_f32 v54, v54
    v_mfma_f32_16x16x32_bf16 v[124:127], a[160:163], a[104:107], v[124:127]
    ds_read_b128 a[148:151], v3 offset:37888
    v_add_f32 v53, 1.0, v53
    v_mfma_f32_16x16x32_bf16 v[128:131], a[160:163], a[108:111], v[128:131]
    buffer_load_dwordx4 v17, s[12:15], s63 offen offset:1024 lds
    v_mfma_f32_16x16x32_bf16 v[132:135], a[164:167], a[104:107], v[132:135]
    ds_read_b128 a[152:155], v3 offset:38912
    v_add_f32 v54, 1.0, v54
    v_mfma_f32_16x16x32_bf16 v[136:139], a[164:167], a[108:111], v[136:139]
    s_waitcnt lgkmcnt(3)
    v_rcp_f32 v53, v53
    v_mfma_f32_16x16x32_bf16 v[140:143], a[168:171], a[104:107], v[140:143]
    ds_read_b128 a[156:159], v3 offset:39936
    v_mul_f32 v55, v107, v107
    v_mfma_f32_16x16x32_bf16 v[144:147], a[168:171], a[108:111], v[144:147]
    v_rcp_f32 v54, v54
    v_mfma_f32_16x16x32_bf16 v[148:151], a[172:175], a[104:107], v[148:151]
    ds_read_b128 a[160:163], v3 offset:40960
    v_mul_f32 v105, v105, v53
    v_mfma_f32_16x16x32_bf16 v[152:155], a[172:175], a[108:111], v[152:155]
    buffer_load_dwordx4 v17, s[12:15], s63 offen offset:2048 lds
    v_mfma_f32_16x16x32_bf16 v[124:127], a[176:179], a[112:115], v[124:127]
    ds_read_b128 a[164:167], v3 offset:41984
    v_mul_f32 v106, v106, v54
    v_mfma_f32_16x16x32_bf16 v[128:131], a[176:179], a[116:119], v[128:131]
    v_fma_f32 v55, v55, v37, s49
    v_mul_f32 v56, v108, v108
    v_mfma_f32_16x16x32_bf16 v[132:135], a[180:183], a[112:115], v[132:135]
    ds_read_b128 a[168:171], v3 offset:43008
    v_mul_f32 v55, v55, v107
    v_mfma_f32_16x16x32_bf16 v[136:139], a[180:183], a[116:119], v[136:139]
    v_exp_f32 v55, v55
    v_mfma_f32_16x16x32_bf16 v[140:143], a[184:187], a[112:115], v[140:143]
    ds_read_b128 a[172:175], v3 offset:44032
    v_fma_f32 v56, v56, v37, s49
    v_mfma_f32_16x16x32_bf16 v[144:147], a[184:187], a[116:119], v[144:147]
    buffer_load_dwordx4 v17, s[12:15], s63 offen offset:3072 lds
    v_mfma_f32_16x16x32_bf16 v[148:151], a[188:191], a[112:115], v[148:151]
    ds_read_b128 a[176:179], v3 offset:45056
    v_add_f32 v55, 1.0, v55
    v_mfma_f32_16x16x32_bf16 v[152:155], a[188:191], a[116:119], v[152:155]
    s_waitcnt lgkmcnt(3)
    v_rcp_f32 v55, v55
    v_mfma_f32_16x16x32_bf16 v[124:127], a[144:147], a[120:123], v[124:127]
    ds_read_b128 a[180:183], v3 offset:46080
    v_mul_f32 v56, v56, v108
    v_mfma_f32_16x16x32_bf16 v[128:131], a[144:147], a[124:127], v[128:131]
    v_exp_f32 v56, v56
    v_mfma_f32_16x16x32_bf16 v[132:135], a[148:151], a[120:123], v[132:135]
    s_add_u32 m0, s50, 81920
    ds_read_b128 a[184:187], v3 offset:47104
    v_mul_f32 v107, v107, v55
    v_mfma_f32_16x16x32_bf16 v[136:139], a[148:151], a[124:127], v[136:139]
    buffer_load_dwordx4 v18, s[12:15], s63 offen offset:0 lds
    v_mfma_f32_16x16x32_bf16 v[140:143], a[152:155], a[120:123], v[140:143]
    ds_read_b128 a[188:191], v3 offset:48128
    v_add_f32 v56, 1.0, v56
    v_mfma_f32_16x16x32_bf16 v[144:147], a[152:155], a[124:127], v[144:147]
    s_waitcnt vmcnt(18)
    v_rcp_f32 v56, v56
    v_mfma_f32_16x16x32_bf16 v[148:151], a[156:159], a[120:123], v[148:151]
    s_barrier
    ds_read_b128 a[144:147], v1 offset:0
    v_mul_f32 v57, v109, v109
    v_mfma_f32_16x16x32_bf16 v[152:155], a[156:159], a[124:127], v[152:155]
    v_mul_f32 v108, v108, v56
    v_fma_f32 v57, v57, v37, s49
    v_mfma_f32_16x16x32_bf16 v[124:127], a[160:163], a[128:131], v[124:127]
    ds_read_b128 a[148:151], v1 offset:1024
    v_mul_f32 v57, v57, v109
    v_mfma_f32_16x16x32_bf16 v[128:131], a[160:163], a[132:135], v[128:131]
    buffer_store_dwordx2 v[10:11], v12, s[32:35], s23 offen sc1
    v_mul_f32 v58, v110, v110
    v_mfma_f32_16x16x32_bf16 v[132:135], a[164:167], a[128:131], v[132:135]
    ds_read_b128 a[152:155], v1 offset:2048
    v_fma_f32 v58, v58, v37, s49
    v_mfma_f32_16x16x32_bf16 v[136:139], a[164:167], a[132:135], v[136:139]
    s_waitcnt lgkmcnt(3)
    v_exp_f32 v57, v57
    v_mfma_f32_16x16x32_bf16 v[140:143], a[168:171], a[128:131], v[140:143]
    s_mov_b32 s23, 2130706432
    ds_read_b128 a[156:159], v1 offset:3072
    v_mul_f32 v58, v58, v110
    v_mfma_f32_16x16x32_bf16 v[144:147], a[168:171], a[132:135], v[144:147]
    v_exp_f32 v58, v58
    v_mfma_f32_16x16x32_bf16 v[148:151], a[172:175], a[128:131], v[148:151]
    ds_read_b128 a[160:163], v1 offset:4096
    v_add_f32 v57, 1.0, v57
    v_mfma_f32_16x16x32_bf16 v[152:155], a[172:175], a[132:135], v[152:155]
    s_add_u32 s70, s70, 4096
    v_rcp_f32 v57, v57
    v_mfma_f32_16x16x32_bf16 v[124:127], a[176:179], a[136:139], v[124:127]
    ds_read_b128 a[164:167], v1 offset:5120
    v_add_f32 v58, 1.0, v58
    v_mfma_f32_16x16x32_bf16 v[128:131], a[176:179], a[140:143], v[128:131]
    v_rcp_f32 v58, v58
    v_mfma_f32_16x16x32_bf16 v[132:135], a[180:183], a[136:139], v[132:135]
    ds_read_b128 a[168:171], v1 offset:6144
    v_mul_f32 v109, v109, v57
    v_mfma_f32_16x16x32_bf16 v[136:139], a[180:183], a[140:143], v[136:139]
    v_mul_f32 v110, v110, v58
    v_mul_f32 v59, v111, v111
    v_mfma_f32_16x16x32_bf16 v[140:143], a[184:187], a[136:139], v[140:143]
    s_add_u32 s53, s53, 1
    ds_read_b128 a[172:175], v1 offset:7168
    v_fma_f32 v59, v59, v37, s49
    v_mfma_f32_16x16x32_bf16 v[144:147], a[184:187], a[140:143], v[144:147]
    s_cmp_lt_u32 s53, 4
    v_mul_f32 v59, v59, v111
    v_mul_f32 v19, v112, v112
    v_mfma_f32_16x16x32_bf16 v[148:151], a[188:191], a[136:139], v[148:151]
    ds_read_b128 a[176:179], v1 offset:8192
    v_fma_f32 v19, v19, v37, s49
    v_mfma_f32_16x16x32_bf16 v[152:155], a[188:191], a[140:143], v[152:155]
    s_waitcnt lgkmcnt(3)
    s_cbranch_scc1 L_main_p1
    v_mfma_f32_16x16x32_bf16 v[60:63], a[144:147], a[0:3], 0
    s_add_u32 s55, s67, 5
    ds_read_b128 a[180:183], v1 offset:9216
    v_exp_f32 v59, v59
    v_mfma_f32_16x16x32_bf16 v[64:67], a[144:147], a[4:7], 0
    v_mov_b32 v42, s55
    v_mul_f32 v124, v92, v124
    v_mfma_f32_16x16x32_bf16 v[68:71], a[148:151], a[0:3], 0
    s_sub_u32 s53, s70, 12288
    ds_read_b128 a[184:187], v1 offset:10240
    v_mul_f32 v125, v93, v125
    v_mfma_f32_16x16x32_bf16 v[72:75], a[148:151], a[4:7], 0
    buffer_store_dword v42, v40, s[32:35], 0 offen sc1
    v_mul_f32 v126, v94, v126
    v_mfma_f32_16x16x32_bf16 v[60:63], a[152:155], a[72:75], v[60:63]
    ds_read_b128 a[188:191], v1 offset:11264
    v_mul_f32 v127, v95, v127
    v_mfma_f32_16x16x32_bf16 v[64:67], a[152:155], a[76:79], v[64:67]
    s_add_u32 s63, s63, 36864
    v_cvt_pk_bf16_f32 v212, v124, v125
    v_cvt_pk_bf16_f32 v213, v126, v127
    v_mfma_f32_16x16x32_bf16 v[68:71], a[156:159], a[72:75], v[68:71]
    s_add_u32 m0, s50, 110592
    ds_read_b128 a[144:147], v1 offset:12288
    v_mul_f32 v128, v96, v128
    v_mul_f32 v129, v97, v129
    v_mfma_f32_16x16x32_bf16 v[72:75], a[156:159], a[76:79], v[72:75]
    buffer_load_dwordx4 v16, s[12:15], s63 offen offset:0 lds
    v_mfma_f32_16x16x32_bf16 v[60:63], a[160:163], a[8:11], v[60:63]
    ds_read_b128 a[148:151], v1 offset:13312
    v_mul_f32 v130, v98, v130
    v_mfma_f32_16x16x32_bf16 v[64:67], a[160:163], a[12:15], v[64:67]
    v_mul_f32 v131, v99, v131
    v_cvt_pk_bf16_f32 v216, v128, v129
    v_mfma_f32_16x16x32_bf16 v[68:71], a[164:167], a[8:11], v[68:71]
    ds_read_b128 a[152:155], v1 offset:14336
    v_cvt_pk_bf16_f32 v217, v130, v131
    v_mfma_f32_16x16x32_bf16 v[72:75], a[164:167], a[12:15], v[72:75]
    s_waitcnt lgkmcnt(3)
    v_mul_f32 v132, v100, v132
    v_mul_f32 v133, v101, v133
    v_mfma_f32_16x16x32_bf16 v[60:63], a[168:171], a[80:83], v[60:63]
    ds_read_b128 a[156:159], v1 offset:15360
    v_mul_f32 v134, v102, v134
    v_mul_f32 v135, v103, v135
    v_mfma_f32_16x16x32_bf16 v[64:67], a[168:171], a[84:87], v[64:67]
    buffer_load_dwordx4 v16, s[12:15], s63 offen offset:1024 lds
    v_mfma_f32_16x16x32_bf16 v[68:71], a[172:175], a[80:83], v[68:71]
    ds_read_b128 a[160:163], v1 offset:16384
    v_cvt_pk_bf16_f32 v214, v132, v133
    v_mfma_f32_16x16x32_bf16 v[72:75], a[172:175], a[84:87], v[72:75]
    v_cvt_pk_bf16_f32 v215, v134, v135
    v_mul_f32 v136, v104, v136
    v_mfma_f32_16x16x32_bf16 v[60:63], a[176:179], a[16:19], v[60:63]
    ds_read_b128 a[164:167], v1 offset:17408
    v_mul_f32 v137, v105, v137
    v_mfma_f32_16x16x32_bf16 v[64:67], a[176:179], a[20:23], v[64:67]
    buffer_load_dwordx4 v16, s[12:15], s63 offen offset:2048 lds
    v_mfma_f32_16x16x32_bf16 v[68:71], a[180:183], a[16:19], v[68:71]
    ds_read_b128 a[168:171], v1 offset:18432
    v_mul_f32 v138, v106, v138
    v_mul_f32 v139, v107, v139
    v_mfma_f32_16x16x32_bf16 v[72:75], a[180:183], a[20:23], v[72:75]
    buffer_store_dwordx4 v[212:215], v38, s[40:43], s70 offen offset:0 sc1
    v_cvt_pk_bf16_f32 v218, v136, v137
    v_mfma_f32_16x16x32_bf16 v[60:63], a[184:187], a[88:91], v[60:63]
    ds_read_b128 a[172:175], v1 offset:19456
    v_cvt_pk_bf16_f32 v219, v138, v139
    v_mfma_f32_16x16x32_bf16 v[64:67], a[184:187], a[92:95], v[64:67]
    buffer_store_dwordx4 v[216:219], v38, s[40:43], s70 offen offset:1024 sc1
    v_add_f32 v59, 1.0, v59
    v_mfma_f32_16x16x32_bf16 v[68:71], a[188:191], a[88:91], v[68:71]
    ds_read_b128 a[176:179], v1 offset:20480
    v_mul_f32 v140, v108, v140
    v_mfma_f32_16x16x32_bf16 v[72:75], a[188:191], a[92:95], v[72:75]
    s_waitcnt lgkmcnt(3)
    buffer_load_dwordx4 v16, s[12:15], s63 offen offset:3072 lds
    v_mfma_f32_16x16x32_bf16 v[60:63], a[144:147], a[24:27], v[60:63]
    ds_read_b128 a[180:183], v1 offset:21504
    v_rcp_f32 v59, v59
    v_mfma_f32_16x16x32_bf16 v[64:67], a[144:147], a[28:31], v[64:67]
    v_mul_f32 v141, v109, v141
    v_mul_f32 v142, v110, v142
    v_mfma_f32_16x16x32_bf16 v[68:71], a[148:151], a[24:27], v[68:71]
    s_add_u32 m0, s50, 114688
    ds_read_b128 a[184:187], v1 offset:22528
    v_mul_f32 v111, v111, v59
    v_mfma_f32_16x16x32_bf16 v[72:75], a[148:151], a[28:31], v[72:75]
    buffer_load_dwordx4 v17, s[12:15], s63 offen offset:0 lds
    v_mfma_f32_16x16x32_bf16 v[60:63], a[152:155], a[96:99], v[60:63]
    ds_read_b128 a[188:191], v1 offset:23552
    v_mul_f32 v143, v111, v143
    v_mfma_f32_16x16x32_bf16 v[64:67], a[152:155], a[100:103], v[64:67]
    v_cvt_pk_bf16_f32 v220, v140, v141
    v_cvt_pk_bf16_f32 v221, v142, v143
    v_mfma_f32_16x16x32_bf16 v[68:71], a[156:159], a[96:99], v[68:71]
    ds_read_b128 a[144:147], v1 offset:24576
    v_mul_f32 v19, v19, v112
    v_mul_f32 v52, v113, v113
    v_mfma_f32_16x16x32_bf16 v[72:75], a[156:159], a[100:103], v[72:75]
    v_exp_f32 v19, v19
    v_mfma_f32_16x16x32_bf16 v[60:63], a[160:163], a[32:35], v[60:63]
    ds_read_b128 a[148:151], v1 offset:25600
    v_fma_f32 v52, v52, v37, s49
    v_mfma_f32_16x16x32_bf16 v[64:67], a[160:163], a[36:39], v[64:67]
    buffer_load_dwordx4 v17, s[12:15], s63 offen offset:1024 lds
    v_mfma_f32_16x16x32_bf16 v[68:71], a[164:167], a[32:35], v[68:71]
    ds_read_b128 a[152:155], v1 offset:26624
    v_add_f32 v19, 1.0, v19
    v_mfma_f32_16x16x32_bf16 v[72:75], a[164:167], a[36:39], v[72:75]
    s_waitcnt lgkmcnt(3)
    v_rcp_f32 v19, v19
    v_mfma_f32_16x16x32_bf16 v[60:63], a[168:171], a[104:107], v[60:63]
    ds_read_b128 a[156:159], v1 offset:27648
    v_mul_f32 v52, v52, v113
    v_mul_f32 v53, v114, v114
    v_mfma_f32_16x16x32_bf16 v[64:67], a[168:171], a[108:111], v[64:67]
    v_exp_f32 v52, v52
    v_mfma_f32_16x16x32_bf16 v[68:71], a[172:175], a[104:107], v[68:71]
    ds_read_b128 a[160:163], v1 offset:28672
    v_mul_f32 v112, v112, v19
    v_mfma_f32_16x16x32_bf16 v[72:75], a[172:175], a[108:111], v[72:75]
    buffer_load_dwordx4 v17, s[12:15], s63 offen offset:2048 lds
    v_mfma_f32_16x16x32_bf16 v[60:63], a[176:179], a[40:43], v[60:63]
    ds_read_b128 a[164:167], v1 offset:29696
    v_add_f32 v52, 1.0, v52
    v_mfma_f32_16x16x32_bf16 v[64:67], a[176:179], a[44:47], v[64:67]
    v_rcp_f32 v52, v52
    v_mfma_f32_16x16x32_bf16 v[68:71], a[180:183], a[40:43], v[68:71]
    ds_read_b128 a[168:171], v1 offset:30720
    v_fma_f32 v53, v53, v37, s49
    v_mul_f32 v54, v115, v115
    v_mfma_f32_16x16x32_bf16 v[72:75], a[180:183], a[44:47], v[72:75]
    v_mul_f32 v113, v113, v52
    v_mul_f32 v53, v53, v114
    v_mfma_f32_16x16x32_bf16 v[60:63], a[184:187], a[112:115], v[60:63]
    ds_read_b128 a[172:175], v1 offset:31744
    v_fma_f32 v54, v54, v37, s49
    v_mfma_f32_16x16x32_bf16 v[64:67], a[184:187], a[116:119], v[64:67]
    buffer_load_dwordx4 v17, s[12:15], s63 offen offset:3072 lds
    v_mfma_f32_16x16x32_bf16 v[68:71], a[188:191], a[112:115], v[68:71]
    ds_read_b128 a[176:179], v1 offset:32768
    v_mul_f32 v54, v54, v115
    v_mfma_f32_16x16x32_bf16 v[72:75], a[188:191], a[116:119], v[72:75]
    s_waitcnt lgkmcnt(3)
    v_exp_f32 v53, v53
    v_mfma_f32_16x16x32_bf16 v[60:63], a[144:147], a[48:51], v[60:63]
    ds_read_b128 a[180:183], v1 offset:33792
    v_exp_f32 v54, v54
    v_mfma_f32_16x16x32_bf16 v[64:67], a[144:147], a[52:55], v[64:67]
    v_add_f32 v53, 1.0, v53
    v_mul_f32 v144, v112, v144
    v_mfma_f32_16x16x32_bf16 v[68:71], a[148:151], a[48:51], v[68:71]
    s_add_u32 m0, s50, 118784
    ds_read_b128 a[184:187], v1 offset:34816
    v_add_f32 v54, 1.0, v54
    v_mfma_f32_16x16x32_bf16 v[72:75], a[148:151], a[52:55], v[72:75]
    buffer_load_dwordx4 v18, s[12:15], s63 offen offset:0 lds
    v_mfma_f32_16x16x32_bf16 v[60:63], a[152:155], a[120:123], v[60:63]
    s_add_u32 s64, s53, 0
    ds_read_b128 a[188:191], v1 offset:35840
    v_mul_f32 v145, v113, v145
    v_mfma_f32_16x16x32_bf16 v[64:67], a[152:155], a[124:127], v[64:67]
    s_waitcnt vmcnt(22)
    buffer_load_dwordx4 v[164:167], v38, s[40:43], s64 offen offset:0 sc1
    v_mfma_f32_16x16x32_bf16 v[68:71], a[156:159], a[120:123], v[68:71]
    s_barrier
    ds_read_b128 a[144:147], v1 offset:36864
    v_rcp_f32 v53, v53
    v_mfma_f32_16x16x32_bf16 v[72:75], a[156:159], a[124:127], v[72:75]
    v_rcp_f32 v54, v54
    v_mfma_f32_16x16x32_bf16 v[60:63], a[160:163], a[56:59], v[60:63]
    ds_read_b128 a[148:151], v1 offset:37888
    v_mul_f32 v114, v114, v53
    v_mfma_f32_16x16x32_bf16 v[64:67], a[160:163], a[60:63], v[64:67]
    v_mul_f32 v115, v115, v54
    v_mul_f32 v146, v114, v146
    v_mfma_f32_16x16x32_bf16 v[68:71], a[164:167], a[56:59], v[68:71]
    ds_read_b128 a[152:155], v1 offset:38912
    v_mul_f32 v147, v115, v147
    v_mfma_f32_16x16x32_bf16 v[72:75], a[164:167], a[60:63], v[72:75]
    s_waitcnt lgkmcnt(3)
    buffer_load_dwordx4 v[168:171], v38, s[40:43], s64 offen offset:1024 sc1
    v_mfma_f32_16x16x32_bf16 v[60:63], a[168:171], a[128:131], v[60:63]
    ds_read_b128 a[156:159], v1 offset:39936
    v_cvt_pk_bf16_f32 v224, v144, v145
    v_cvt_pk_bf16_f32 v225, v146, v147
    v_mfma_f32_16x16x32_bf16 v[64:67], a[168:171], a[132:135], v[64:67]
    v_mul_f32 v55, v116, v116
    v_mul_f32 v56, v117, v117
    v_mfma_f32_16x16x32_bf16 v[68:71], a[172:175], a[128:131], v[68:71]
    ds_read_b128 a[160:163], v1 offset:40960
    v_fma_f32 v55, v55, v37, s49
    v_mfma_f32_16x16x32_bf16 v[72:75], a[172:175], a[132:135], v[72:75]
    v_mul_f32 v55, v55, v116
    v_fma_f32 v56, v56, v37, s49
    v_mfma_f32_16x16x32_bf16 v[60:63], a[176:179], a[64:67], v[60:63]
    ds_read_b128 a[164:167], v1 offset:41984
    v_mul_f32 v56, v56, v117
    v_mfma_f32_16x16x32_bf16 v[64:67], a[176:179], a[68:71], v[64:67]
    v_exp_f32 v55, v55
    v_mfma_f32_16x16x32_bf16 v[68:71], a[180:183], a[64:67], v[68:71]
    ds_read_b128 a[168:171], v1 offset:43008
    v_exp_f32 v56, v56
    v_mfma_f32_16x16x32_bf16 v[72:75], a[180:183], a[68:71], v[72:75]
    v_add_f32 v55, 1.0, v55
    v_mul_f32 v57, v118, v118
    v_mfma_f32_16x16x32_bf16 v[92:95], a[184:187], a[136:139], v[60:63]
    ds_read_b128 a[172:175], v1 offset:44032
    v_add_f32 v56, 1.0, v56
    v_mfma_f32_16x16x32_bf16 v[96:99], a[184:187], a[140:143], v[64:67]
    buffer_load_dwordx4 v[172:175], v38, s[40:43], s64 offen offset:2048 sc1
    v_mfma_f32_16x16x32_bf16 v[100:103], a[188:191], a[136:139], v[68:71]
    ds_read_b128 a[176:179], v1 offset:45056
    v_fma_f32 v57, v57, v37, s49
    v_mfma_f32_16x16x32_bf16 v[104:107], a[188:191], a[140:143], v[72:75]
    s_waitcnt lgkmcnt(3)
    v_rcp_f32 v55, v55
    v_mfma_f32_16x16x32_bf16 v[124:127], a[144:147], a[0:3], 0
    ds_read_b128 a[180:183], v1 offset:46080
    v_rcp_f32 v56, v56
    v_mfma_f32_16x16x32_bf16 v[128:131], a[144:147], a[4:7], 0
    v_mul_f32 v116, v116, v55
    v_mul_f32 v57, v57, v118
    v_mfma_f32_16x16x32_bf16 v[132:135], a[148:151], a[0:3], 0
    ds_read_b128 a[184:187], v1 offset:47104
    v_mul_f32 v117, v117, v56
    v_mfma_f32_16x16x32_bf16 v[136:139], a[148:151], a[4:7], 0
    v_exp_f32 v57, v57
    v_mfma_f32_16x16x32_bf16 v[124:127], a[152:155], a[72:75], v[124:127]
    ds_read_b128 a[188:191], v1 offset:48128
    v_mul_f32 v58, v119, v119
    v_mfma_f32_16x16x32_bf16 v[128:131], a[152:155], a[76:79], v[128:131]
    s_add_u32 s63, s63, 36864
    buffer_load_dwordx4 v[176:179], v38, s[40:43], s64 offen offset:3072 sc1
    v_mfma_f32_16x16x32_bf16 v[132:135], a[156:159], a[72:75], v[132:135]
    s_add_u32 m0, s50, 0
    ds_read_b128 a[144:147], v2 offset:0
    v_add_f32 v57, 1.0, v57
    v_fma_f32 v58, v58, v37, s49
    v_mfma_f32_16x16x32_bf16 v[136:139], a[156:159], a[76:79], v[136:139]
    buffer_load_dwordx4 v16, s[12:15], s63 offen offset:0 lds
    v_mfma_f32_16x16x32_bf16 v[124:127], a[160:163], a[8:11], v[124:127]
    ds_read_b128 a[148:151], v2 offset:1024
    v_mul_f32 v58, v58, v119
    v_mfma_f32_16x16x32_bf16 v[128:131], a[160:163], a[12:15], v[128:131]
    v_rcp_f32 v57, v57
    v_mfma_f32_16x16x32_bf16 v[132:135], a[164:167], a[8:11], v[132:135]
    ds_read_b128 a[152:155], v2 offset:2048
    v_mul_f32 v148, v116, v148
    v_mfma_f32_16x16x32_bf16 v[136:139], a[164:167], a[12:15], v[136:139]
    s_waitcnt lgkmcnt(3)
    v_exp_f32 v58, v58
    v_mfma_f32_16x16x32_bf16 v[124:127], a[168:171], a[80:83], v[124:127]
    ds_read_b128 a[156:159], v2 offset:3072
    v_mul_f32 v118, v118, v57
    v_mul_f32 v149, v117, v149
    v_mfma_f32_16x16x32_bf16 v[128:131], a[168:171], a[84:87], v[128:131]
    buffer_load_dwordx4 v16, s[12:15], s63 offen offset:1024 lds
    v_mfma_f32_16x16x32_bf16 v[132:135], a[172:175], a[80:83], v[132:135]
    s_add_u32 s64, s53, 4096
    ds_read_b128 a[160:163], v2 offset:4096
    v_add_f32 v58, 1.0, v58
    v_mfma_f32_16x16x32_bf16 v[136:139], a[172:175], a[84:87], v[136:139]
    buffer_load_dwordx4 v[180:183], v38, s[40:43], s64 offen offset:0 sc1
    v_mfma_f32_16x16x32_bf16 v[124:127], a[176:179], a[16:19], v[124:127]
    ds_read_b128 a[164:167], v2 offset:5120
    v_mul_f32 v150, v118, v150
    v_mfma_f32_16x16x32_bf16 v[128:131], a[176:179], a[20:23], v[128:131]
    buffer_load_dwordx4 v16, s[12:15], s63 offen offset:2048 lds
    v_mfma_f32_16x16x32_bf16 v[132:135], a[180:183], a[16:19], v[132:135]
    ds_read_b128 a[168:171], v2 offset:6144
    v_rcp_f32 v58, v58
    v_mfma_f32_16x16x32_bf16 v[136:139], a[180:183], a[20:23], v[136:139]
    v_cvt_pk_bf16_f32 v222, v148, v149
    v_mul_f32 v20, v120, v120
    v_mfma_f32_16x16x32_bf16 v[124:127], a[184:187], a[88:91], v[124:127]
    ds_read_b128 a[172:175], v2 offset:7168
    v_mul_f32 v119, v119, v58
    v_mfma_f32_16x16x32_bf16 v[128:131], a[184:187], a[92:95], v[128:131]
    v_mul_f32 v151, v119, v151
    v_fma_f32 v20, v20, v37, s49
    v_mfma_f32_16x16x32_bf16 v[132:135], a[188:191], a[88:91], v[132:135]
    ds_read_b128 a[176:179], v2 offset:8192
    v_cvt_pk_bf16_f32 v223, v150, v151
    v_mfma_f32_16x16x32_bf16 v[136:139], a[188:191], a[92:95], v[136:139]
    s_waitcnt lgkmcnt(3)
    buffer_load_dwordx4 v16, s[12:15], s63 offen offset:3072 lds
    v_mfma_f32_16x16x32_bf16 v[124:127], a[144:147], a[24:27], v[124:127]
    ds_read_b128 a[180:183], v2 offset:9216
    v_mul_f32 v20, v20, v120
    v_mul_f32 v21, v121, v121
    v_mfma_f32_16x16x32_bf16 v[128:131], a[144:147], a[28:31], v[128:131]
    buffer_load_dwordx4 v[184:187], v38, s[40:43], s64 offen offset:1024 sc1
    v_mfma_f32_16x16x32_bf16 v[132:135], a[148:151], a[24:27], v[132:135]
    s_add_u32 m0, s50, 4096
    ds_read_b128 a[184:187], v2 offset:10240
    v_fma_f32 v21, v21, v37, s49
    v_mfma_f32_16x16x32_bf16 v[136:139], a[148:151], a[28:31], v[136:139]
    buffer_load_dwordx4 v17, s[12:15], s63 offen offset:0 lds
    v_mfma_f32_16x16x32_bf16 v[124:127], a[152:155], a[96:99], v[124:127]
    ds_read_b128 a[188:191], v2 offset:11264
    v_mul_f32 v21, v21, v121
    v_mfma_f32_16x16x32_bf16 v[128:131], a[152:155], a[100:103], v[128:131]
    buffer_store_dwordx4 v[220:223], v38, s[40:43], s70 offen offset:2048 sc1
    v_mul_f32 v22, v122, v122
    v_mfma_f32_16x16x32_bf16 v[132:135], a[156:159], a[96:99], v[132:135]
    ds_read_b128 a[144:147], v2 offset:12288
    v_exp_f32 v20, v20
    v_mfma_f32_16x16x32_bf16 v[136:139], a[156:159], a[100:103], v[136:139]
    buffer_load_dword v43, v44, s[32:35], 0 offen sc1
    v_mfma_f32_16x16x32_bf16 v[124:127], a[160:163], a[32:35], v[124:127]
    ds_read_b128 a[148:151], v2 offset:13312
    v_add_f32 v20, 1.0, v20
    v_mfma_f32_16x16x32_bf16 v[128:131], a[160:163], a[36:39], v[128:131]
    buffer_load_dwordx4 v17, s[12:15], s63 offen offset:1024 lds
    v_mfma_f32_16x16x32_bf16 v[132:135], a[164:167], a[32:35], v[132:135]
    ds_read_b128 a[152:155], v2 offset:14336
    v_fma_f32 v22, v22, v37, s49
    v_mfma_f32_16x16x32_bf16 v[136:139], a[164:167], a[36:39], v[136:139]
    s_waitcnt lgkmcnt(3)
    buffer_load_dwordx4 v[188:191], v38, s[40:43], s64 offen offset:2048 sc1
    v_mfma_f32_16x16x32_bf16 v[124:127], a[168:171], a[104:107], v[124:127]
    ds_read_b128 a[156:159], v2 offset:15360
    v_rcp_f32 v20, v20
    v_mfma_f32_16x16x32_bf16 v[128:131], a[168:171], a[108:111], v[128:131]
    v_exp_f32 v21, v21
    v_mfma_f32_16x16x32_bf16 v[132:135], a[172:175], a[104:107], v[132:135]
    ds_read_b128 a[160:163], v2 offset:16384
    v_mul_f32 v120, v120, v20
    v_mfma_f32_16x16x32_bf16 v[136:139], a[172:175], a[108:111], v[136:139]
    buffer_load_dwordx4 v17, s[12:15], s63 offen offset:2048 lds
    v_mfma_f32_16x16x32_bf16 v[124:127], a[176:179], a[40:43], v[124:127]
    ds_read_b128 a[164:167], v2 offset:17408
    v_add_f32 v21, 1.0, v21
    v_mfma_f32_16x16x32_bf16 v[128:131], a[176:179], a[44:47], v[128:131]
    buffer_load_dwordx4 v[192:195], v38, s[40:43], s64 offen offset:3072 sc1
    v_mfma_f32_16x16x32_bf16 v[132:135], a[180:183], a[40:43], v[132:135]
    ds_read_b128 a[168:171], v2 offset:18432
    v_rcp_f32 v21, v21
    v_mfma_f32_16x16x32_bf16 v[136:139], a[180:183], a[44:47], v[136:139]
    v_mul_f32 v22, v22, v122
    v_mul_f32 v59, v123, v123
    v_mfma_f32_16x16x32_bf16 v[124:127], a[184:187], a[112:115], v[124:127]
    ds_read_b128 a[172:175], v2 offset:19456
    v_mul_f32 v121, v121, v21
    v_mfma_f32_16x16x32_bf16 v[128:131], a[184:187], a[116:119], v[128:131]
    buffer_load_dwordx4 v17, s[12:15], s63 offen offset:3072 lds
    v_mfma_f32_16x16x32_bf16 v[132:135], a[188:191], a[112:115], v[132:135]
    ds_read_b128 a[176:179], v2 offset:20480
    v_fma_f32 v59, v59, v37, s49
    v_mfma_f32_16x16x32_bf16 v[136:139], a[188:191], a[116:119], v[136:139]
    s_waitcnt lgkmcnt(3)
    v_exp_f32 v22, v22
    v_mfma_f32_16x16x32_bf16 v[124:127], a[144:147], a[48:51], v[124:127]
    ds_read_b128 a[180:183], v2 offset:21504
    v_mul_f32 v59, v59, v123
    v_mul_f32 v152, v120, v152
    v_mfma_f32_16x16x32_bf16 v[128:131], a[144:147], a[52:55], v[128:131]
    v_exp_f32 v59, v59
    v_mfma_f32_16x16x32_bf16 v[132:135], a[148:151], a[48:51], v[132:135]
    s_add_u32 m0, s50, 8192
    ds_read_b128 a[184:187], v2 offset:22528
    v_add_f32 v22, 1.0, v22
    v_mfma_f32_16x16x32_bf16 v[136:139], a[148:151], a[52:55], v[136:139]
    buffer_load_dwordx4 v18, s[12:15], s63 offen offset:0 lds
    v_mfma_f32_16x16x32_bf16 v[124:127], a[152:155], a[120:123], v[124:127]
    s_add_u32 s64, s53, 8192
    ds_read_b128 a[188:191], v2 offset:23552
    v_add_f32 v59, 1.0, v59
    v_mfma_f32_16x16x32_bf16 v[128:131], a[152:155], a[124:127], v[128:131]
    s_waitcnt vmcnt(32)
    buffer_load_dwordx4 v[196:199], v38, s[40:43], s64 offen offset:0 sc1
    v_mfma_f32_16x16x32_bf16 v[132:135], a[156:159], a[120:123], v[132:135]
    s_barrier
    ds_read_b128 a[144:147], v2 offset:24576
    v_rcp_f32 v22, v22
    v_mfma_f32_16x16x32_bf16 v[136:139], a[156:159], a[124:127], v[136:139]
    v_rcp_f32 v59, v59
    v_mfma_f32_16x16x32_bf16 v[124:127], a[160:163], a[56:59], v[124:127]
    ds_read_b128 a[148:151], v2 offset:25600
    v_mul_f32 v122, v122, v22
    v_mfma_f32_16x16x32_bf16 v[128:131], a[160:163], a[60:63], v[128:131]
    v_mul_f32 v123, v123, v59
    v_mul_f32 v153, v121, v153
    v_mfma_f32_16x16x32_bf16 v[132:135], a[164:167], a[56:59], v[132:135]
    ds_read_b128 a[152:155], v2 offset:26624
    v_mul_f32 v154, v122, v154
    v_mfma_f32_16x16x32_bf16 v[136:139], a[164:167], a[60:63], v[136:139]
    s_waitcnt lgkmcnt(3)
    buffer_load_dwordx4 v[200:203], v38, s[40:43], s64 offen offset:1024 sc1
    v_mfma_f32_16x16x32_bf16 v[124:127], a[168:171], a[128:131], v[124:127]
    ds_read_b128 a[156:159], v2 offset:27648
    v_mul_f32 v155, v123, v155
    v_cvt_pk_bf16_f32 v226, v152, v153
    v_mfma_f32_16x16x32_bf16 v[128:131], a[168:171], a[132:135], v[128:131]
    v_cvt_pk_bf16_f32 v227, v154, v155
    v_mul_f32 v19, v92, v92
    v_mfma_f32_16x16x32_bf16 v[132:135], a[172:175], a[128:131], v[132:135]
    ds_read_b128 a[160:163], v2 offset:28672
    v_fma_f32 v19, v19, v37, s49
    v_mfma_f32_16x16x32_bf16 v[136:139], a[172:175], a[132:135], v[136:139]
    buffer_store_dwordx4 v[224:227], v38, s[40:43], s70 offen offset:3072 sc1
    v_mul_f32 v19, v19, v92
    v_mfma_f32_16x16x32_bf16 v[124:127], a[176:179], a[64:67], v[124:127]
    s_add_u32 s70, s70, 4096
    ds_read_b128 a[164:167], v2 offset:29696
    v_mul_f32 v52, v93, v93
    v_mfma_f32_16x16x32_bf16 v[128:131], a[176:179], a[68:71], v[128:131]
    v_exp_f32 v19, v19
    v_mfma_f32_16x16x32_bf16 v[132:135], a[180:183], a[64:67], v[132:135]
    ds_read_b128 a[168:171], v2 offset:30720
    v_fma_f32 v52, v52, v37, s49
    v_mul_f32 v53, v94, v94
    v_mfma_f32_16x16x32_bf16 v[136:139], a[180:183], a[68:71], v[136:139]
    v_add_f32 v19, 1.0, v19
    v_mul_f32 v52, v52, v93
    v_mfma_f32_16x16x32_bf16 v[124:127], a[184:187], a[136:139], v[124:127]
    ds_read_b128 a[172:175], v2 offset:31744
    v_fma_f32 v53, v53, v37, s49
    v_mfma_f32_16x16x32_bf16 v[128:131], a[184:187], a[140:143], v[128:131]
    buffer_load_dwordx4 v[204:207], v38, s[40:43], s64 offen offset:2048 sc1
    v_mfma_f32_16x16x32_bf16 v[132:135], a[188:191], a[136:139], v[132:135]
    ds_read_b128 a[176:179], v2 offset:32768
    v_mul_f32 v53, v53, v94
    v_mfma_f32_16x16x32_bf16 v[136:139], a[188:191], a[140:143], v[136:139]
    s_waitcnt lgkmcnt(3)
    v_rcp_f32 v19, v19
    v_mfma_f32_16x16x32_bf16 v[60:63], a[144:147], v[212:215], 0
    ds_read_b128 a[180:183], v2 offset:33792
    v_exp_f32 v52, v52
    v_mfma_f32_16x16x32_bf16 v[64:67], a[144:147], v[216:219], 0
    v_exp_f32 v53, v53
    v_mfma_f32_16x16x32_bf16 v[68:71], a[148:151], v[212:215], 0
    ds_read_b128 a[184:187], v2 offset:34816
    v_mul_f32 v92, v92, v19
    v_mfma_f32_16x16x32_bf16 v[72:75], a[148:151], v[216:219], 0
    v_add_f32 v52, 1.0, v52
    v_add_f32 v53, 1.0, v53
    v_mfma_f32_16x16x32_bf16 v[76:79], a[152:155], v[212:215], 0
L_pg_main3:
    s_cbranch_execz L_wret
    ds_read_b128 a[188:191], v2 offset:35840
    v_mul_f32 v54, v95, v95
    v_mfma_f32_16x16x32_bf16 v[80:83], a[152:155], v[216:219], 0
    s_add_u32 s63, s63, 36864
    v_rcp_f32 v52, v52
    v_mfma_f32_16x16x32_bf16 v[84:87], a[156:159], v[212:215], 0
    s_add_u32 m0, s50, 36864
    ds_read_b128 a[144:147], v2 offset:36864
    v_rcp_f32 v53, v53
    v_mfma_f32_16x16x32_bf16 v[88:91], a[156:159], v[216:219], 0
    buffer_load_dwordx4 v16, s[12:15], s63 offen offset:0 lds
    v_mfma_f32_16x16x32_bf16 v[108:111], a[160:163], v[212:215], 0
    ds_read_b128 a[148:151], v2 offset:37888
    v_mul_f32 v93, v93, v52
    v_mfma_f32_16x16x32_bf16 v[112:115], a[160:163], v[216:219], 0
    buffer_load_dwordx4 v[208:211], v38, s[40:43], s64 offen offset:3072 sc1
    v_mfma_f32_16x16x32_bf16 v[116:119], a[164:167], v[212:215], 0
    ds_read_b128 a[152:155], v2 offset:38912
    v_mul_f32 v94, v94, v53
    v_mfma_f32_16x16x32_bf16 v[120:123], a[164:167], v[216:219], 0
    s_waitcnt lgkmcnt(3)
    v_fma_f32 v54, v54, v37, s49
    v_mul_f32 v124, v92, v124
    v_mfma_f32_16x16x32_bf16 v[140:143], a[168:171], v[212:215], 0
    ds_read_b128 a[156:159], v2 offset:39936
    v_mul_f32 v54, v54, v95
    v_mul_f32 v125, v93, v125
    v_mfma_f32_16x16x32_bf16 v[144:147], a[168:171], v[216:219], 0
    buffer_load_dwordx4 v16, s[12:15], s63 offen offset:1024 lds
    v_mfma_f32_16x16x32_bf16 v[148:151], a[172:175], v[212:215], 0
    ds_read_b128 a[160:163], v2 offset:40960
    v_mul_f32 v126, v94, v126
    v_mfma_f32_16x16x32_bf16 v[152:155], a[172:175], v[216:219], 0
    v_exp_f32 v54, v54
    v_mfma_f32_16x16x32_bf16 v[156:159], a[176:179], v[212:215], 0
    ds_read_b128 a[164:167], v2 offset:41984
    v_cvt_pk_bf16_f32 v228, v124, v125
    v_mfma_f32_16x16x32_bf16 v[160:163], a[176:179], v[216:219], 0
    buffer_load_dwordx4 v16, s[12:15], s63 offen offset:2048 lds
    v_mfma_f32_16x16x32_bf16 v[60:63], a[180:183], v[220:223], v[60:63]
    ds_read_b128 a[168:171], v2 offset:43008
    v_add_f32 v54, 1.0, v54
    v_mul_f32 v55, v96, v96
    v_mfma_f32_16x16x32_bf16 v[64:67], a[180:183], v[224:227], v[64:67]
    v_rcp_f32 v54, v54
    v_mfma_f32_16x16x32_bf16 v[68:71], a[184:187], v[220:223], v[68:71]
    ds_read_b128 a[172:175], v2 offset:44032
    v_fma_f32 v55, v55, v37, s49
    v_mfma_f32_16x16x32_bf16 v[72:75], a[184:187], v[224:227], v[72:75]
    v_mul_f32 v95, v95, v54
    v_mul_f32 v55, v55, v96
    v_mfma_f32_16x16x32_bf16 v[76:79], a[188:191], v[220:223], v[76:79]
    ds_read_b128 a[176:179], v2 offset:45056
    v_mul_f32 v127, v95, v127
    v_mfma_f32_16x16x32_bf16 v[80:83], a[188:191], v[224:227], v[80:83]
    s_waitcnt lgkmcnt(3)
    buffer_load_dwordx4 v16, s[12:15], s63 offen offset:3072 lds
    v_mfma_f32_16x16x32_bf16 v[84:87], a[144:147], v[220:223], v[84:87]
    ds_read_b128 a[180:183], v2 offset:46080
    v_exp_f32 v55, v55
    v_mfma_f32_16x16x32_bf16 v[88:91], a[144:147], v[224:227], v[88:91]
    v_cvt_pk_bf16_f32 v229, v126, v127
    v_mul_f32 v56, v97, v97
    v_mfma_f32_16x16x32_bf16 v[108:111], a[148:151], v[220:223], v[108:111]
    s_add_u32 m0, s50, 40960
    ds_read_b128 a[184:187], v2 offset:47104
    v_add_f32 v55, 1.0, v55
    v_mfma_f32_16x16x32_bf16 v[112:115], a[148:151], v[224:227], v[112:115]
    buffer_load_dwordx4 v17, s[12:15], s63 offen offset:0 lds
    v_mfma_f32_16x16x32_bf16 v[116:119], a[152:155], v[220:223], v[116:119]
    ds_read_b128 a[188:191], v2 offset:48128
    v_fma_f32 v56, v56, v37, s49
    v_mfma_f32_16x16x32_bf16 v[120:123], a[152:155], v[224:227], v[120:123]
    v_rcp_f32 v55, v55
    v_mfma_f32_16x16x32_bf16 v[140:143], a[156:159], v[220:223], v[140:143]
    ds_read_b128 a[144:147], v3 offset:0
    v_mul_f32 v56, v56, v97
    v_mul_f32 v57, v98, v98
    v_mfma_f32_16x16x32_bf16 v[144:147], a[156:159], v[224:227], v[144:147]
    v_exp_f32 v56, v56
    v_mfma_f32_16x16x32_bf16 v[148:151], a[160:163], v[220:223], v[148:151]
    ds_read_b128 a[148:151], v3 offset:1024
    v_mul_f32 v96, v96, v55
    v_mfma_f32_16x16x32_bf16 v[152:155], a[160:163], v[224:227], v[152:155]
    buffer_load_dwordx4 v17, s[12:15], s63 offen offset:1024 lds
    v_mfma_f32_16x16x32_bf16 v[156:159], a[164:167], v[220:223], v[156:159]
    ds_read_b128 a[152:155], v3 offset:2048
    v_add_f32 v56, 1.0, v56
    v_mfma_f32_16x16x32_bf16 v[160:163], a[164:167], v[224:227], v[160:163]
    s_waitcnt vmcnt(28) lgkmcnt(3)
    s_add_u32 s69, s67, 5
    v_fma_f32 v57, v57, v37, s49
    v_mfma_f32_16x16x32_bf16 v[60:63], a[168:171], v[164:167], v[60:63]
    s_waitcnt vmcnt(17)
    ds_read_b128 a[156:159], v3 offset:3072
    v_cmp_gt_u32 vcc, s69, v43
    v_mul_f32 v57, v57, v98
    v_mfma_f32_16x16x32_bf16 v[64:67], a[168:171], v[168:171], v[64:67]
    s_cbranch_vccnz L_slowe
L_backe:
    v_rcp_f32 v56, v56
    v_mfma_f32_16x16x32_bf16 v[68:71], a[172:175], v[164:167], v[68:71]
    ds_read_b128 a[160:163], v3 offset:4096
    v_mul_f32 v58, v99, v99
    v_mfma_f32_16x16x32_bf16 v[72:75], a[172:175], v[168:171], v[72:75]
    buffer_load_dwordx4 v17, s[12:15], s63 offen offset:2048 lds
    v_mfma_f32_16x16x32_bf16 v[76:79], a[176:179], v[164:167], v[76:79]
    s_add_u32 s74, s71, 0
    ds_read_b128 a[164:167], v3 offset:5120
    v_mul_f32 v97, v97, v56
    v_mfma_f32_16x16x32_bf16 v[80:83], a[176:179], v[168:171], v[80:83]
    buffer_load_dwordx4 a[0:3], v38, s[40:43], s74 offen offset:0 sc1
    v_mfma_f32_16x16x32_bf16 v[84:87], a[180:183], v[164:167], v[84:87]
    ds_read_b128 a[168:171], v3 offset:6144
    v_exp_f32 v57, v57
    v_mfma_f32_16x16x32_bf16 v[88:91], a[180:183], v[168:171], v[88:91]
    v_fma_f32 v58, v58, v37, s49
    v_mul_f32 v128, v96, v128
    v_mfma_f32_16x16x32_bf16 v[108:111], a[184:187], v[164:167], v[108:111]
    ds_read_b128 a[172:175], v3 offset:7168
    v_add_f32 v57, 1.0, v57
    v_mfma_f32_16x16x32_bf16 v[112:115], a[184:187], v[168:171], v[112:115]
    buffer_load_dwordx4 v17, s[12:15], s63 offen offset:3072 lds
    v_mfma_f32_16x16x32_bf16 v[116:119], a[188:191], v[164:167], v[116:119]
    ds_read_b128 a[176:179], v3 offset:8192
    v_mul_f32 v58, v58, v99
    v_mfma_f32_16x16x32_bf16 v[120:123], a[188:191], v[168:171], v[120:123]
    s_waitcnt lgkmcnt(3)
    v_rcp_f32 v57, v57
    v_mfma_f32_16x16x32_bf16 v[140:143], a[144:147], v[164:167], v[140:143]
    ds_read_b128 a[180:183], v3 offset:9216
    v_exp_f32 v58, v58
    v_mfma_f32_16x16x32_bf16 v[144:147], a[144:147], v[168:171], v[144:147]
    buffer_load_dwordx4 a[4:7], v38, s[40:43], s74 offen offset:1024 sc1
    v_mfma_f32_16x16x32_bf16 v[148:151], a[148:151], v[164:167], v[148:151]
    s_add_u32 m0, s50, 45056
    ds_read_b128 a[184:187], v3 offset:10240
    v_mul_f32 v98, v98, v57
    v_mfma_f32_16x16x32_bf16 v[152:155], a[148:151], v[168:171], v[152:155]
    buffer_load_dwordx4 v18, s[12:15], s63 offen offset:0 lds
    v_mfma_f32_16x16x32_bf16 v[156:159], a[152:155], v[164:167], v[156:159]
    ds_read_b128 a[188:191], v3 offset:11264
    v_add_f32 v58, 1.0, v58
    v_mfma_f32_16x16x32_bf16 v[160:163], a[152:155], v[168:171], v[160:163]
    s_waitcnt vmcnt(31)
    v_rcp_f32 v58, v58
    v_mfma_f32_16x16x32_bf16 v[60:63], a[156:159], v[172:175], v[60:63]
    s_barrier
    ds_read_b128 a[144:147], v3 offset:12288
    v_mul_f32 v129, v97, v129
    v_mul_f32 v130, v98, v130
    v_mfma_f32_16x16x32_bf16 v[64:67], a[156:159], v[176:179], v[64:67]
    v_mul_f32 v99, v99, v58
    v_cvt_pk_bf16_f32 v232, v128, v129
    v_mfma_f32_16x16x32_bf16 v[68:71], a[160:163], v[172:175], v[68:71]
    ds_read_b128 a[148:151], v3 offset:13312
    v_mul_f32 v131, v99, v131
    v_mfma_f32_16x16x32_bf16 v[72:75], a[160:163], v[176:179], v[72:75]
    buffer_load_dwordx4 a[8:11], v38, s[40:43], s74 offen offset:2048 sc1
    v_mfma_f32_16x16x32_bf16 v[76:79], a[164:167], v[172:175], v[76:79]
    ds_read_b128 a[152:155], v3 offset:14336
    v_cvt_pk_bf16_f32 v233, v130, v131
    v_mfma_f32_16x16x32_bf16 v[80:83], a[164:167], v[176:179], v[80:83]
    s_waitcnt lgkmcnt(3)
    v_mul_f32 v20, v100, v100
    v_mul_f32 v21, v101, v101
    v_mfma_f32_16x16x32_bf16 v[84:87], a[168:171], v[172:175], v[84:87]
    ds_read_b128 a[156:159], v3 offset:15360
    v_fma_f32 v20, v20, v37, s49
    v_fma_f32 v21, v21, v37, s49
    v_mfma_f32_16x16x32_bf16 v[88:91], a[168:171], v[176:179], v[88:91]
    v_mul_f32 v20, v20, v100
    v_mul_f32 v21, v21, v101
    v_mfma_f32_16x16x32_bf16 v[108:111], a[172:175], v[172:175], v[108:111]
    ds_read_b128 a[160:163], v3 offset:16384
    v_mul_f32 v22, v102, v102
    v_mfma_f32_16x16x32_bf16 v[112:115], a[172:175], v[176:179], v[112:115]
    v_exp_f32 v20, v20
    v_mfma_f32_16x16x32_bf16 v[116:119], a[176:179], v[172:175], v[116:119]
    ds_read_b128 a[164:167], v3 offset:17408
    v_fma_f32 v22, v22, v37, s49
    v_mfma_f32_16x16x32_bf16 v[120:123], a[176:179], v[176:179], v[120:123]
    buffer_load_dwordx4 a[12:15], v38, s[40:43], s74 offen offset:3072 sc1
    v_mfma_f32_16x16x32_bf16 v[140:143], a[180:183], v[172:175], v[140:143]
    ds_read_b128 a[168:171], v3 offset:18432
    v_exp_f32 v21, v21
    v_mfma_f32_16x16x32_bf16 v[144:147], a[180:183], v[176:179], v[144:147]
    v_add_f32 v20, 1.0, v20
    v_mul_f32 v22, v22, v102
    v_mfma_f32_16x16x32_bf16 v[148:151], a[184:187], v[172:175], v[148:151]
    ds_read_b128 a[172:175], v3 offset:19456
    v_add_f32 v21, 1.0, v21
    v_mfma_f32_16x16x32_bf16 v[152:155], a[184:187], v[176:179], v[152:155]
    v_rcp_f32 v20, v20
    v_mfma_f32_16x16x32_bf16 v[156:159], a[188:191], v[172:175], v[156:159]
    ds_read_b128 a[176:179], v3 offset:20480
    v_mul_f32 v59, v103, v103
    v_mfma_f32_16x16x32_bf16 v[160:163], a[188:191], v[176:179], v[160:163]
    s_waitcnt lgkmcnt(3)
    v_rcp_f32 v21, v21
    v_mfma_f32_16x16x32_bf16 v[60:63], a[144:147], v[180:183], v[60:63]
    ds_read_b128 a[180:183], v3 offset:21504
    v_exp_f32 v22, v22
    v_mfma_f32_16x16x32_bf16 v[64:67], a[144:147], v[184:187], v[64:67]
    v_mul_f32 v100, v100, v20
    v_mul_f32 v101, v101, v21
    v_mfma_f32_16x16x32_bf16 v[68:71], a[148:151], v[180:183], v[68:71]
    s_add_u32 s74, s71, 4096
    ds_read_b128 a[184:187], v3 offset:22528
    v_add_f32 v22, 1.0, v22
    v_mfma_f32_16x16x32_bf16 v[72:75], a[148:151], v[184:187], v[72:75]
    buffer_load_dwordx4 a[16:19], v38, s[40:43], s74 offen offset:0 sc1
    v_mfma_f32_16x16x32_bf16 v[76:79], a[152:155], v[180:183], v[76:79]
    ds_read_b128 a[188:191], v3 offset:23552
    v_fma_f32 v59, v59, v37, s49
    v_mfma_f32_16x16x32_bf16 v[80:83], a[152:155], v[184:187], v[80:83]
    s_add_u32 s63, s63, 36864
    v_rcp_f32 v22, v22
    v_mfma_f32_16x16x32_bf16 v[84:87], a[156:159], v[180:183], v[84:87]
    s_add_u32 m0, s50, 73728
    ds_read_b128 a[144:147], v3 offset:24576
    v_mul_f32 v59, v59, v103
    v_mul_f32 v132, v100, v132
    v_mfma_f32_16x16x32_bf16 v[88:91], a[156:159], v[184:187], v[88:91]
    buffer_load_dwordx4 v16, s[12:15], s63 offen offset:0 lds
    v_mfma_f32_16x16x32_bf16 v[108:111], a[160:163], v[180:183], v[108:111]
    ds_read_b128 a[148:151], v3 offset:25600
    v_mul_f32 v102, v102, v22
    v_mfma_f32_16x16x32_bf16 v[112:115], a[160:163], v[184:187], v[112:115]
    v_exp_f32 v59, v59
    v_mfma_f32_16x16x32_bf16 v[116:119], a[164:167], v[180:183], v[116:119]
    ds_read_b128 a[152:155], v3 offset:26624
    v_mul_f32 v133, v101, v133
    v_mfma_f32_16x16x32_bf16 v[120:123], a[164:167], v[184:187], v[120:123]
    s_waitcnt lgkmcnt(3)
    buffer_load_dwordx4 a[20:23], v38, s[40:43], s74 offen offset:1024 sc1
    v_mfma_f32_16x16x32_bf16 v[140:143], a[168:171], v[180:183], v[140:143]
    ds_read_b128 a[156:159], v3 offset:27648
    v_add_f32 v59, 1.0, v59
    v_mul_f32 v134, v102, v134
    v_mfma_f32_16x16x32_bf16 v[144:147], a[168:171], v[184:187], v[144:147]
    buffer_load_dwordx4 v16, s[12:15], s63 offen offset:1024 lds
    v_mfma_f32_16x16x32_bf16 v[148:151], a[172:175], v[180:183], v[148:151]
    ds_read_b128 a[160:163], v3 offset:28672
    v_cvt_pk_bf16_f32 v230, v132, v133
    v_mfma_f32_16x16x32_bf16 v[152:155], a[172:175], v[184:187], v[152:155]
    v_rcp_f32 v59, v59
    v_mfma_f32_16x16x32_bf16 v[156:159], a[176:179], v[180:183], v[156:159]
    ds_read_b128 a[164:167], v3 offset:29696
    v_mul_f32 v19, v104, v104
    v_mfma_f32_16x16x32_bf16 v[160:163], a[176:179], v[184:187], v[160:163]
    s_waitcnt vmcnt(24)
    buffer_load_dwordx4 v16, s[12:15], s63 offen offset:2048 lds
    v_mfma_f32_16x16x32_bf16 v[60:63], a[180:183], v[188:191], v[60:63]
    ds_read_b128 a[168:171], v3 offset:30720
    v_mul_f32 v103, v103, v59
    v_fma_f32 v19, v19, v37, s49
    v_mfma_f32_16x16x32_bf16 v[64:67], a[180:183], v[192:195], v[64:67]
    buffer_load_dwordx4 a[24:27], v38, s[40:43], s74 offen offset:2048 sc1
    v_mfma_f32_16x16x32_bf16 v[68:71], a[184:187], v[188:191], v[68:71]
    ds_read_b128 a[172:175], v3 offset:31744
    v_mul_f32 v135, v103, v135
    v_mfma_f32_16x16x32_bf16 v[72:75], a[184:187], v[192:195], v[72:75]
    v_cvt_pk_bf16_f32 v231, v134, v135
    v_mul_f32 v19, v19, v104
    v_mfma_f32_16x16x32_bf16 v[76:79], a[188:191], v[188:191], v[76:79]
    ds_read_b128 a[176:179], v3 offset:32768
    v_mul_f32 v52, v105, v105
    v_mfma_f32_16x16x32_bf16 v[80:83], a[188:191], v[192:195], v[80:83]
    s_waitcnt lgkmcnt(3)
    buffer_load_dwordx4 v16, s[12:15], s63 offen offset:3072 lds
    v_mfma_f32_16x16x32_bf16 v[84:87], a[144:147], v[188:191], v[84:87]
    ds_read_b128 a[180:183], v3 offset:33792
    v_exp_f32 v19, v19
    v_mfma_f32_16x16x32_bf16 v[88:91], a[144:147], v[192:195], v[88:91]
    buffer_store_dwordx4 v[228:231], v38, s[40:43], s70 offen offset:0 sc1
    v_fma_f32 v52, v52, v37, s49
    v_mfma_f32_16x16x32_bf16 v[108:111], a[148:151], v[188:191], v[108:111]
    s_add_u32 m0, s50, 77824
    ds_read_b128 a[184:187], v3 offset:34816
    v_add_f32 v19, 1.0, v19
    v_mfma_f32_16x16x32_bf16 v[112:115], a[148:151], v[192:195], v[112:115]
    buffer_load_dwordx4 v17, s[12:15], s63 offen offset:0 lds
    v_mfma_f32_16x16x32_bf16 v[116:119], a[152:155], v[188:191], v[116:119]
    ds_read_b128 a[188:191], v3 offset:35840
    v_mul_f32 v52, v52, v105
    v_mfma_f32_16x16x32_bf16 v[120:123], a[152:155], v[192:195], v[120:123]
    buffer_load_dwordx4 a[28:31], v38, s[40:43], s74 offen offset:3072 sc1
    v_mfma_f32_16x16x32_bf16 v[140:143], a[156:159], v[188:191], v[140:143]
    ds_read_b128 a[144:147], v3 offset:36864
    v_rcp_f32 v19, v19
    v_mfma_f32_16x16x32_bf16 v[144:147], a[156:159], v[192:195], v[144:147]
    v_exp_f32 v52, v52
    v_mfma_f32_16x16x32_bf16 v[148:151], a[160:163], v[188:191], v[148:151]
    ds_read_b128 a[148:151], v3 offset:37888
    v_mul_f32 v104, v104, v19
    v_mfma_f32_16x16x32_bf16 v[152:155], a[160:163], v[192:195], v[152:155]
    buffer_load_dwordx4 v17, s[12:15], s63 offen offset:1024 lds
    v_mfma_f32_16x16x32_bf16 v[156:159], a[164:167], v[188:191], v[156:159]
    ds_read_b128 a[152:155], v3 offset:38912
    v_add_f32 v52, 1.0, v52
    v_mfma_f32_16x16x32_bf16 v[160:163], a[164:167], v[192:195], v[160:163]
    s_waitcnt vmcnt(27) lgkmcnt(3)
    v_rcp_f32 v52, v52
    v_mfma_f32_16x16x32_bf16 v[60:63], a[168:171], v[196:199], v[60:63]
    s_add_u32 s74, s71, 8192
    ds_read_b128 a[156:159], v3 offset:39936
    v_mul_f32 v53, v106, v106
    v_mul_f32 v54, v107, v107
    v_mfma_f32_16x16x32_bf16 v[64:67], a[168:171], v[200:203], v[64:67]
    buffer_load_dwordx4 a[32:35], v38, s[40:43], s74 offen offset:0 sc1
    v_mfma_f32_16x16x32_bf16 v[68:71], a[172:175], v[196:199], v[68:71]
    ds_read_b128 a[160:163], v3 offset:40960
    v_mul_f32 v105, v105, v52
    v_mfma_f32_16x16x32_bf16 v[72:75], a[172:175], v[200:203], v[72:75]
    buffer_load_dwordx4 v17, s[12:15], s63 offen offset:2048 lds
    v_mfma_f32_16x16x32_bf16 v[76:79], a[176:179], v[196:199], v[76:79]
    ds_read_b128 a[164:167], v3 offset:41984
    v_fma_f32 v53, v53, v37, s49
    v_mfma_f32_16x16x32_bf16 v[80:83], a[176:179], v[200:203], v[80:83]
    v_mul_f32 v53, v53, v106
    v_fma_f32 v54, v54, v37, s49
    v_mfma_f32_16x16x32_bf16 v[84:87], a[180:183], v[196:199], v[84:87]
    ds_read_b128 a[168:171], v3 offset:43008
    v_exp_f32 v53, v53
    v_mfma_f32_16x16x32_bf16 v[88:91], a[180:183], v[200:203], v[88:91]
    v_mul_f32 v54, v54, v107
    v_mul_f32 v136, v104, v136
    v_mfma_f32_16x16x32_bf16 v[108:111], a[184:187], v[196:199], v[108:111]
    ds_read_b128 a[172:175], v3 offset:44032
    v_add_f32 v53, 1.0, v53
    v_mfma_f32_16x16x32_bf16 v[112:115], a[184:187], v[200:203], v[112:115]
    buffer_load_dwordx4 v17, s[12:15], s63 offen offset:3072 lds
    v_mfma_f32_16x16x32_bf16 v[116:119], a[188:191], v[196:199], v[116:119]
    ds_read_b128 a[176:179], v3 offset:45056
    v_mul_f32 v137, v105, v137
    v_mfma_f32_16x16x32_bf16 v[120:123], a[188:191], v[200:203], v[120:123]
    s_waitcnt lgkmcnt(3)
    buffer_load_dwordx4 a[36:39], v38, s[40:43], s74 offen offset:1024 sc1
    v_mfma_f32_16x16x32_bf16 v[140:143], a[144:147], v[196:199], v[140:143]
    ds_read_b128 a[180:183], v3 offset:46080
    v_rcp_f32 v53, v53
    v_mfma_f32_16x16x32_bf16 v[144:147], a[144:147], v[200:203], v[144:147]
    v_exp_f32 v54, v54
    v_mfma_f32_16x16x32_bf16 v[148:151], a[148:151], v[196:199], v[148:151]
    s_add_u32 m0, s50, 81920
    ds_read_b128 a[184:187], v3 offset:47104
    v_mul_f32 v106, v106, v53
    v_mfma_f32_16x16x32_bf16 v[152:155], a[148:151], v[200:203], v[152:155]
    buffer_load_dwordx4 v18, s[12:15], s63 offen offset:0 lds
    v_mfma_f32_16x16x32_bf16 v[156:159], a[152:155], v[196:199], v[156:159]
    ds_read_b128 a[188:191], v3 offset:48128
    v_add_f32 v54, 1.0, v54
    v_mfma_f32_16x16x32_bf16 v[160:163], a[152:155], v[200:203], v[160:163]
    s_waitcnt vmcnt(28)
    buffer_load_dwordx4 a[40:43], v38, s[40:43], s74 offen offset:2048 sc1
    v_mfma_f32_16x16x32_bf16 v[60:63], a[156:159], v[204:207], v[60:63]
    s_barrier
    ds_read_b128 a[144:147], v1 offset:0
    v_rcp_f32 v54, v54
    v_mfma_f32_16x16x32_bf16 v[64:67], a[156:159], v[208:211], v[64:67]
    v_mul_f32 v138, v106, v138
    v_cvt_pk_bf16_f32 v234, v136, v137
    v_mfma_f32_16x16x32_bf16 v[68:71], a[160:163], v[204:207], v[68:71]
    ds_read_b128 a[148:151], v1 offset:1024
    v_mul_f32 v107, v107, v54
    v_mfma_f32_16x16x32_bf16 v[72:75], a[160:163], v[208:211], v[72:75]
    v_mul_f32 v139, v107, v139
    v_mfma_f32_16x16x32_bf16 v[76:79], a[164:167], v[204:207], v[76:79]
    ds_read_b128 a[152:155], v1 offset:2048
    v_cvt_pk_bf16_f32 v235, v138, v139
    v_mfma_f32_16x16x32_bf16 v[80:83], a[164:167], v[208:211], v[80:83]
    s_waitcnt lgkmcnt(3)
    buffer_store_dwordx4 v[232:235], v38, s[40:43], s70 offen offset:1024 sc1
    v_mfma_f32_16x16x32_bf16 v[84:87], a[168:171], v[204:207], v[84:87]
    ds_read_b128 a[156:159], v1 offset:3072
    v_mfma_f32_16x16x32_bf16 v[88:91], a[168:171], v[208:211], v[88:91]
    v_mfma_f32_16x16x32_bf16 v[108:111], a[172:175], v[204:207], v[108:111]
    ds_read_b128 a[160:163], v1 offset:4096
    v_mfma_f32_16x16x32_bf16 v[112:115], a[172:175], v[208:211], v[112:115]
    buffer_load_dwordx4 a[44:47], v38, s[40:43], s74 offen offset:3072 sc1
    v_mfma_f32_16x16x32_bf16 v[116:119], a[176:179], v[204:207], v[116:119]
    ds_read_b128 a[164:167], v1 offset:5120
    v_mfma_f32_16x16x32_bf16 v[120:123], a[176:179], v[208:211], v[120:123]
    v_mfma_f32_16x16x32_bf16 v[140:143], a[180:183], v[204:207], v[140:143]
    ds_read_b128 a[168:171], v1 offset:6144
    v_mfma_f32_16x16x32_bf16 v[144:147], a[180:183], v[208:211], v[144:147]
    v_mfma_f32_16x16x32_bf16 v[148:151], a[184:187], v[204:207], v[148:151]
    ds_read_b128 a[172:175], v1 offset:7168
    v_mfma_f32_16x16x32_bf16 v[152:155], a[184:187], v[208:211], v[152:155]
    v_mfma_f32_16x16x32_bf16 v[156:159], a[188:191], v[204:207], v[156:159]
    s_add_u32 s74, s72, 0
    ds_read_b128 a[176:179], v1 offset:8192
    v_mfma_f32_16x16x32_bf16 v[160:163], a[188:191], v[208:211], v[160:163]
    s_waitcnt lgkmcnt(3)
    buffer_load_dwordx4 a[48:51], v38, s[40:43], s74 offen offset:0 sc1
    v_mfma_f32_16x16x32_bf16 v[60:63], a[144:147], v[228:231], v[60:63]
    ds_read_b128 a[180:183], v1 offset:9216
    v_mfma_f32_16x16x32_bf16 v[64:67], a[144:147], v[232:235], v[64:67]
    v_mfma_f32_16x16x32_bf16 v[68:71], a[148:151], v[228:231], v[68:71]
    ds_read_b128 a[184:187], v1 offset:10240
    v_mfma_f32_16x16x32_bf16 v[72:75], a[148:151], v[232:235], v[72:75]
    v_mfma_f32_16x16x32_bf16 v[76:79], a[152:155], v[228:231], v[76:79]
    ds_read_b128 a[188:191], v1 offset:11264
    v_mfma_f32_16x16x32_bf16 v[80:83], a[152:155], v[232:235], v[80:83]
    s_add_u32 s63, s63, 36864
    v_mfma_f32_16x16x32_bf16 v[84:87], a[156:159], v[228:231], v[84:87]
    s_add_u32 m0, s50, 110592
    ds_read_b128 a[144:147], v1 offset:12288
    v_mfma_f32_16x16x32_bf16 v[88:91], a[156:159], v[232:235], v[88:91]
    buffer_load_dwordx4 v16, s[12:15], s63 offen offset:0 lds
    v_mfma_f32_16x16x32_bf16 v[108:111], a[160:163], v[228:231], v[108:111]
    ds_read_b128 a[148:151], v1 offset:13312
    v_mfma_f32_16x16x32_bf16 v[112:115], a[160:163], v[232:235], v[112:115]
    buffer_load_dwordx4 a[52:55], v38, s[40:43], s74 offen offset:1024 sc1
    v_mfma_f32_16x16x32_bf16 v[116:119], a[164:167], v[228:231], v[116:119]
    ds_read_b128 a[152:155], v1 offset:14336
    v_mfma_f32_16x16x32_bf16 v[120:123], a[164:167], v[232:235], v[120:123]
    s_waitcnt lgkmcnt(3)
    v_mfma_f32_16x16x32_bf16 v[140:143], a[168:171], v[228:231], v[140:143]
    ds_read_b128 a[156:159], v1 offset:15360
    v_mfma_f32_16x16x32_bf16 v[144:147], a[168:171], v[232:235], v[144:147]
    buffer_load_dwordx4 v16, s[12:15], s63 offen offset:1024 lds
    v_mfma_f32_16x16x32_bf16 v[148:151], a[172:175], v[228:231], v[148:151]
    ds_read_b128 a[160:163], v1 offset:16384
    v_mfma_f32_16x16x32_bf16 v[152:155], a[172:175], v[232:235], v[152:155]
    v_mfma_f32_16x16x32_bf16 v[156:159], a[176:179], v[228:231], v[156:159]
    ds_read_b128 a[164:167], v1 offset:17408
    v_mfma_f32_16x16x32_bf16 v[160:163], a[176:179], v[232:235], v[160:163]
    s_waitcnt vmcnt(26)
    buffer_load_dwordx4 v16, s[12:15], s63 offen offset:2048 lds
    v_mfma_f32_16x16x32_bf16 v[60:63], a[180:183], a[0:3], v[60:63]
    ds_read_b128 a[168:171], v1 offset:18432
    v_mfma_f32_16x16x32_bf16 v[64:67], a[180:183], a[4:7], v[64:67]
    buffer_load_dwordx4 a[56:59], v38, s[40:43], s74 offen offset:2048 sc1
    v_mfma_f32_16x16x32_bf16 v[68:71], a[184:187], a[0:3], v[68:71]
    ds_read_b128 a[172:175], v1 offset:19456
    v_mfma_f32_16x16x32_bf16 v[72:75], a[184:187], a[4:7], v[72:75]
    v_mfma_f32_16x16x32_bf16 v[76:79], a[188:191], a[0:3], v[76:79]
    ds_read_b128 a[176:179], v1 offset:20480
    v_mfma_f32_16x16x32_bf16 v[80:83], a[188:191], a[4:7], v[80:83]
    s_waitcnt lgkmcnt(3)
    buffer_load_dwordx4 v16, s[12:15], s63 offen offset:3072 lds
    v_mfma_f32_16x16x32_bf16 v[84:87], a[144:147], a[0:3], v[84:87]
    ds_read_b128 a[180:183], v1 offset:21504
    v_mfma_f32_16x16x32_bf16 v[88:91], a[144:147], a[4:7], v[88:91]
    buffer_load_dwordx4 a[60:63], v38, s[40:43], s74 offen offset:3072 sc1
    v_mfma_f32_16x16x32_bf16 v[108:111], a[148:151], a[0:3], v[108:111]
    s_add_u32 m0, s50, 114688
    ds_read_b128 a[184:187], v1 offset:22528
    v_mfma_f32_16x16x32_bf16 v[112:115], a[148:151], a[4:7], v[112:115]
    buffer_load_dwordx4 v17, s[12:15], s63 offen offset:0 lds
    v_mfma_f32_16x16x32_bf16 v[116:119], a[152:155], a[0:3], v[116:119]
    ds_read_b128 a[188:191], v1 offset:23552
    v_mfma_f32_16x16x32_bf16 v[120:123], a[152:155], a[4:7], v[120:123]
    v_mfma_f32_16x16x32_bf16 v[140:143], a[156:159], a[0:3], v[140:143]
    ds_read_b128 a[144:147], v1 offset:24576
    v_mfma_f32_16x16x32_bf16 v[144:147], a[156:159], a[4:7], v[144:147]
    v_mfma_f32_16x16x32_bf16 v[148:151], a[160:163], a[0:3], v[148:151]
    ds_read_b128 a[148:151], v1 offset:25600
    v_mfma_f32_16x16x32_bf16 v[152:155], a[160:163], a[4:7], v[152:155]
    buffer_load_dwordx4 v17, s[12:15], s63 offen offset:1024 lds
    v_mfma_f32_16x16x32_bf16 v[156:159], a[164:167], a[0:3], v[156:159]
    s_add_u32 s74, s72, 4096
    ds_read_b128 a[152:155], v1 offset:26624
    v_mfma_f32_16x16x32_bf16 v[160:163], a[164:167], a[4:7], v[160:163]
    s_waitcnt vmcnt(29) lgkmcnt(3)
    buffer_load_dwordx4 a[64:67], v38, s[40:43], s74 offen offset:0 sc1
    v_mfma_f32_16x16x32_bf16 v[60:63], a[168:171], a[8:11], v[60:63]
    ds_read_b128 a[156:159], v1 offset:27648
    v_mfma_f32_16x16x32_bf16 v[64:67], a[168:171], a[12:15], v[64:67]
    v_mfma_f32_16x16x32_bf16 v[68:71], a[172:175], a[8:11], v[68:71]
    ds_read_b128 a[160:163], v1 offset:28672
    v_mfma_f32_16x16x32_bf16 v[72:75], a[172:175], a[12:15], v[72:75]
    buffer_load_dwordx4 v17, s[12:15], s63 offen offset:2048 lds
    v_mfma_f32_16x16x32_bf16 v[76:79], a[176:179], a[8:11], v[76:79]
    ds_read_b128 a[164:167], v1 offset:29696
    v_mfma_f32_16x16x32_bf16 v[80:83], a[176:179], a[12:15], v[80:83]
    buffer_load_dwordx4 a[68:71], v38, s[40:43], s74 offen offset:1024 sc1
    v_mfma_f32_16x16x32_bf16 v[84:87], a[180:183], a[8:11], v[84:87]
    ds_read_b128 a[168:171], v1 offset:30720
    v_mfma_f32_16x16x32_bf16 v[88:91], a[180:183], a[12:15], v[88:91]
    v_mfma_f32_16x16x32_bf16 v[108:111], a[184:187], a[8:11], v[108:111]
    ds_read_b128 a[172:175], v1 offset:31744
    v_mfma_f32_16x16x32_bf16 v[112:115], a[184:187], a[12:15], v[112:115]
    buffer_load_dwordx4 v17, s[12:15], s63 offen offset:3072 lds
    v_mfma_f32_16x16x32_bf16 v[116:119], a[188:191], a[8:11], v[116:119]
    ds_read_b128 a[176:179], v1 offset:32768
    v_mfma_f32_16x16x32_bf16 v[120:123], a[188:191], a[12:15], v[120:123]
    s_waitcnt lgkmcnt(3)
    v_mfma_f32_16x16x32_bf16 v[140:143], a[144:147], a[8:11], v[140:143]
    ds_read_b128 a[180:183], v1 offset:33792
    v_mfma_f32_16x16x32_bf16 v[144:147], a[144:147], a[12:15], v[144:147]
    v_mfma_f32_16x16x32_bf16 v[148:151], a[148:151], a[8:11], v[148:151]
    s_add_u32 m0, s50, 118784
    ds_read_b128 a[184:187], v1 offset:34816
    v_mfma_f32_16x16x32_bf16 v[152:155], a[148:151], a[12:15], v[152:155]
    buffer_load_dwordx4 v18, s[12:15], s63 offen offset:0 lds
    v_mfma_f32_16x16x32_bf16 v[156:159], a[152:155], a[8:11], v[156:159]
    ds_read_b128 a[188:191], v1 offset:35840
    v_mfma_f32_16x16x32_bf16 v[160:163], a[152:155], a[12:15], v[160:163]
    s_waitcnt vmcnt(31)
    buffer_load_dwordx4 a[72:75], v38, s[40:43], s74 offen offset:2048 sc1
    v_mfma_f32_16x16x32_bf16 v[60:63], a[156:159], a[16:19], v[60:63]
    s_barrier
    ds_read_b128 a[144:147], v1 offset:36864
    v_mfma_f32_16x16x32_bf16 v[64:67], a[156:159], a[20:23], v[64:67]
    v_mfma_f32_16x16x32_bf16 v[68:71], a[160:163], a[16:19], v[68:71]
    ds_read_b128 a[148:151], v1 offset:37888
    v_mfma_f32_16x16x32_bf16 v[72:75], a[160:163], a[20:23], v[72:75]
    v_mfma_f32_16x16x32_bf16 v[76:79], a[164:167], a[16:19], v[76:79]
    ds_read_b128 a[152:155], v1 offset:38912
    v_mfma_f32_16x16x32_bf16 v[80:83], a[164:167], a[20:23], v[80:83]
    s_waitcnt lgkmcnt(3)
    buffer_load_dwordx4 a[76:79], v38, s[40:43], s74 offen offset:3072 sc1
    v_mfma_f32_16x16x32_bf16 v[84:87], a[168:171], a[16:19], v[84:87]
    ds_read_b128 a[156:159], v1 offset:39936
    v_mfma_f32_16x16x32_bf16 v[88:91], a[168:171], a[20:23], v[88:91]
    v_mfma_f32_16x16x32_bf16 v[108:111], a[172:175], a[16:19], v[108:111]
    ds_read_b128 a[160:163], v1 offset:40960
    v_mfma_f32_16x16x32_bf16 v[112:115], a[172:175], a[20:23], v[112:115]
    v_mfma_f32_16x16x32_bf16 v[116:119], a[176:179], a[16:19], v[116:119]
    ds_read_b128 a[164:167], v1 offset:41984
    v_mfma_f32_16x16x32_bf16 v[120:123], a[176:179], a[20:23], v[120:123]
    v_mfma_f32_16x16x32_bf16 v[140:143], a[180:183], a[16:19], v[140:143]
    s_add_u32 s74, s72, 8192
    ds_read_b128 a[168:171], v1 offset:43008
    v_mfma_f32_16x16x32_bf16 v[144:147], a[180:183], a[20:23], v[144:147]
    buffer_load_dwordx4 a[80:83], v38, s[40:43], s74 offen offset:0 sc1
    v_mfma_f32_16x16x32_bf16 v[148:151], a[184:187], a[16:19], v[148:151]
    ds_read_b128 a[172:175], v1 offset:44032
    v_mfma_f32_16x16x32_bf16 v[152:155], a[184:187], a[20:23], v[152:155]
    v_mfma_f32_16x16x32_bf16 v[156:159], a[188:191], a[16:19], v[156:159]
    ds_read_b128 a[176:179], v1 offset:45056
    v_mfma_f32_16x16x32_bf16 v[160:163], a[188:191], a[20:23], v[160:163]
    s_waitcnt vmcnt(27) lgkmcnt(3)
    v_mfma_f32_16x16x32_bf16 v[60:63], a[144:147], a[24:27], v[60:63]
    ds_read_b128 a[180:183], v1 offset:46080
    v_mfma_f32_16x16x32_bf16 v[64:67], a[144:147], a[28:31], v[64:67]
    v_mfma_f32_16x16x32_bf16 v[68:71], a[148:151], a[24:27], v[68:71]
    ds_read_b128 a[184:187], v1 offset:47104
    v_mfma_f32_16x16x32_bf16 v[72:75], a[148:151], a[28:31], v[72:75]
    v_mfma_f32_16x16x32_bf16 v[76:79], a[152:155], a[24:27], v[76:79]
    ds_read_b128 a[188:191], v1 offset:48128
    v_mfma_f32_16x16x32_bf16 v[80:83], a[152:155], a[28:31], v[80:83]
    s_add_u32 s63, s63, 36864
    buffer_load_dwordx4 a[84:87], v38, s[40:43], s74 offen offset:1024 sc1
    v_mfma_f32_16x16x32_bf16 v[84:87], a[156:159], a[24:27], v[84:87]
    s_add_u32 m0, s50, 0
    ds_read_b128 a[144:147], v2 offset:0
    v_mfma_f32_16x16x32_bf16 v[88:91], a[156:159], a[28:31], v[88:91]
    buffer_load_dwordx4 v16, s[12:15], s63 offen offset:0 lds
    v_mfma_f32_16x16x32_bf16 v[108:111], a[160:163], a[24:27], v[108:111]
    ds_read_b128 a[148:151], v2 offset:1024
    v_mfma_f32_16x16x32_bf16 v[112:115], a[160:163], a[28:31], v[112:115]
    v_mfma_f32_16x16x32_bf16 v[116:119], a[164:167], a[24:27], v[116:119]
    ds_read_b128 a[152:155], v2 offset:2048
    v_mfma_f32_16x16x32_bf16 v[120:123], a[164:167], a[28:31], v[120:123]
    s_waitcnt lgkmcnt(3)
    v_mfma_f32_16x16x32_bf16 v[140:143], a[168:171], a[24:27], v[140:143]
    ds_read_b128 a[156:159], v2 offset:3072
    v_mfma_f32_16x16x32_bf16 v[144:147], a[168:171], a[28:31], v[144:147]
    buffer_load_dwordx4 v16, s[12:15], s63 offen offset:1024 lds
    v_mfma_f32_16x16x32_bf16 v[148:151], a[172:175], a[24:27], v[148:151]
    ds_read_b128 a[160:163], v2 offset:4096
    v_mfma_f32_16x16x32_bf16 v[152:155], a[172:175], a[28:31], v[152:155]
    buffer_load_dwordx4 a[88:91], v38, s[40:43], s74 offen offset:2048 sc1
    v_mfma_f32_16x16x32_bf16 v[156:159], a[176:179], a[24:27], v[156:159]
    ds_read_b128 a[164:167], v2 offset:5120
    v_mfma_f32_16x16x32_bf16 v[160:163], a[176:179], a[28:31], v[160:163]
    s_waitcnt vmcnt(26)
    buffer_load_dwordx4 v16, s[12:15], s63 offen offset:2048 lds
    v_mfma_f32_16x16x32_bf16 v[60:63], a[180:183], a[32:35], v[60:63]
    ds_read_b128 a[168:171], v2 offset:6144
    v_mfma_f32_16x16x32_bf16 v[64:67], a[180:183], a[36:39], v[64:67]
    v_mfma_f32_16x16x32_bf16 v[68:71], a[184:187], a[32:35], v[68:71]
    ds_read_b128 a[172:175], v2 offset:7168
    v_mfma_f32_16x16x32_bf16 v[72:75], a[184:187], a[36:39], v[72:75]
L_pg_main4:
    s_cbranch_execz L_wret
    buffer_load_dwordx4 a[92:95], v38, s[40:43], s74 offen offset:3072 sc1
    v_mfma_f32_16x16x32_bf16 v[76:79], a[188:191], a[32:35], v[76:79]
    ds_read_b128 a[176:179], v2 offset:8192
    v_mfma_f32_16x16x32_bf16 v[80:83], a[188:191], a[36:39], v[80:83]
    s_waitcnt lgkmcnt(3)
    buffer_load_dwordx4 v16, s[12:15], s63 offen offset:3072 lds
    v_mfma_f32_16x16x32_bf16 v[84:87], a[144:147], a[32:35], v[84:87]
    ds_read_b128 a[180:183], v2 offset:9216
    v_mfma_f32_16x16x32_bf16 v[88:91], a[144:147], a[36:39], v[88:91]
    v_mfma_f32_16x16x32_bf16 v[108:111], a[148:151], a[32:35], v[108:111]
    s_add_u32 m0, s50, 4096
    ds_read_b128 a[184:187], v2 offset:10240
    v_mfma_f32_16x16x32_bf16 v[112:115], a[148:151], a[36:39], v[112:115]
    buffer_load_dwordx4 v17, s[12:15], s63 offen offset:0 lds
    v_mfma_f32_16x16x32_bf16 v[116:119], a[152:155], a[32:35], v[116:119]
    s_add_u32 s74, s73, 0
    ds_read_b128 a[188:191], v2 offset:11264
    v_mfma_f32_16x16x32_bf16 v[120:123], a[152:155], a[36:39], v[120:123]
    buffer_load_dwordx4 a[96:99], v38, s[40:43], s74 offen offset:0 sc1
    v_mfma_f32_16x16x32_bf16 v[140:143], a[156:159], a[32:35], v[140:143]
    ds_read_b128 a[144:147], v2 offset:12288
    v_mfma_f32_16x16x32_bf16 v[144:147], a[156:159], a[36:39], v[144:147]
    v_mfma_f32_16x16x32_bf16 v[148:151], a[160:163], a[32:35], v[148:151]
    ds_read_b128 a[148:151], v2 offset:13312
    v_mfma_f32_16x16x32_bf16 v[152:155], a[160:163], a[36:39], v[152:155]
    buffer_load_dwordx4 v17, s[12:15], s63 offen offset:1024 lds
    v_mfma_f32_16x16x32_bf16 v[156:159], a[164:167], a[32:35], v[156:159]
    ds_read_b128 a[152:155], v2 offset:14336
    v_mfma_f32_16x16x32_bf16 v[160:163], a[164:167], a[36:39], v[160:163]
    s_waitcnt vmcnt(28) lgkmcnt(3)
    v_mfma_f32_16x16x32_bf16 v[60:63], a[168:171], a[40:43], v[60:63]
    ds_read_b128 a[156:159], v2 offset:15360
    v_mfma_f32_16x16x32_bf16 v[64:67], a[168:171], a[44:47], v[64:67]
    v_mfma_f32_16x16x32_bf16 v[68:71], a[172:175], a[40:43], v[68:71]
    ds_read_b128 a[160:163], v2 offset:16384
    v_mfma_f32_16x16x32_bf16 v[72:75], a[172:175], a[44:47], v[72:75]
    buffer_load_dwordx4 v17, s[12:15], s63 offen offset:2048 lds
    v_mfma_f32_16x16x32_bf16 v[76:79], a[176:179], a[40:43], v[76:79]
    ds_read_b128 a[164:167], v2 offset:17408
    v_mfma_f32_16x16x32_bf16 v[80:83], a[176:179], a[44:47], v[80:83]
    buffer_load_dwordx4 a[100:103], v38, s[40:43], s74 offen offset:1024 sc1
    v_mfma_f32_16x16x32_bf16 v[84:87], a[180:183], a[40:43], v[84:87]
    ds_read_b128 a[168:171], v2 offset:18432
    v_mfma_f32_16x16x32_bf16 v[88:91], a[180:183], a[44:47], v[88:91]
    v_mfma_f32_16x16x32_bf16 v[108:111], a[184:187], a[40:43], v[108:111]
    ds_read_b128 a[172:175], v2 offset:19456
    v_mfma_f32_16x16x32_bf16 v[112:115], a[184:187], a[44:47], v[112:115]
    buffer_load_dwordx4 v17, s[12:15], s63 offen offset:3072 lds
    v_mfma_f32_16x16x32_bf16 v[116:119], a[188:191], a[40:43], v[116:119]
    ds_read_b128 a[176:179], v2 offset:20480
    v_mfma_f32_16x16x32_bf16 v[120:123], a[188:191], a[44:47], v[120:123]
    s_waitcnt lgkmcnt(3)
    buffer_load_dwordx4 a[104:107], v38, s[40:43], s74 offen offset:2048 sc1
    v_mfma_f32_16x16x32_bf16 v[140:143], a[144:147], a[40:43], v[140:143]
    ds_read_b128 a[180:183], v2 offset:21504
    v_mfma_f32_16x16x32_bf16 v[144:147], a[144:147], a[44:47], v[144:147]
    v_mfma_f32_16x16x32_bf16 v[148:151], a[148:151], a[40:43], v[148:151]
    s_add_u32 m0, s50, 8192
    ds_read_b128 a[184:187], v2 offset:22528
    v_mfma_f32_16x16x32_bf16 v[152:155], a[148:151], a[44:47], v[152:155]
    buffer_load_dwordx4 v18, s[12:15], s63 offen offset:0 lds
    v_mfma_f32_16x16x32_bf16 v[156:159], a[152:155], a[40:43], v[156:159]
    ds_read_b128 a[188:191], v2 offset:23552
    v_mfma_f32_16x16x32_bf16 v[160:163], a[152:155], a[44:47], v[160:163]
    s_waitcnt vmcnt(30)
    v_mfma_f32_16x16x32_bf16 v[60:63], a[156:159], a[48:51], v[60:63]
    s_barrier
    ds_read_b128 a[144:147], v2 offset:24576
    v_mfma_f32_16x16x32_bf16 v[64:67], a[156:159], a[52:55], v[64:67]
    s_add_u32 s55, s67, 6
    buffer_load_dwordx4 a[108:111], v38, s[40:43], s74 offen offset:3072 sc1
    v_mfma_f32_16x16x32_bf16 v[68:71], a[160:163], a[48:51], v[68:71]
    ds_read_b128 a[148:151], v2 offset:25600
    v_mov_b32 v42, s55
    v_mfma_f32_16x16x32_bf16 v[72:75], a[160:163], a[52:55], v[72:75]
    buffer_store_dword v42, v40, s[32:35], 0 offen sc1
    v_mfma_f32_16x16x32_bf16 v[76:79], a[164:167], a[48:51], v[76:79]
    ds_read_b128 a[152:155], v2 offset:26624
    v_mfma_f32_16x16x32_bf16 v[80:83], a[164:167], a[52:55], v[80:83]
    s_waitcnt lgkmcnt(3)
    v_mfma_f32_16x16x32_bf16 v[84:87], a[168:171], a[48:51], v[84:87]
    ds_read_b128 a[156:159], v2 offset:27648
    v_mfma_f32_16x16x32_bf16 v[88:91], a[168:171], a[52:55], v[88:91]
    v_mfma_f32_16x16x32_bf16 v[108:111], a[172:175], a[48:51], v[108:111]
    ds_read_b128 a[160:163], v2 offset:28672
    v_mfma_f32_16x16x32_bf16 v[112:115], a[172:175], a[52:55], v[112:115]
    v_mfma_f32_16x16x32_bf16 v[116:119], a[176:179], a[48:51], v[116:119]
    s_add_u32 s74, s73, 4096
    ds_read_b128 a[164:167], v2 offset:29696
    v_mfma_f32_16x16x32_bf16 v[120:123], a[176:179], a[52:55], v[120:123]
    buffer_load_dwordx4 a[112:115], v38, s[40:43], s74 offen offset:0 sc1
    v_mfma_f32_16x16x32_bf16 v[140:143], a[180:183], a[48:51], v[140:143]
    ds_read_b128 a[168:171], v2 offset:30720
    v_mfma_f32_16x16x32_bf16 v[144:147], a[180:183], a[52:55], v[144:147]
    v_mfma_f32_16x16x32_bf16 v[148:151], a[184:187], a[48:51], v[148:151]
    ds_read_b128 a[172:175], v2 offset:31744
    v_mfma_f32_16x16x32_bf16 v[152:155], a[184:187], a[52:55], v[152:155]
    v_mfma_f32_16x16x32_bf16 v[156:159], a[188:191], a[48:51], v[156:159]
    ds_read_b128 a[176:179], v2 offset:32768
    v_mfma_f32_16x16x32_bf16 v[160:163], a[188:191], a[52:55], v[160:163]
    s_waitcnt vmcnt(28) lgkmcnt(3)
    v_mfma_f32_16x16x32_bf16 v[60:63], a[144:147], a[56:59], v[60:63]
    ds_read_b128 a[180:183], v2 offset:33792
    v_mfma_f32_16x16x32_bf16 v[64:67], a[144:147], a[60:63], v[64:67]
    buffer_load_dwordx4 a[116:119], v38, s[40:43], s74 offen offset:1024 sc1
    v_mfma_f32_16x16x32_bf16 v[68:71], a[148:151], a[56:59], v[68:71]
    ds_read_b128 a[184:187], v2 offset:34816
    v_mfma_f32_16x16x32_bf16 v[72:75], a[148:151], a[60:63], v[72:75]
    v_mfma_f32_16x16x32_bf16 v[76:79], a[152:155], a[56:59], v[76:79]
    ds_read_b128 a[188:191], v2 offset:35840
    v_mfma_f32_16x16x32_bf16 v[80:83], a[152:155], a[60:63], v[80:83]
    s_add_u32 s63, s63, 36864
    v_mfma_f32_16x16x32_bf16 v[84:87], a[156:159], a[56:59], v[84:87]
    s_add_u32 m0, s50, 36864
    ds_read_b128 a[144:147], v2 offset:36864
    v_mfma_f32_16x16x32_bf16 v[88:91], a[156:159], a[60:63], v[88:91]
    buffer_load_dwordx4 v16, s[12:15], s63 offen offset:0 lds
    v_mfma_f32_16x16x32_bf16 v[108:111], a[160:163], a[56:59], v[108:111]
    ds_read_b128 a[148:151], v2 offset:37888
    v_mfma_f32_16x16x32_bf16 v[112:115], a[160:163], a[60:63], v[112:115]
    buffer_load_dwordx4 a[120:123], v38, s[40:43], s74 offen offset:2048 sc1
    v_mfma_f32_16x16x32_bf16 v[116:119], a[164:167], a[56:59], v[116:119]
    ds_read_b128 a[152:155], v2 offset:38912
    v_mfma_f32_16x16x32_bf16 v[120:123], a[164:167], a[60:63], v[120:123]
    s_waitcnt lgkmcnt(3)
    v_mfma_f32_16x16x32_bf16 v[140:143], a[168:171], a[56:59], v[140:143]
    ds_read_b128 a[156:159], v2 offset:39936
    v_mfma_f32_16x16x32_bf16 v[144:147], a[168:171], a[60:63], v[144:147]
    buffer_load_dwordx4 v16, s[12:15], s63 offen offset:1024 lds
    v_mfma_f32_16x16x32_bf16 v[148:151], a[172:175], a[56:59], v[148:151]
    ds_read_b128 a[160:163], v2 offset:40960
    v_mfma_f32_16x16x32_bf16 v[152:155], a[172:175], a[60:63], v[152:155]
    v_mfma_f32_16x16x32_bf16 v[156:159], a[176:179], a[56:59], v[156:159]
    ds_read_b128 a[164:167], v2 offset:41984
    v_mfma_f32_16x16x32_bf16 v[160:163], a[176:179], a[60:63], v[160:163]
    s_waitcnt vmcnt(27)
    buffer_load_dwordx4 v16, s[12:15], s63 offen offset:2048 lds
    v_mfma_f32_16x16x32_bf16 v[60:63], a[180:183], a[64:67], v[60:63]
    ds_read_b128 a[168:171], v2 offset:43008
    v_mfma_f32_16x16x32_bf16 v[64:67], a[180:183], a[68:71], v[64:67]
    buffer_load_dwordx4 a[124:127], v38, s[40:43], s74 offen offset:3072 sc1
    v_mfma_f32_16x16x32_bf16 v[68:71], a[184:187], a[64:67], v[68:71]
    ds_read_b128 a[172:175], v2 offset:44032
    v_mfma_f32_16x16x32_bf16 v[72:75], a[184:187], a[68:71], v[72:75]
    v_mfma_f32_16x16x32_bf16 v[76:79], a[188:191], a[64:67], v[76:79]
    ds_read_b128 a[176:179], v2 offset:45056
    v_mfma_f32_16x16x32_bf16 v[80:83], a[188:191], a[68:71], v[80:83]
    s_waitcnt lgkmcnt(3)
    buffer_load_dwordx4 v16, s[12:15], s63 offen offset:3072 lds
    v_mfma_f32_16x16x32_bf16 v[84:87], a[144:147], a[64:67], v[84:87]
    ds_read_b128 a[180:183], v2 offset:46080
    v_mfma_f32_16x16x32_bf16 v[88:91], a[144:147], a[68:71], v[88:91]
    v_mfma_f32_16x16x32_bf16 v[108:111], a[148:151], a[64:67], v[108:111]
    s_add_u32 m0, s50, 40960
    ds_read_b128 a[184:187], v2 offset:47104
    v_mfma_f32_16x16x32_bf16 v[112:115], a[148:151], a[68:71], v[112:115]
    buffer_load_dwordx4 v17, s[12:15], s63 offen offset:0 lds
    v_mfma_f32_16x16x32_bf16 v[116:119], a[152:155], a[64:67], v[116:119]
    s_add_u32 s74, s73, 8192
    ds_read_b128 a[188:191], v2 offset:48128
    v_mfma_f32_16x16x32_bf16 v[120:123], a[152:155], a[68:71], v[120:123]
    buffer_load_dwordx4 a[128:131], v38, s[40:43], s74 offen offset:0 sc1
    v_mfma_f32_16x16x32_bf16 v[140:143], a[156:159], a[64:67], v[140:143]
    ds_read_b128 a[144:147], v3 offset:0
    v_mfma_f32_16x16x32_bf16 v[144:147], a[156:159], a[68:71], v[144:147]
    v_mfma_f32_16x16x32_bf16 v[148:151], a[160:163], a[64:67], v[148:151]
    ds_read_b128 a[148:151], v3 offset:1024
    v_mfma_f32_16x16x32_bf16 v[152:155], a[160:163], a[68:71], v[152:155]
    buffer_load_dwordx4 v17, s[12:15], s63 offen offset:1024 lds
    v_mfma_f32_16x16x32_bf16 v[156:159], a[164:167], a[64:67], v[156:159]
    ds_read_b128 a[152:155], v3 offset:2048
    v_mfma_f32_16x16x32_bf16 v[160:163], a[164:167], a[68:71], v[160:163]
    s_waitcnt vmcnt(29) lgkmcnt(3)
    buffer_load_dwordx4 a[132:135], v38, s[40:43], s74 offen offset:1024 sc1
    v_mfma_f32_16x16x32_bf16 v[60:63], a[168:171], a[72:75], v[60:63]
    ds_read_b128 a[156:159], v3 offset:3072
    v_mfma_f32_16x16x32_bf16 v[64:67], a[168:171], a[76:79], v[64:67]
    v_mfma_f32_16x16x32_bf16 v[68:71], a[172:175], a[72:75], v[68:71]
    ds_read_b128 a[160:163], v3 offset:4096
    v_mfma_f32_16x16x32_bf16 v[72:75], a[172:175], a[76:79], v[72:75]
    buffer_load_dwordx4 v17, s[12:15], s63 offen offset:2048 lds
    v_mfma_f32_16x16x32_bf16 v[76:79], a[176:179], a[72:75], v[76:79]
    ds_read_b128 a[164:167], v3 offset:5120
    v_mfma_f32_16x16x32_bf16 v[80:83], a[176:179], a[76:79], v[80:83]
    v_mfma_f32_16x16x32_bf16 v[84:87], a[180:183], a[72:75], v[84:87]
    ds_read_b128 a[168:171], v3 offset:6144
    v_mfma_f32_16x16x32_bf16 v[88:91], a[180:183], a[76:79], v[88:91]
    buffer_load_dwordx4 a[136:139], v38, s[40:43], s74 offen offset:2048 sc1
    v_mfma_f32_16x16x32_bf16 v[108:111], a[184:187], a[72:75], v[108:111]
    ds_read_b128 a[172:175], v3 offset:7168
    v_mfma_f32_16x16x32_bf16 v[112:115], a[184:187], a[76:79], v[112:115]
    buffer_load_dwordx4 v17, s[12:15], s63 offen offset:3072 lds
    v_mfma_f32_16x16x32_bf16 v[116:119], a[188:191], a[72:75], v[116:119]
    ds_read_b128 a[176:179], v3 offset:8192
    v_mfma_f32_16x16x32_bf16 v[120:123], a[188:191], a[76:79], v[120:123]
    s_waitcnt lgkmcnt(3)
    v_mfma_f32_16x16x32_bf16 v[140:143], a[144:147], a[72:75], v[140:143]
    ds_read_b128 a[180:183], v3 offset:9216
    v_mfma_f32_16x16x32_bf16 v[144:147], a[144:147], a[76:79], v[144:147]
    v_mfma_f32_16x16x32_bf16 v[148:151], a[148:151], a[72:75], v[148:151]
    s_add_u32 m0, s50, 45056
    ds_read_b128 a[184:187], v3 offset:10240
    v_mfma_f32_16x16x32_bf16 v[152:155], a[148:151], a[76:79], v[152:155]
    buffer_load_dwordx4 v18, s[12:15], s63 offen offset:0 lds
    v_mfma_f32_16x16x32_bf16 v[156:159], a[152:155], a[72:75], v[156:159]
    ds_read_b128 a[188:191], v3 offset:11264
    v_mfma_f32_16x16x32_bf16 v[160:163], a[152:155], a[76:79], v[160:163]
    s_waitcnt vmcnt(32)
    buffer_load_dword v43, v44, s[32:35], 0 offen sc1
    v_mfma_f32_16x16x32_bf16 v[60:63], a[156:159], a[80:83], v[60:63]
    s_barrier
    ds_read_b128 a[144:147], v3 offset:12288
    v_mfma_f32_16x16x32_bf16 v[64:67], a[156:159], a[84:87], v[64:67]
    buffer_load_dwordx4 a[140:143], v38, s[40:43], s74 offen offset:3072 sc1
    v_mfma_f32_16x16x32_bf16 v[68:71], a[160:163], a[80:83], v[68:71]
    ds_read_b128 a[148:151], v3 offset:13312
    v_mfma_f32_16x16x32_bf16 v[72:75], a[160:163], a[84:87], v[72:75]
    v_mfma_f32_16x16x32_bf16 v[76:79], a[164:167], a[80:83], v[76:79]
    ds_read_b128 a[152:155], v3 offset:14336
    v_mfma_f32_16x16x32_bf16 v[80:83], a[164:167], a[84:87], v[80:83]
    s_waitcnt lgkmcnt(3)
    v_mfma_f32_16x16x32_bf16 v[84:87], a[168:171], a[80:83], v[84:87]
    ds_read_b128 a[156:159], v3 offset:15360
    v_mfma_f32_16x16x32_bf16 v[88:91], a[168:171], a[84:87], v[88:91]
    v_mfma_f32_16x16x32_bf16 v[108:111], a[172:175], a[80:83], v[108:111]
    ds_read_b128 a[160:163], v3 offset:16384
    v_mfma_f32_16x16x32_bf16 v[112:115], a[172:175], a[84:87], v[112:115]
    v_mfma_f32_16x16x32_bf16 v[116:119], a[176:179], a[80:83], v[116:119]
    ds_read_b128 a[164:167], v3 offset:17408
    v_mfma_f32_16x16x32_bf16 v[120:123], a[176:179], a[84:87], v[120:123]
    v_mfma_f32_16x16x32_bf16 v[140:143], a[180:183], a[80:83], v[140:143]
    ds_read_b128 a[168:171], v3 offset:18432
    v_mfma_f32_16x16x32_bf16 v[144:147], a[180:183], a[84:87], v[144:147]
    v_mfma_f32_16x16x32_bf16 v[148:151], a[184:187], a[80:83], v[148:151]
    ds_read_b128 a[172:175], v3 offset:19456
    v_mfma_f32_16x16x32_bf16 v[152:155], a[184:187], a[84:87], v[152:155]
    v_mfma_f32_16x16x32_bf16 v[156:159], a[188:191], a[80:83], v[156:159]
    ds_read_b128 a[176:179], v3 offset:20480
    v_mfma_f32_16x16x32_bf16 v[160:163], a[188:191], a[84:87], v[160:163]
    s_waitcnt vmcnt(29) lgkmcnt(3)
    v_mfma_f32_16x16x32_bf16 v[60:63], a[144:147], a[88:91], v[60:63]
    ds_read_b128 a[180:183], v3 offset:21504
    v_mfma_f32_16x16x32_bf16 v[64:67], a[144:147], a[92:95], v[64:67]
    v_mfma_f32_16x16x32_bf16 v[68:71], a[148:151], a[88:91], v[68:71]
    ds_read_b128 a[184:187], v3 offset:22528
    v_mfma_f32_16x16x32_bf16 v[72:75], a[148:151], a[92:95], v[72:75]
    v_mfma_f32_16x16x32_bf16 v[76:79], a[152:155], a[88:91], v[76:79]
    ds_read_b128 a[188:191], v3 offset:23552
    v_mfma_f32_16x16x32_bf16 v[80:83], a[152:155], a[92:95], v[80:83]
    s_add_u32 s63, s63, 36864
    v_mfma_f32_16x16x32_bf16 v[84:87], a[156:159], a[88:91], v[84:87]
    s_add_u32 m0, s50, 73728
    ds_read_b128 a[144:147], v3 offset:24576
    v_mfma_f32_16x16x32_bf16 v[88:91], a[156:159], a[92:95], v[88:91]
    buffer_load_dwordx4 v16, s[12:15], s63 offen offset:0 lds
    v_mfma_f32_16x16x32_bf16 v[108:111], a[160:163], a[88:91], v[108:111]
    ds_read_b128 a[148:151], v3 offset:25600
    v_mfma_f32_16x16x32_bf16 v[112:115], a[160:163], a[92:95], v[112:115]
    v_mfma_f32_16x16x32_bf16 v[116:119], a[164:167], a[88:91], v[116:119]
    ds_read_b128 a[152:155], v3 offset:26624
    v_mfma_f32_16x16x32_bf16 v[120:123], a[164:167], a[92:95], v[120:123]
    s_waitcnt lgkmcnt(3)
    v_mfma_f32_16x16x32_bf16 v[140:143], a[168:171], a[88:91], v[140:143]
    ds_read_b128 a[156:159], v3 offset:27648
    v_mfma_f32_16x16x32_bf16 v[144:147], a[168:171], a[92:95], v[144:147]
    buffer_load_dwordx4 v16, s[12:15], s63 offen offset:1024 lds
    v_mfma_f32_16x16x32_bf16 v[148:151], a[172:175], a[88:91], v[148:151]
    ds_read_b128 a[160:163], v3 offset:28672
    v_mfma_f32_16x16x32_bf16 v[152:155], a[172:175], a[92:95], v[152:155]
    v_mfma_f32_16x16x32_bf16 v[156:159], a[176:179], a[88:91], v[156:159]
    ds_read_b128 a[164:167], v3 offset:29696
    v_mfma_f32_16x16x32_bf16 v[160:163], a[176:179], a[92:95], v[160:163]
    s_waitcnt vmcnt(25)
    buffer_load_dwordx4 v16, s[12:15], s63 offen offset:2048 lds
    v_mfma_f32_16x16x32_bf16 v[60:63], a[180:183], a[96:99], v[60:63]
    ds_read_b128 a[168:171], v3 offset:30720
    v_mfma_f32_16x16x32_bf16 v[64:67], a[180:183], a[100:103], v[64:67]
    v_mfma_f32_16x16x32_bf16 v[68:71], a[184:187], a[96:99], v[68:71]
    ds_read_b128 a[172:175], v3 offset:31744
    v_mfma_f32_16x16x32_bf16 v[72:75], a[184:187], a[100:103], v[72:75]
    v_mfma_f32_16x16x32_bf16 v[76:79], a[188:191], a[96:99], v[76:79]
    ds_read_b128 a[176:179], v3 offset:32768
    v_mfma_f32_16x16x32_bf16 v[80:83], a[188:191], a[100:103], v[80:83]
    s_waitcnt lgkmcnt(3)
    buffer_load_dwordx4 v16, s[12:15], s63 offen offset:3072 lds
    v_mfma_f32_16x16x32_bf16 v[84:87], a[144:147], a[96:99], v[84:87]
    ds_read_b128 a[180:183], v3 offset:33792
    v_mfma_f32_16x16x32_bf16 v[88:91], a[144:147], a[100:103], v[88:91]
    v_mfma_f32_16x16x32_bf16 v[108:111], a[148:151], a[96:99], v[108:111]
    s_add_u32 m0, s50, 77824
    ds_read_b128 a[184:187], v3 offset:34816
    v_mfma_f32_16x16x32_bf16 v[112:115], a[148:151], a[100:103], v[112:115]
    buffer_load_dwordx4 v17, s[12:15], s63 offen offset:0 lds
    v_mfma_f32_16x16x32_bf16 v[116:119], a[152:155], a[96:99], v[116:119]
    ds_read_b128 a[188:191], v3 offset:35840
    v_mfma_f32_16x16x32_bf16 v[120:123], a[152:155], a[100:103], v[120:123]
    v_mfma_f32_16x16x32_bf16 v[140:143], a[156:159], a[96:99], v[140:143]
    ds_read_b128 a[144:147], v3 offset:36864
    v_mfma_f32_16x16x32_bf16 v[144:147], a[156:159], a[100:103], v[144:147]
    v_mfma_f32_16x16x32_bf16 v[148:151], a[160:163], a[96:99], v[148:151]
    ds_read_b128 a[148:151], v3 offset:37888
    v_mfma_f32_16x16x32_bf16 v[152:155], a[160:163], a[100:103], v[152:155]
    buffer_load_dwordx4 v17, s[12:15], s63 offen offset:1024 lds
    v_mfma_f32_16x16x32_bf16 v[156:159], a[164:167], a[96:99], v[156:159]
    ds_read_b128 a[152:155], v3 offset:38912
    v_mfma_f32_16x16x32_bf16 v[160:163], a[164:167], a[100:103], v[160:163]
    s_waitcnt vmcnt(25) lgkmcnt(3)
    s_add_u32 s69, s67, 6
    v_mfma_f32_16x16x32_bf16 v[60:63], a[168:171], a[104:107], v[60:63]
    s_waitcnt vmcnt(7)
    ds_read_b128 a[156:159], v3 offset:39936
    v_cmp_gt_u32 vcc, s69, v43
    v_mfma_f32_16x16x32_bf16 v[64:67], a[168:171], a[108:111], v[64:67]
    s_cbranch_vccnz L_slowl
L_backl:
    v_mfma_f32_16x16x32_bf16 v[68:71], a[172:175], a[104:107], v[68:71]
    ds_read_b128 a[160:163], v3 offset:40960
    v_mfma_f32_16x16x32_bf16 v[72:75], a[172:175], a[108:111], v[72:75]
    buffer_load_dwordx4 v17, s[12:15], s63 offen offset:2048 lds
    v_mfma_f32_16x16x32_bf16 v[76:79], a[176:179], a[104:107], v[76:79]
    s_add_u32 s65, s71, 12288
    ds_read_b128 a[164:167], v3 offset:41984
    v_mfma_f32_16x16x32_bf16 v[80:83], a[176:179], a[108:111], v[80:83]
    buffer_load_dwordx4 v[164:167], v38, s[40:43], s65 offen offset:0 sc1
    v_mfma_f32_16x16x32_bf16 v[84:87], a[180:183], a[104:107], v[84:87]
    ds_read_b128 a[168:171], v3 offset:43008
    v_mfma_f32_16x16x32_bf16 v[88:91], a[180:183], a[108:111], v[88:91]
    v_mfma_f32_16x16x32_bf16 v[108:111], a[184:187], a[104:107], v[108:111]
    ds_read_b128 a[172:175], v3 offset:44032
    v_mfma_f32_16x16x32_bf16 v[112:115], a[184:187], a[108:111], v[112:115]
    buffer_load_dwordx4 v17, s[12:15], s63 offen offset:3072 lds
    v_mfma_f32_16x16x32_bf16 v[116:119], a[188:191], a[104:107], v[116:119]
    ds_read_b128 a[176:179], v3 offset:45056
    v_mfma_f32_16x16x32_bf16 v[120:123], a[188:191], a[108:111], v[120:123]
    s_waitcnt lgkmcnt(3)
    buffer_load_dwordx4 v[168:171], v38, s[40:43], s65 offen offset:1024 sc1
    v_mfma_f32_16x16x32_bf16 v[140:143], a[144:147], a[104:107], v[140:143]
    ds_read_b128 a[180:183], v3 offset:46080
    v_mfma_f32_16x16x32_bf16 v[144:147], a[144:147], a[108:111], v[144:147]
    v_mfma_f32_16x16x32_bf16 v[148:151], a[148:151], a[104:107], v[148:151]
    s_add_u32 m0, s50, 81920
    ds_read_b128 a[184:187], v3 offset:47104
    v_mfma_f32_16x16x32_bf16 v[152:155], a[148:151], a[108:111], v[152:155]
    buffer_load_dwordx4 v18, s[12:15], s63 offen offset:0 lds
    v_mfma_f32_16x16x32_bf16 v[156:159], a[152:155], a[104:107], v[156:159]
    ds_read_b128 a[188:191], v3 offset:48128
    v_mfma_f32_16x16x32_bf16 v[160:163], a[152:155], a[108:111], v[160:163]
    s_waitcnt vmcnt(27)
    v_mfma_f32_16x16x32_bf16 v[60:63], a[156:159], a[112:115], v[60:63]
    s_barrier
    ds_read_b128 a[144:147], v1 offset:0
    v_mfma_f32_16x16x32_bf16 v[64:67], a[156:159], a[116:119], v[64:67]
    buffer_load_dwordx4 v[172:175], v38, s[40:43], s65 offen offset:2048 sc1
    v_mfma_f32_16x16x32_bf16 v[68:71], a[160:163], a[112:115], v[68:71]
    ds_read_b128 a[148:151], v1 offset:1024
    v_mfma_f32_16x16x32_bf16 v[72:75], a[160:163], a[116:119], v[72:75]
    v_mfma_f32_16x16x32_bf16 v[76:79], a[164:167], a[112:115], v[76:79]
    ds_read_b128 a[152:155], v1 offset:2048
    v_mfma_f32_16x16x32_bf16 v[80:83], a[164:167], a[116:119], v[80:83]
    s_waitcnt lgkmcnt(3)
    v_mfma_f32_16x16x32_bf16 v[84:87], a[168:171], a[112:115], v[84:87]
    ds_read_b128 a[156:159], v1 offset:3072
    v_mfma_f32_16x16x32_bf16 v[88:91], a[168:171], a[116:119], v[88:91]
    buffer_load_dwordx4 v[176:179], v38, s[40:43], s65 offen offset:3072 sc1
    v_mfma_f32_16x16x32_bf16 v[108:111], a[172:175], a[112:115], v[108:111]
    ds_read_b128 a[160:163], v1 offset:4096
    v_mfma_f32_16x16x32_bf16 v[112:115], a[172:175], a[116:119], v[112:115]
    v_mfma_f32_16x16x32_bf16 v[116:119], a[176:179], a[112:115], v[116:119]
    ds_read_b128 a[164:167], v1 offset:5120
    v_mfma_f32_16x16x32_bf16 v[120:123], a[176:179], a[116:119], v[120:123]
    v_mfma_f32_16x16x32_bf16 v[140:143], a[180:183], a[112:115], v[140:143]
    ds_read_b128 a[168:171], v1 offset:6144
    v_mfma_f32_16x16x32_bf16 v[144:147], a[180:183], a[116:119], v[144:147]
    v_mfma_f32_16x16x32_bf16 v[148:151], a[184:187], a[112:115], v[148:151]
    s_add_u32 s65, s71, 16384
    ds_read_b128 a[172:175], v1 offset:7168
    v_mfma_f32_16x16x32_bf16 v[152:155], a[184:187], a[116:119], v[152:155]
    buffer_load_dwordx4 v[180:183], v38, s[40:43], s65 offen offset:0 sc1
    v_mfma_f32_16x16x32_bf16 v[156:159], a[188:191], a[112:115], v[156:159]
    ds_read_b128 a[176:179], v1 offset:8192
    v_mfma_f32_16x16x32_bf16 v[160:163], a[188:191], a[116:119], v[160:163]
    s_waitcnt lgkmcnt(3)
    v_mfma_f32_16x16x32_bf16 v[60:63], a[144:147], a[120:123], v[60:63]
    ds_read_b128 a[180:183], v1 offset:9216
    v_mfma_f32_16x16x32_bf16 v[64:67], a[144:147], a[124:127], v[64:67]
    v_mfma_f32_16x16x32_bf16 v[68:71], a[148:151], a[120:123], v[68:71]
    s_cmp_lg_u32 s61, 0
    s_cselect_b32 s63, 2130706432, s66
    ds_read_b128 a[184:187], v1 offset:10240
    v_mfma_f32_16x16x32_bf16 v[72:75], a[148:151], a[124:127], v[72:75]
    buffer_load_dwordx4 v[184:187], v38, s[40:43], s65 offen offset:1024 sc1
    v_mfma_f32_16x16x32_bf16 v[76:79], a[152:155], a[120:123], v[76:79]
    ds_read_b128 a[188:191], v1 offset:11264
    v_mfma_f32_16x16x32_bf16 v[80:83], a[152:155], a[124:127], v[80:83]
    v_mfma_f32_16x16x32_bf16 v[84:87], a[156:159], a[120:123], v[84:87]
    ds_read_b128 a[144:147], v1 offset:12288
    v_mfma_f32_16x16x32_bf16 v[88:91], a[156:159], a[124:127], v[88:91]
    v_mfma_f32_16x16x32_bf16 v[108:111], a[160:163], a[120:123], v[108:111]
    ds_read_b128 a[148:151], v1 offset:13312
    v_mfma_f32_16x16x32_bf16 v[112:115], a[160:163], a[124:127], v[112:115]
    v_mfma_f32_16x16x32_bf16 v[116:119], a[164:167], a[120:123], v[116:119]
    s_add_u32 s65, s72, 12288
    ds_read_b128 a[152:155], v1 offset:14336
    v_mfma_f32_16x16x32_bf16 v[120:123], a[164:167], a[124:127], v[120:123]
    s_waitcnt lgkmcnt(3)
    buffer_load_dwordx4 v[188:191], v38, s[40:43], s65 offen offset:0 sc1
    v_mfma_f32_16x16x32_bf16 v[140:143], a[168:171], a[120:123], v[140:143]
    ds_read_b128 a[156:159], v1 offset:15360
    v_mfma_f32_16x16x32_bf16 v[144:147], a[168:171], a[124:127], v[144:147]
    v_mfma_f32_16x16x32_bf16 v[148:151], a[172:175], a[120:123], v[148:151]
    ds_read_b128 a[160:163], v1 offset:16384
    v_mfma_f32_16x16x32_bf16 v[152:155], a[172:175], a[124:127], v[152:155]
    v_mfma_f32_16x16x32_bf16 v[156:159], a[176:179], a[120:123], v[156:159]
    ds_read_b128 a[164:167], v1 offset:17408
    v_mfma_f32_16x16x32_bf16 v[160:163], a[176:179], a[124:127], v[160:163]
    buffer_load_dwordx4 v[192:195], v38, s[40:43], s65 offen offset:1024 sc1
    v_mfma_f32_16x16x32_bf16 v[60:63], a[180:183], a[128:131], v[60:63]
    ds_read_b128 a[168:171], v1 offset:18432
    v_mfma_f32_16x16x32_bf16 v[64:67], a[180:183], a[132:135], v[64:67]
    v_mfma_f32_16x16x32_bf16 v[68:71], a[184:187], a[128:131], v[68:71]
    ds_read_b128 a[172:175], v1 offset:19456
    v_mfma_f32_16x16x32_bf16 v[72:75], a[184:187], a[132:135], v[72:75]
    v_mfma_f32_16x16x32_bf16 v[76:79], a[188:191], a[128:131], v[76:79]
    ds_read_b128 a[176:179], v1 offset:20480
    v_mfma_f32_16x16x32_bf16 v[80:83], a[188:191], a[132:135], v[80:83]
    s_waitcnt lgkmcnt(3)
    v_mfma_f32_16x16x32_bf16 v[84:87], a[144:147], a[128:131], v[84:87]
    ds_read_b128 a[180:183], v1 offset:21504
    v_mfma_f32_16x16x32_bf16 v[88:91], a[144:147], a[132:135], v[88:91]
    buffer_load_dwordx4 v[196:199], v38, s[40:43], s65 offen offset:2048 sc1
    v_mfma_f32_16x16x32_bf16 v[108:111], a[148:151], a[128:131], v[108:111]
    ds_read_b128 a[184:187], v1 offset:22528
    v_mfma_f32_16x16x32_bf16 v[112:115], a[148:151], a[132:135], v[112:115]
    v_mfma_f32_16x16x32_bf16 v[116:119], a[152:155], a[128:131], v[116:119]
    ds_read_b128 a[188:191], v1 offset:23552
    v_mfma_f32_16x16x32_bf16 v[120:123], a[152:155], a[132:135], v[120:123]
    v_mfma_f32_16x16x32_bf16 v[140:143], a[156:159], a[128:131], v[140:143]
    ds_read_b128 a[144:147], v1 offset:24576
    v_mfma_f32_16x16x32_bf16 v[144:147], a[156:159], a[132:135], v[144:147]
    buffer_load_dwordx4 v[200:203], v38, s[40:43], s65 offen offset:3072 sc1
    v_mfma_f32_16x16x32_bf16 v[148:151], a[160:163], a[128:131], v[148:151]
    ds_read_b128 a[148:151], v1 offset:25600
    v_mfma_f32_16x16x32_bf16 v[152:155], a[160:163], a[132:135], v[152:155]
    v_mfma_f32_16x16x32_bf16 v[156:159], a[164:167], a[128:131], v[156:159]
    ds_read_b128 a[152:155], v1 offset:26624
    v_mfma_f32_16x16x32_bf16 v[160:163], a[164:167], a[132:135], v[160:163]
    s_waitcnt vmcnt(19) lgkmcnt(3)
    v_mfma_f32_16x16x32_bf16 v[60:63], a[168:171], a[136:139], v[60:63]
    ds_read_b128 a[156:159], v1 offset:27648
    v_mfma_f32_16x16x32_bf16 v[64:67], a[168:171], a[140:143], v[64:67]
    v_mfma_f32_16x16x32_bf16 v[68:71], a[172:175], a[136:139], v[68:71]
    s_add_u32 s65, s72, 16384
    ds_read_b128 a[160:163], v1 offset:28672
    v_mfma_f32_16x16x32_bf16 v[72:75], a[172:175], a[140:143], v[72:75]
    buffer_load_dwordx4 v[204:207], v38, s[40:43], s65 offen offset:0 sc1
    v_mfma_f32_16x16x32_bf16 v[76:79], a[176:179], a[136:139], v[76:79]
    ds_read_b128 a[164:167], v1 offset:29696
    v_mfma_f32_16x16x32_bf16 v[80:83], a[176:179], a[140:143], v[80:83]
    v_mfma_f32_16x16x32_bf16 v[84:87], a[180:183], a[136:139], v[84:87]
    ds_read_b128 a[168:171], v1 offset:30720
    v_mfma_f32_16x16x32_bf16 v[88:91], a[180:183], a[140:143], v[88:91]
    v_mfma_f32_16x16x32_bf16 v[108:111], a[184:187], a[136:139], v[108:111]
    ds_read_b128 a[172:175], v1 offset:31744
    v_mfma_f32_16x16x32_bf16 v[112:115], a[184:187], a[140:143], v[112:115]
    buffer_load_dwordx4 v[208:211], v38, s[40:43], s65 offen offset:1024 sc1
    v_mfma_f32_16x16x32_bf16 v[116:119], a[188:191], a[136:139], v[116:119]
    ds_read_b128 a[176:179], v1 offset:32768
    v_mfma_f32_16x16x32_bf16 v[120:123], a[188:191], a[140:143], v[120:123]
    s_waitcnt lgkmcnt(3)
    v_mfma_f32_16x16x32_bf16 v[140:143], a[144:147], a[136:139], v[140:143]
    ds_read_b128 a[180:183], v1 offset:33792
    v_mfma_f32_16x16x32_bf16 v[144:147], a[144:147], a[140:143], v[144:147]
    v_mfma_f32_16x16x32_bf16 v[148:151], a[148:151], a[136:139], v[148:151]
    ds_read_b128 a[184:187], v1 offset:34816
    v_mfma_f32_16x16x32_bf16 v[152:155], a[148:151], a[140:143], v[152:155]
    v_mfma_f32_16x16x32_bf16 v[156:159], a[152:155], a[136:139], v[156:159]
    s_add_u32 s65, s73, 12288
    ds_read_b128 a[188:191], v1 offset:35840
    v_mfma_f32_16x16x32_bf16 v[160:163], a[152:155], a[140:143], v[160:163]
    s_waitcnt vmcnt(11)
    buffer_load_dwordx4 v[212:215], v38, s[40:43], s65 offen offset:0 sc1
    v_mfma_f32_16x16x32_bf16 v[60:63], a[156:159], v[164:167], v[60:63]
    s_barrier
    ds_read_b128 a[144:147], v1 offset:36864
    v_mfma_f32_16x16x32_bf16 v[64:67], a[156:159], v[168:171], v[64:67]
    v_mfma_f32_16x16x32_bf16 v[68:71], a[160:163], v[164:167], v[68:71]
    ds_read_b128 a[148:151], v1 offset:37888
    v_mfma_f32_16x16x32_bf16 v[72:75], a[160:163], v[168:171], v[72:75]
    v_mfma_f32_16x16x32_bf16 v[76:79], a[164:167], v[164:167], v[76:79]
    ds_read_b128 a[152:155], v1 offset:38912
    v_mfma_f32_16x16x32_bf16 v[80:83], a[164:167], v[168:171], v[80:83]
    s_waitcnt lgkmcnt(3)
    buffer_load_dwordx4 v[216:219], v38, s[40:43], s65 offen offset:1024 sc1
    v_mfma_f32_16x16x32_bf16 v[84:87], a[168:171], v[164:167], v[84:87]
    ds_read_b128 a[156:159], v1 offset:39936
    v_mfma_f32_16x16x32_bf16 v[88:91], a[168:171], v[168:171], v[88:91]
    v_mfma_f32_16x16x32_bf16 v[108:111], a[172:175], v[164:167], v[108:111]
    ds_read_b128 a[160:163], v1 offset:40960
    v_mfma_f32_16x16x32_bf16 v[112:115], a[172:175], v[168:171], v[112:115]
    v_mfma_f32_16x16x32_bf16 v[116:119], a[176:179], v[164:167], v[116:119]
    ds_read_b128 a[164:167], v1 offset:41984
    v_mfma_f32_16x16x32_bf16 v[120:123], a[176:179], v[168:171], v[120:123]
    v_mfma_f32_16x16x32_bf16 v[140:143], a[180:183], v[164:167], v[140:143]
    ds_read_b128 a[168:171], v1 offset:43008
    v_mfma_f32_16x16x32_bf16 v[144:147], a[180:183], v[168:171], v[144:147]
    buffer_load_dwordx4 v[220:223], v38, s[40:43], s65 offen offset:2048 sc1
    v_mfma_f32_16x16x32_bf16 v[148:151], a[184:187], v[164:167], v[148:151]
    ds_read_b128 a[172:175], v1 offset:44032
    v_mfma_f32_16x16x32_bf16 v[152:155], a[184:187], v[168:171], v[152:155]
    v_mfma_f32_16x16x32_bf16 v[156:159], a[188:191], v[164:167], v[156:159]
    ds_read_b128 a[176:179], v1 offset:45056
    v_mfma_f32_16x16x32_bf16 v[160:163], a[188:191], v[168:171], v[160:163]
    s_waitcnt vmcnt(11) lgkmcnt(3)
    v_mfma_f32_16x16x32_bf16 v[60:63], a[144:147], v[172:175], v[60:63]
    ds_read_b128 a[180:183], v1 offset:46080
    v_mfma_f32_16x16x32_bf16 v[64:67], a[144:147], v[176:179], v[64:67]
    buffer_load_dwordx4 v[224:227], v38, s[40:43], s65 offen offset:3072 sc1
    v_mfma_f32_16x16x32_bf16 v[68:71], a[148:151], v[172:175], v[68:71]
    ds_read_b128 a[184:187], v1 offset:47104
    v_mfma_f32_16x16x32_bf16 v[72:75], a[148:151], v[176:179], v[72:75]
    v_mfma_f32_16x16x32_bf16 v[76:79], a[152:155], v[172:175], v[76:79]
    ds_read_b128 a[188:191], v1 offset:48128
    v_mfma_f32_16x16x32_bf16 v[80:83], a[152:155], v[176:179], v[80:83]
    v_mfma_f32_16x16x32_bf16 v[84:87], a[156:159], v[172:175], v[84:87]
    s_add_u32 m0, s50, 0
    ds_read_b128 a[144:147], v2 offset:0
    v_mfma_f32_16x16x32_bf16 v[88:91], a[156:159], v[176:179], v[88:91]
    buffer_load_dwordx4 v16, s[12:15], s63 offen offset:0 lds
    v_mfma_f32_16x16x32_bf16 v[108:111], a[160:163], v[172:175], v[108:111]
    s_add_u32 s65, s73, 16384
    ds_read_b128 a[148:151], v2 offset:1024
    v_mfma_f32_16x16x32_bf16 v[112:115], a[160:163], v[176:179], v[112:115]
    buffer_load_dwordx4 v[228:231], v38, s[40:43], s65 offen offset:0 sc1
    v_mfma_f32_16x16x32_bf16 v[116:119], a[164:167], v[172:175], v[116:119]
L_pg_main5:
    s_cbranch_execz L_wret
    ds_read_b128 a[152:155], v2 offset:2048
    v_mfma_f32_16x16x32_bf16 v[120:123], a[164:167], v[176:179], v[120:123]
    s_waitcnt lgkmcnt(3)
    v_mfma_f32_16x16x32_bf16 v[140:143], a[168:171], v[172:175], v[140:143]
    ds_read_b128 a[156:159], v2 offset:3072
    v_mfma_f32_16x16x32_bf16 v[144:147], a[168:171], v[176:179], v[144:147]
    buffer_load_dwordx4 v16, s[12:15], s63 offen offset:1024 lds
    v_mfma_f32_16x16x32_bf16 v[148:151], a[172:175], v[172:175], v[148:151]
    ds_read_b128 a[160:163], v2 offset:4096
    v_mfma_f32_16x16x32_bf16 v[152:155], a[172:175], v[176:179], v[152:155]
    v_mfma_f32_16x16x32_bf16 v[156:159], a[176:179], v[172:175], v[156:159]
    ds_read_b128 a[164:167], v2 offset:5120
    v_mfma_f32_16x16x32_bf16 v[160:163], a[176:179], v[176:179], v[160:163]
    s_waitcnt vmcnt(13)
    buffer_load_dwordx4 v16, s[12:15], s63 offen offset:2048 lds
    v_mfma_f32_16x16x32_bf16 v[60:63], a[180:183], v[180:183], v[60:63]
    ds_read_b128 a[168:171], v2 offset:6144
    v_mfma_f32_16x16x32_bf16 v[64:67], a[180:183], v[184:187], v[64:67]
    buffer_load_dwordx4 v[232:235], v38, s[40:43], s65 offen offset:1024 sc1
    v_mfma_f32_16x16x32_bf16 v[68:71], a[184:187], v[180:183], v[68:71]
    ds_read_b128 a[172:175], v2 offset:7168
    v_mfma_f32_16x16x32_bf16 v[72:75], a[184:187], v[184:187], v[72:75]
    v_mfma_f32_16x16x32_bf16 v[76:79], a[188:191], v[180:183], v[76:79]
    ds_read_b128 a[176:179], v2 offset:8192
    v_mfma_f32_16x16x32_bf16 v[80:83], a[188:191], v[184:187], v[80:83]
    s_waitcnt lgkmcnt(3)
    buffer_load_dwordx4 v16, s[12:15], s63 offen offset:3072 lds
    v_mfma_f32_16x16x32_bf16 v[84:87], a[144:147], v[180:183], v[84:87]
    ds_read_b128 a[180:183], v2 offset:9216
    v_mfma_f32_16x16x32_bf16 v[88:91], a[144:147], v[184:187], v[88:91]
    v_mfma_f32_16x16x32_bf16 v[108:111], a[148:151], v[180:183], v[108:111]
    s_add_u32 m0, s50, 4096
    ds_read_b128 a[184:187], v2 offset:10240
    v_mfma_f32_16x16x32_bf16 v[112:115], a[148:151], v[184:187], v[112:115]
    buffer_load_dwordx4 v17, s[12:15], s63 offen offset:0 lds
    v_mfma_f32_16x16x32_bf16 v[116:119], a[152:155], v[180:183], v[116:119]
    ds_read_b128 a[188:191], v2 offset:11264
    v_mfma_f32_16x16x32_bf16 v[120:123], a[152:155], v[184:187], v[120:123]
    v_mfma_f32_16x16x32_bf16 v[140:143], a[156:159], v[180:183], v[140:143]
    ds_read_b128 a[144:147], v2 offset:12288
    v_mfma_f32_16x16x32_bf16 v[144:147], a[156:159], v[184:187], v[144:147]
    v_mfma_f32_16x16x32_bf16 v[148:151], a[160:163], v[180:183], v[148:151]
    ds_read_b128 a[148:151], v2 offset:13312
    v_mfma_f32_16x16x32_bf16 v[152:155], a[160:163], v[184:187], v[152:155]
    buffer_load_dwordx4 v17, s[12:15], s63 offen offset:1024 lds
    v_mfma_f32_16x16x32_bf16 v[156:159], a[164:167], v[180:183], v[156:159]
    ds_read_b128 a[152:155], v2 offset:14336
    v_mfma_f32_16x16x32_bf16 v[160:163], a[164:167], v[184:187], v[160:163]
    s_waitcnt vmcnt(16) lgkmcnt(3)
    v_mfma_f32_16x16x32_bf16 v[60:63], a[168:171], v[188:191], v[60:63]
    ds_read_b128 a[156:159], v2 offset:15360
    v_mfma_f32_16x16x32_bf16 v[64:67], a[168:171], v[192:195], v[64:67]
    v_mfma_f32_16x16x32_bf16 v[68:71], a[172:175], v[188:191], v[68:71]
    ds_read_b128 a[160:163], v2 offset:16384
    v_mfma_f32_16x16x32_bf16 v[72:75], a[172:175], v[192:195], v[72:75]
    buffer_load_dwordx4 v17, s[12:15], s63 offen offset:2048 lds
    v_mfma_f32_16x16x32_bf16 v[76:79], a[176:179], v[188:191], v[76:79]
    ds_read_b128 a[164:167], v2 offset:17408
    v_mfma_f32_16x16x32_bf16 v[80:83], a[176:179], v[192:195], v[80:83]
    v_mfma_f32_16x16x32_bf16 v[84:87], a[180:183], v[188:191], v[84:87]
    ds_read_b128 a[168:171], v2 offset:18432
    v_mfma_f32_16x16x32_bf16 v[88:91], a[180:183], v[192:195], v[88:91]
    v_mfma_f32_16x16x32_bf16 v[108:111], a[184:187], v[188:191], v[108:111]
    ds_read_b128 a[172:175], v2 offset:19456
    v_mfma_f32_16x16x32_bf16 v[112:115], a[184:187], v[192:195], v[112:115]
    buffer_load_dwordx4 v17, s[12:15], s63 offen offset:3072 lds
    v_mfma_f32_16x16x32_bf16 v[116:119], a[188:191], v[188:191], v[116:119]
    ds_read_b128 a[176:179], v2 offset:20480
    v_mfma_f32_16x16x32_bf16 v[120:123], a[188:191], v[192:195], v[120:123]
    s_waitcnt lgkmcnt(3)
    v_mfma_f32_16x16x32_bf16 v[140:143], a[144:147], v[188:191], v[140:143]
    ds_read_b128 a[180:183], v2 offset:21504
    v_mfma_f32_16x16x32_bf16 v[144:147], a[144:147], v[192:195], v[144:147]
    v_mfma_f32_16x16x32_bf16 v[148:151], a[148:151], v[188:191], v[148:151]
    s_add_u32 m0, s50, 8192
    ds_read_b128 a[184:187], v2 offset:22528
    v_mfma_f32_16x16x32_bf16 v[152:155], a[148:151], v[192:195], v[152:155]
    buffer_load_dwordx4 v18, s[12:15], s63 offen offset:0 lds
    v_mfma_f32_16x16x32_bf16 v[156:159], a[152:155], v[188:191], v[156:159]
    ds_read_b128 a[188:191], v2 offset:23552
    v_mfma_f32_16x16x32_bf16 v[160:163], a[152:155], v[192:195], v[160:163]
    s_waitcnt vmcnt(17)
    v_mfma_f32_16x16x32_bf16 v[60:63], a[156:159], v[196:199], v[60:63]
    s_barrier
    ds_read_b128 a[144:147], v3 offset:8192
    v_mfma_f32_16x16x32_bf16 v[64:67], a[156:159], v[200:203], v[64:67]
    v_mfma_f32_16x16x32_bf16 v[68:71], a[160:163], v[196:199], v[68:71]
    ds_read_b128 a[148:151], v3 offset:9216
    v_mfma_f32_16x16x32_bf16 v[72:75], a[160:163], v[200:203], v[72:75]
    v_mfma_f32_16x16x32_bf16 v[76:79], a[164:167], v[196:199], v[76:79]
    ds_read_b128 a[152:155], v3 offset:10240
    v_mfma_f32_16x16x32_bf16 v[80:83], a[164:167], v[200:203], v[80:83]
    s_waitcnt lgkmcnt(3)
    v_mfma_f32_16x16x32_bf16 v[84:87], a[168:171], v[196:199], v[84:87]
    ds_read_b128 a[156:159], v3 offset:11264
    v_mfma_f32_16x16x32_bf16 v[88:91], a[168:171], v[200:203], v[88:91]
    v_mfma_f32_16x16x32_bf16 v[108:111], a[172:175], v[196:199], v[108:111]
    ds_read_b128 a[160:163], v2 offset:24576
    v_mfma_f32_16x16x32_bf16 v[112:115], a[172:175], v[200:203], v[112:115]
    v_mfma_f32_16x16x32_bf16 v[116:119], a[176:179], v[196:199], v[116:119]
    ds_read_b128 a[164:167], v2 offset:25600
    v_mfma_f32_16x16x32_bf16 v[120:123], a[176:179], v[200:203], v[120:123]
    v_mfma_f32_16x16x32_bf16 v[140:143], a[180:183], v[196:199], v[140:143]
    ds_read_b128 a[168:171], v2 offset:26624
    v_mfma_f32_16x16x32_bf16 v[144:147], a[180:183], v[200:203], v[144:147]
    v_mfma_f32_16x16x32_bf16 v[148:151], a[184:187], v[196:199], v[148:151]
    ds_read_b128 a[172:175], v2 offset:27648
    v_mfma_f32_16x16x32_bf16 v[152:155], a[184:187], v[200:203], v[152:155]
    v_mfma_f32_16x16x32_bf16 v[156:159], a[188:191], v[196:199], v[156:159]
    ds_read_b128 a[176:179], v2 offset:28672
    v_mfma_f32_16x16x32_bf16 v[160:163], a[188:191], v[200:203], v[160:163]
    s_waitcnt vmcnt(6) lgkmcnt(3)
    v_mfma_f32_16x16x32_bf16 v[156:159], a[144:147], v[204:207], v[156:159]
    ds_read_b128 a[180:183], v2 offset:29696
    v_mfma_f32_16x16x32_bf16 v[160:163], a[144:147], v[208:211], v[160:163]
    v_mfma_f32_16x16x32_bf16 v[156:159], a[148:151], v[212:215], v[156:159]
    ds_read_b128 a[184:187], v2 offset:30720
    v_mfma_f32_16x16x32_bf16 v[160:163], a[148:151], v[216:219], v[160:163]
    v_mfma_f32_16x16x32_bf16 v[156:159], a[152:155], v[220:223], v[156:159]
    ds_read_b128 a[188:191], v2 offset:31744
    v_mfma_f32_16x16x32_bf16 v[160:163], a[152:155], v[224:227], v[160:163]
    s_add_u32 s54, s63, 36864
    v_mfma_f32_16x16x32_bf16 v[156:159], a[156:159], v[228:231], v[156:159]
    s_add_u32 m0, s50, 36864
    ds_read_b128 a[144:147], v2 offset:32768
    v_mfma_f32_16x16x32_bf16 v[160:163], a[156:159], v[232:235], v[160:163]
    buffer_load_dwordx4 v16, s[12:15], s54 offen offset:0 lds
    v_mfma_f32_16x16x32_bf16 v[60:63], a[160:163], v[204:207], v[60:63]
    ds_read_b128 a[148:151], v2 offset:33792
    v_mfma_f32_16x16x32_bf16 v[64:67], a[160:163], v[208:211], v[64:67]
    v_mfma_f32_16x16x32_bf16 v[60:63], a[164:167], v[212:215], v[60:63]
    ds_read_b128 a[152:155], v2 offset:34816
    v_mfma_f32_16x16x32_bf16 v[64:67], a[164:167], v[216:219], v[64:67]
    s_waitcnt lgkmcnt(3)
    v_cvt_pk_bf16_f32 v20, v156, v157
    v_cvt_pk_bf16_f32 v21, v158, v159
    v_mfma_f32_16x16x32_bf16 v[60:63], a[168:171], v[220:223], v[60:63]
    ds_read_b128 a[156:159], v2 offset:35840
    v_cvt_pk_bf16_f32 v22, v160, v161
    v_mfma_f32_16x16x32_bf16 v[64:67], a[168:171], v[224:227], v[64:67]
    buffer_load_dwordx4 v16, s[12:15], s54 offen offset:1024 lds
    v_mfma_f32_16x16x32_bf16 v[60:63], a[172:175], v[228:231], v[60:63]
    ds_read_b128 a[160:163], v2 offset:36864
    v_cvt_pk_bf16_f32 v23, v162, v163
    v_mfma_f32_16x16x32_bf16 v[64:67], a[172:175], v[232:235], v[64:67]
    buffer_store_dwordx2 v[20:21], v36, s[28:31], s51 offen sc1
    v_mfma_f32_16x16x32_bf16 v[68:71], a[176:179], v[204:207], v[68:71]
    ds_read_b128 a[164:167], v2 offset:37888
    v_mfma_f32_16x16x32_bf16 v[72:75], a[176:179], v[208:211], v[72:75]
    buffer_load_dwordx4 v16, s[12:15], s54 offen offset:2048 lds
    v_mfma_f32_16x16x32_bf16 v[68:71], a[180:183], v[212:215], v[68:71]
    ds_read_b128 a[168:171], v2 offset:38912
    v_mfma_f32_16x16x32_bf16 v[72:75], a[180:183], v[216:219], v[72:75]
    buffer_store_dwordx2 v[22:23], v36, s[28:31], s52 offen sc1
    v_cvt_pk_bf16_f32 v52, v60, v61
    v_mfma_f32_16x16x32_bf16 v[68:71], a[184:187], v[220:223], v[68:71]
    ds_read_b128 a[172:175], v2 offset:39936
    v_cvt_pk_bf16_f32 v53, v62, v63
    v_mfma_f32_16x16x32_bf16 v[72:75], a[184:187], v[224:227], v[72:75]
    v_cvt_pk_bf16_f32 v56, v64, v65
    v_cvt_pk_bf16_f32 v57, v66, v67
    v_mfma_f32_16x16x32_bf16 v[68:71], a[188:191], v[228:231], v[68:71]
    ds_read_b128 a[176:179], v2 offset:40960
    v_mfma_f32_16x16x32_bf16 v[72:75], a[188:191], v[232:235], v[72:75]
    s_waitcnt lgkmcnt(3)
    buffer_load_dwordx4 v16, s[12:15], s54 offen offset:3072 lds
    v_mfma_f32_16x16x32_bf16 v[76:79], a[144:147], v[204:207], v[76:79]
    ds_read_b128 a[180:183], v2 offset:41984
    v_mfma_f32_16x16x32_bf16 v[80:83], a[144:147], v[208:211], v[80:83]
    v_mfma_f32_16x16x32_bf16 v[76:79], a[148:151], v[212:215], v[76:79]
    s_add_u32 m0, s50, 40960
    ds_read_b128 a[184:187], v2 offset:43008
    v_mfma_f32_16x16x32_bf16 v[80:83], a[148:151], v[216:219], v[80:83]
    buffer_load_dwordx4 v17, s[12:15], s54 offen offset:0 lds
    v_mfma_f32_16x16x32_bf16 v[76:79], a[152:155], v[220:223], v[76:79]
    ds_read_b128 a[188:191], v2 offset:44032
    v_cvt_pk_bf16_f32 v54, v68, v69
    v_mfma_f32_16x16x32_bf16 v[80:83], a[152:155], v[224:227], v[80:83]
    v_cvt_pk_bf16_f32 v55, v70, v71
    v_cvt_pk_bf16_f32 v58, v72, v73
    v_mfma_f32_16x16x32_bf16 v[76:79], a[156:159], v[228:231], v[76:79]
    ds_read_b128 a[144:147], v2 offset:45056
    v_cvt_pk_bf16_f32 v59, v74, v75
    v_mfma_f32_16x16x32_bf16 v[80:83], a[156:159], v[232:235], v[80:83]
    buffer_store_dwordx4 v[52:55], v35, s[28:31], s51 offen offset:0 sc1
    v_mfma_f32_16x16x32_bf16 v[84:87], a[160:163], v[204:207], v[84:87]
    ds_read_b128 a[148:151], v2 offset:46080
    v_mfma_f32_16x16x32_bf16 v[88:91], a[160:163], v[208:211], v[88:91]
    buffer_load_dwordx4 v17, s[12:15], s54 offen offset:1024 lds
    v_mfma_f32_16x16x32_bf16 v[84:87], a[164:167], v[212:215], v[84:87]
    ds_read_b128 a[152:155], v2 offset:47104
    v_mfma_f32_16x16x32_bf16 v[88:91], a[164:167], v[216:219], v[88:91]
    s_waitcnt lgkmcnt(3)
    buffer_store_dwordx4 v[56:59], v35, s[28:31], s52 offen offset:0 sc1
    v_cvt_pk_bf16_f32 v52, v76, v77
    v_mfma_f32_16x16x32_bf16 v[84:87], a[168:171], v[220:223], v[84:87]
    ds_read_b128 a[156:159], v2 offset:48128
    v_cvt_pk_bf16_f32 v53, v78, v79
    v_mfma_f32_16x16x32_bf16 v[88:91], a[168:171], v[224:227], v[88:91]
    v_cvt_pk_bf16_f32 v56, v80, v81
    v_cvt_pk_bf16_f32 v57, v82, v83
    v_mfma_f32_16x16x32_bf16 v[84:87], a[172:175], v[228:231], v[84:87]
    ds_read_b128 a[160:163], v3 offset:0
    v_mfma_f32_16x16x32_bf16 v[88:91], a[172:175], v[232:235], v[88:91]
    buffer_load_dwordx4 v17, s[12:15], s54 offen offset:2048 lds
    v_mfma_f32_16x16x32_bf16 v[108:111], a[176:179], v[204:207], v[108:111]
    ds_read_b128 a[164:167], v3 offset:1024
    v_mfma_f32_16x16x32_bf16 v[112:115], a[176:179], v[208:211], v[112:115]
    v_mfma_f32_16x16x32_bf16 v[108:111], a[180:183], v[212:215], v[108:111]
    ds_read_b128 a[168:171], v3 offset:2048
    v_mfma_f32_16x16x32_bf16 v[112:115], a[180:183], v[216:219], v[112:115]
    v_cvt_pk_bf16_f32 v54, v84, v85
    v_cvt_pk_bf16_f32 v55, v86, v87
    v_mfma_f32_16x16x32_bf16 v[108:111], a[184:187], v[220:223], v[108:111]
    ds_read_b128 a[172:175], v3 offset:3072
    v_cvt_pk_bf16_f32 v58, v88, v89
    v_mfma_f32_16x16x32_bf16 v[112:115], a[184:187], v[224:227], v[112:115]
    buffer_load_dwordx4 v17, s[12:15], s54 offen offset:3072 lds
    v_mfma_f32_16x16x32_bf16 v[108:111], a[188:191], v[228:231], v[108:111]
    ds_read_b128 a[176:179], v3 offset:4096
    v_cvt_pk_bf16_f32 v59, v90, v91
    v_mfma_f32_16x16x32_bf16 v[112:115], a[188:191], v[232:235], v[112:115]
    s_waitcnt lgkmcnt(3)
    buffer_store_dwordx4 v[52:55], v35, s[28:31], s51 offen offset:128 sc1
    v_mfma_f32_16x16x32_bf16 v[116:119], a[144:147], v[204:207], v[116:119]
    ds_read_b128 a[180:183], v3 offset:5120
    v_mfma_f32_16x16x32_bf16 v[120:123], a[144:147], v[208:211], v[120:123]
    buffer_store_dwordx4 v[56:59], v35, s[28:31], s52 offen offset:128 sc1
    v_mfma_f32_16x16x32_bf16 v[116:119], a[148:151], v[212:215], v[116:119]
    s_add_u32 m0, s50, 45056
    ds_read_b128 a[184:187], v3 offset:6144
    v_mfma_f32_16x16x32_bf16 v[120:123], a[148:151], v[216:219], v[120:123]
    buffer_load_dwordx4 v18, s[12:15], s54 offen offset:0 lds
    v_mfma_f32_16x16x32_bf16 v[116:119], a[152:155], v[220:223], v[116:119]
    ds_read_b128 a[188:191], v3 offset:7168
    v_cvt_pk_bf16_f32 v52, v108, v109
    v_mfma_f32_16x16x32_bf16 v[120:123], a[152:155], v[224:227], v[120:123]
    v_cvt_pk_bf16_f32 v53, v110, v111
    v_cvt_pk_bf16_f32 v56, v112, v113
    v_mfma_f32_16x16x32_bf16 v[116:119], a[156:159], v[228:231], v[116:119]
    v_cvt_pk_bf16_f32 v57, v114, v115
    v_mfma_f32_16x16x32_bf16 v[120:123], a[156:159], v[232:235], v[120:123]
    v_mfma_f32_16x16x32_bf16 v[140:143], a[160:163], v[204:207], v[140:143]
    v_mfma_f32_16x16x32_bf16 v[144:147], a[160:163], v[208:211], v[144:147]
    v_mfma_f32_16x16x32_bf16 v[140:143], a[164:167], v[212:215], v[140:143]
    v_mfma_f32_16x16x32_bf16 v[144:147], a[164:167], v[216:219], v[144:147]
    s_waitcnt lgkmcnt(0)
    v_mfma_f32_16x16x32_bf16 v[140:143], a[168:171], v[220:223], v[140:143]
    v_cvt_pk_bf16_f32 v54, v116, v117
    v_cvt_pk_bf16_f32 v55, v118, v119
    v_mfma_f32_16x16x32_bf16 v[144:147], a[168:171], v[224:227], v[144:147]
    buffer_store_dwordx4 v[52:55], v35, s[28:31], s51 offen offset:256 sc1
    v_cvt_pk_bf16_f32 v58, v120, v121
    v_mfma_f32_16x16x32_bf16 v[140:143], a[172:175], v[228:231], v[140:143]
    v_cvt_pk_bf16_f32 v59, v122, v123
    v_mfma_f32_16x16x32_bf16 v[144:147], a[172:175], v[232:235], v[144:147]
    buffer_store_dwordx4 v[56:59], v35, s[28:31], s52 offen offset:256 sc1
    v_mfma_f32_16x16x32_bf16 v[148:151], a[176:179], v[204:207], v[148:151]
    v_mfma_f32_16x16x32_bf16 v[152:155], a[176:179], v[208:211], v[152:155]
    v_mfma_f32_16x16x32_bf16 v[148:151], a[180:183], v[212:215], v[148:151]
    v_mfma_f32_16x16x32_bf16 v[152:155], a[180:183], v[216:219], v[152:155]
    v_mfma_f32_16x16x32_bf16 v[148:151], a[184:187], v[220:223], v[148:151]
    v_mfma_f32_16x16x32_bf16 v[152:155], a[184:187], v[224:227], v[152:155]
    v_mfma_f32_16x16x32_bf16 v[148:151], a[188:191], v[228:231], v[148:151]
    v_mfma_f32_16x16x32_bf16 v[152:155], a[188:191], v[232:235], v[152:155]
    v_cvt_pk_bf16_f32 v52, v140, v141
    v_cvt_pk_bf16_f32 v53, v142, v143
    v_cvt_pk_bf16_f32 v56, v144, v145
    v_cvt_pk_bf16_f32 v57, v146, v147
    s_nop 2
    v_cvt_pk_bf16_f32 v54, v148, v149
    v_cvt_pk_bf16_f32 v55, v150, v151
    buffer_store_dwordx4 v[52:55], v35, s[28:31], s51 offen offset:384 sc1
    v_cvt_pk_bf16_f32 v58, v152, v153
    v_cvt_pk_bf16_f32 v59, v154, v155
    buffer_store_dwordx4 v[56:59], v35, s[28:31], s52 offen offset:384 sc1
    v_bfe_u32 v144, v0, 1, 3
    v_and_b32 v145, 1, v0
    v_lshlrev_b32 v145, 4, v145
    s_mov_b32 s8, 0x3f80
    v_lshlrev_b32 v145, v145, s8
    v_cmp_eq_u32 vcc, 0, v144
    s_nop 1
    v_cndmask_b32 v80, 0, v145, vcc
    v_cmp_eq_u32 vcc, 1, v144
    s_nop 1
    v_cndmask_b32 v81, 0, v145, vcc
    v_cmp_eq_u32 vcc, 2, v144
    s_nop 1
    v_cndmask_b32 v82, 0, v145, vcc
    v_cmp_eq_u32 vcc, 3, v144
    s_nop 1
    v_cndmask_b32 v83, 0, v145, vcc
    v_cmp_eq_u32 vcc, 4, v144
    s_nop 1
    v_cndmask_b32 v84, 0, v145, vcc
    v_cmp_eq_u32 vcc, 5, v144
    s_nop 1
    v_cndmask_b32 v85, 0, v145, vcc
    v_cmp_eq_u32 vcc, 6, v144
    s_nop 1
    v_cndmask_b32 v86, 0, v145, vcc
    v_cmp_eq_u32 vcc, 7, v144
    s_nop 1
    v_cndmask_b32 v87, 0, v145, vcc
    v_lshlrev_b32 v124, 16, v236
    v_and_b32 v125, 0xffff0000, v236
    v_lshlrev_b32 v126, 16, v237
    v_and_b32 v127, 0xffff0000, v237
    v_lshlrev_b32 v128, 16, v238
    v_and_b32 v129, 0xffff0000, v238
    v_lshlrev_b32 v130, 16, v239
    v_and_b32 v131, 0xffff0000, v239
    v_lshlrev_b32 v132, 16, v240
    v_and_b32 v133, 0xffff0000, v240
    v_lshlrev_b32 v134, 16, v241
    v_and_b32 v135, 0xffff0000, v241
    v_lshlrev_b32 v136, 16, v242
    v_and_b32 v137, 0xffff0000, v242
    v_lshlrev_b32 v138, 16, v243
    v_and_b32 v139, 0xffff0000, v243
    v_lshlrev_b32 v140, 16, v244
    v_and_b32 v141, 0xffff0000, v244
    v_lshlrev_b32 v142, 16, v245
    v_and_b32 v143, 0xffff0000, v245
    s_waitcnt vmcnt(0)
    s_barrier
    s_add_u32 s55, s67, 7
    v_mov_b32 v42, s55
    buffer_store_dword v42, v40, s[32:35], 0 offen sc1
    v_mov_b32 v180, 0
    v_mov_b32 v181, 0
    v_mov_b32 v182, 0
    v_mov_b32 v183, 0
    ds_read_u16 v164, v49 offset:0
    ds_read_u16 v165, v49 offset:16
    ds_read_u16 v166, v49 offset:32
    ds_read_u16 v167, v49 offset:48
    ds_read_u16 v168, v49 offset:2304
    ds_read_u16 v169, v49 offset:2320
    ds_read_u16 v170, v49 offset:2336
    ds_read_u16 v171, v49 offset:2352
    ds_read_u16 v172, v49 offset:4608
    ds_read_u16 v173, v49 offset:4624
    ds_read_u16 v174, v49 offset:4640
    ds_read_u16 v175, v49 offset:4656
    ds_read_u16 v176, v49 offset:6912
    ds_read_u16 v177, v49 offset:6928
    ds_read_u16 v178, v49 offset:6944
    ds_read_u16 v179, v49 offset:6960
    s_mov_b64 exec, 0xffffffff
    ds_read_u16 v180, v49 offset:9216
    ds_read_u16 v181, v49 offset:9232
    ds_read_u16 v182, v49 offset:9248
    ds_read_u16 v183, v49 offset:9264
    s_mov_b64 exec, -1
    s_mov_b32 s68, 0
L_spin_fin:
    buffer_load_dword v43, v41, s[32:35], 0 offen sc1
    s_add_u32 s68, s68, 1
    s_waitcnt vmcnt(0)
    v_cmp_gt_u32 vcc, s55, v43
    s_cmp_ge_u32 s68, 100000
    s_cbranch_scc1 L_spun_fin
    s_cbranch_vccz L_spun_fin
    s_sleep 1
    s_branch L_spin_fin
L_spun_fin:
    buffer_load_dwordx4 a[0:3], v39, s[28:31], s62 offen offset:0 sc1
    buffer_load_dwordx4 a[4:7], v39, s[28:31], s62 offen offset:256 sc1
    buffer_load_dwordx4 a[8:11], v39, s[28:31], s62 offen offset:512 sc1
    buffer_load_dwordx4 a[12:15], v39, s[28:31], s62 offen offset:768 sc1
    buffer_load_dwordx4 a[16:19], v39, s[28:31], s62 offen offset:1024 sc1
    buffer_load_dwordx4 a[20:23], v39, s[28:31], s62 offen offset:1280 sc1
    buffer_load_dwordx4 a[24:27], v39, s[28:31], s62 offen offset:1536 sc1
    buffer_load_dwordx4 a[28:31], v39, s[28:31], s62 offen offset:1792 sc1
    buffer_load_dwordx4 a[32:35], v39, s[28:31], s62 offen offset:2048 sc1
    s_waitcnt vmcnt(8)
    v_mfma_f32_16x16x32_bf16 v[60:63], v[80:83], a[0:3], 0
    s_waitcnt vmcnt(7)
    v_mfma_f32_16x16x32_bf16 v[60:63], v[84:87], a[4:7], v[60:63]
    s_waitcnt vmcnt(6)
    v_mfma_f32_16x16x32_bf16 v[64:67], v[80:83], a[8:11], 0
    s_waitcnt vmcnt(5)
    v_mfma_f32_16x16x32_bf16 v[64:67], v[84:87], a[12:15], v[64:67]
    s_waitcnt vmcnt(4)
    v_mfma_f32_16x16x32_bf16 v[68:71], v[80:83], a[16:19], 0
    s_waitcnt vmcnt(3)
    v_mfma_f32_16x16x32_bf16 v[68:71], v[84:87], a[20:23], v[68:71]
    s_waitcnt vmcnt(2)
    v_mfma_f32_16x16x32_bf16 v[72:75], v[80:83], a[24:27], 0
    s_waitcnt vmcnt(1)
    v_mfma_f32_16x16x32_bf16 v[72:75], v[84:87], a[28:31], v[72:75]
    s_waitcnt vmcnt(0)
    v_mfma_f32_16x16x32_bf16 v[76:79], v[80:83], a[32:35], 0
    s_nop 7
    v_cvt_pk_bf16_f32 v112, v60, v61
    v_cvt_pk_bf16_f32 v113, v62, v63
    v_cvt_pk_bf16_f32 v114, v64, v65
    v_cvt_pk_bf16_f32 v115, v66, v67
    v_cvt_pk_bf16_f32 v116, v68, v69
    v_cvt_pk_bf16_f32 v117, v70, v71
    v_cvt_pk_bf16_f32 v118, v72, v73
    v_cvt_pk_bf16_f32 v119, v74, v75
    v_cvt_pk_bf16_f32 v120, v76, v77
    v_cvt_pk_bf16_f32 v121, v78, v79
    v_lshlrev_b32 v92, 16, v112
    v_and_b32 v93, 0xffff0000, v112
    v_lshlrev_b32 v94, 16, v113
    v_and_b32 v95, 0xffff0000, v113
    v_lshlrev_b32 v96, 16, v114
    v_and_b32 v97, 0xffff0000, v114
    v_lshlrev_b32 v98, 16, v115
    v_and_b32 v99, 0xffff0000, v115
    v_lshlrev_b32 v100, 16, v116
    v_and_b32 v101, 0xffff0000, v116
    v_lshlrev_b32 v102, 16, v117
    v_and_b32 v103, 0xffff0000, v117
    v_lshlrev_b32 v104, 16, v118
    v_and_b32 v105, 0xffff0000, v118
    v_lshlrev_b32 v106, 16, v119
    v_and_b32 v107, 0xffff0000, v119
    v_lshlrev_b32 v108, 16, v120
    v_and_b32 v109, 0xffff0000, v120
    v_lshlrev_b32 v110, 16, v121
    v_and_b32 v111, 0xffff0000, v121
    v_pk_add_f32 v[124:125], v[124:125], v[92:93]
    v_pk_add_f32 v[126:127], v[126:127], v[94:95]
    v_pk_add_f32 v[128:129], v[128:129], v[96:97]
    v_pk_add_f32 v[130:131], v[130:131], v[98:99]
    v_pk_add_f32 v[132:133], v[132:133], v[100:101]
    v_pk_add_f32 v[134:135], v[134:135], v[102:103]
    v_pk_add_f32 v[136:137], v[136:137], v[104:105]
    v_pk_add_f32 v[138:139], v[138:139], v[106:107]
    v_pk_add_f32 v[140:141], v[140:141], v[108:109]
    v_pk_add_f32 v[142:143], v[142:143], v[110:111]
    s_cmp_lg_u32 s61, 0
    s_cbranch_scc1 L_main_fin
    v_cvt_pk_bf16_f32 v236, v124, v125
    v_cvt_pk_bf16_f32 v237, v126, v127
    v_cvt_pk_bf16_f32 v238, v128, v129
    v_cvt_pk_bf16_f32 v239, v130, v131
    v_cvt_pk_bf16_f32 v240, v132, v133
    v_cvt_pk_bf16_f32 v241, v134, v135
    v_cvt_pk_bf16_f32 v242, v136, v137
    v_cvt_pk_bf16_f32 v243, v138, v139
    v_cvt_pk_bf16_f32 v244, v140, v141
    v_cvt_pk_bf16_f32 v245, v142, v143
    v_lshlrev_b32 v124, 16, v236
    v_and_b32 v125, 0xffff0000, v236
    v_lshlrev_b32 v126, 16, v237
    v_and_b32 v127, 0xffff0000, v237
    v_lshlrev_b32 v128, 16, v238
    v_and_b32 v129, 0xffff0000, v238
    v_lshlrev_b32 v130, 16, v239
    v_and_b32 v131, 0xffff0000, v239
    v_lshlrev_b32 v132, 16, v240
    v_and_b32 v133, 0xffff0000, v240
    v_lshlrev_b32 v134, 16, v241
    v_and_b32 v135, 0xffff0000, v241
    v_lshlrev_b32 v136, 16, v242
    v_and_b32 v137, 0xffff0000, v242
    v_lshlrev_b32 v138, 16, v243
    v_and_b32 v139, 0xffff0000, v243
    v_lshlrev_b32 v140, 16, v244
    v_and_b32 v141, 0xffff0000, v244
    v_lshlrev_b32 v142, 16, v245
    v_and_b32 v143, 0xffff0000, v245
    s_mov_b32 s61, 1
    s_mov_b32 s67, 16
    s_mov_b32 s20, 2130706432
    s_mov_b32 s22, 0x7ff
    s_mov_b32 s21, 2130706432
    s_mov_b32 s36, 2130706432
    s_mov_b32 s38, 2130706432
    s_mov_b32 s75, 99
    s_mov_b32 s5, 99
    s_add_u32 s24, s24, 3145728
    s_addc_u32 s25, s25, 0
    s_add_u32 s28, s28, 10485760
    s_addc_u32 s29, s29, 0
    s_add_u32 s40, s40, 20971520
    s_addc_u32 s41, s41, 0
    s_branch L_main_gate
L_main_cold:
L_slowe:
    s_mov_b32 s68, 0
L_spin_se:
    buffer_load_dword v43, v44, s[32:35], 0 offen sc1
    s_add_u32 s68, s68, 1
    s_waitcnt vmcnt(0)
    v_cmp_gt_u32 vcc, s69, v43
    s_cmp_ge_u32 s68, 100000
    s_cbranch_scc1 L_spun_se
    s_cbranch_vccz L_spun_se
    s_sleep 1
    s_branch L_spin_se
L_spun_se:
    s_branch L_backe
L_slowl:
    s_mov_b32 s68, 0
L_spin_sl:
    buffer_load_dword v43, v44, s[32:35], 0 offen sc1
    s_add_u32 s68, s68, 1
    s_waitcnt vmcnt(0)
    v_cmp_gt_u32 vcc, s69, v43
    s_cmp_ge_u32 s68, 100000
    s_cbranch_scc1 L_spun_sl
    s_cbranch_vccz L_spun_sl
    s_sleep 1
    s_branch L_spin_sl
L_spun_sl:
    s_branch L_backl
L_main_xp:
    s_mov_b32 s9, s17
    s_add_u32 s8, s9, 18432
    buffer_load_dwordx4 a[0:3], v38, s[24:27], s9 offen offset:0 sc1
    buffer_load_dwordx4 a[4:7], v38, s[24:27], s8 offen offset:0 sc1
    buffer_load_dwordx4 a[8:11], v38, s[24:27], s9 offen offset:1024 sc1
    buffer_load_dwordx4 a[12:15], v38, s[24:27], s8 offen offset:1024 sc1
    buffer_load_dwordx4 a[16:19], v38, s[24:27], s9 offen offset:2048 sc1
    buffer_load_dwordx4 a[20:23], v38, s[24:27], s8 offen offset:2048 sc1
    buffer_load_dwordx4 a[24:27], v38, s[24:27], s9 offen offset:3072 sc1
    buffer_load_dwordx4 a[28:31], v38, s[24:27], s8 offen offset:3072 sc1
    s_add_u32 s9, s9, 4096
    s_add_u32 s8, s8, 4096
    buffer_load_dwordx4 a[32:35], v38, s[24:27], s9 offen offset:0 sc1
    buffer_load_dwordx4 a[36:39], v38, s[24:27], s8 offen offset:0 sc1
    buffer_load_dwordx4 a[40:43], v38, s[24:27], s9 offen offset:1024 sc1
    buffer_load_dwordx4 a[44:47], v38, s[24:27], s8 offen offset:1024 sc1
    s_add_u32 s68, s68, 1
    s_waitcnt vmcnt(0)
    s_waitcnt vmcnt(10)
    v_accvgpr_read_b32 v52, a0
    v_accvgpr_read_b32 v53, a4
    v_max_u32 v224, v52, v53
    s_waitcnt vmcnt(8)
    v_accvgpr_read_b32 v54, a8
    v_accvgpr_read_b32 v55, a12
    v_max3_u32 v224, v54, v55, v224
    v_cmp_eq_u32 vcc, -1, v224
    s_cmp_ge_u32 s68, 100000
    s_cbranch_vccz L_main_xq
    s_cbranch_scc0 L_main_xp
    s_branch L_main_xq
L_fw_slow:
    s_mov_b32 s68, 0
L_fw_poll:
    buffer_load_dwordx2 v[14:15], v50, s[32:35], 0 offen sc1
    s_add_u32 s68, s68, 1
    s_waitcnt vmcnt(0)
    v_cmp_ne_u64 vcc, s[100:101], v[14:15]
    s_cmp_ge_u32 s68, 100000
    s_cbranch_scc1 L_fw_back
    s_cbranch_vccnz L_fw_poll
    s_branch L_fw_back
L_xs2:
    s_mov_b32 s68, 0
    s_add_u32 s18, s17, 0
    s_add_u32 s19, s18, 18432
L_xl2:
    buffer_load_dwordx4 a[16:19], v38, s[24:27], s18 offen offset:2048 sc1
    buffer_load_dwordx4 a[20:23], v38, s[24:27], s19 offen offset:2048 sc1
    s_add_u32 s68, s68, 1
    s_waitcnt vmcnt(0)
    v_accvgpr_read_b32 v52, a16
    v_accvgpr_read_b32 v53, a20
    v_max_u32 v52, v52, v53
    v_cmp_eq_u32 vcc, -1, v52
    s_cmp_ge_u32 s68, 100000
    s_cbranch_scc1 L_xb2
    s_cbranch_vccnz L_xl2
    s_branch L_xb2
L_xs3:
    s_mov_b32 s68, 0
    s_add_u32 s18, s17, 0
    s_add_u32 s19, s18, 18432
L_xl3:
    buffer_load_dwordx4 a[24:27], v38, s[24:27], s18 offen offset:3072 sc1
    buffer_load_dwordx4 a[28:31], v38, s[24:27], s19 offen offset:3072 sc1
    s_add_u32 s68, s68, 1
    s_waitcnt vmcnt(0)
    v_accvgpr_read_b32 v56, a24
    v_accvgpr_read_b32 v57, a28
    v_max_u32 v56, v56, v57
    v_cmp_eq_u32 vcc, -1, v56
    s_cmp_ge_u32 s68, 100000
    s_cbranch_scc1 L_xb3
    s_cbranch_vccnz L_xl3
    s_branch L_xb3
L_xs4:
    s_mov_b32 s68, 0
    s_add_u32 s18, s17, 4096
    s_add_u32 s19, s18, 18432
L_xl4:
    buffer_load_dwordx4 a[32:35], v38, s[24:27], s18 offen offset:0 sc1
    buffer_load_dwordx4 a[36:39], v38, s[24:27], s19 offen offset:0 sc1
    s_add_u32 s68, s68, 1
    s_waitcnt vmcnt(0)
    v_accvgpr_read_b32 v52, a32
    v_accvgpr_read_b32 v53, a36
    v_max_u32 v52, v52, v53
    v_cmp_eq_u32 vcc, -1, v52
    s_cmp_ge_u32 s68, 100000
    s_cbranch_scc1 L_xb4
    s_cbranch_vccnz L_xl4
    s_branch L_xb4
L_xs5:
    s_mov_b32 s68, 0
    s_add_u32 s18, s17, 4096
    s_add_u32 s19, s18, 18432
L_xl5:
    buffer_load_dwordx4 a[40:43], v38, s[24:27], s18 offen offset:1024 sc1
    buffer_load_dwordx4 a[44:47], v38, s[24:27], s19 offen offset:1024 sc1
    s_add_u32 s68, s68, 1
    s_waitcnt vmcnt(0)
    v_accvgpr_read_b32 v56, a40
    v_accvgpr_read_b32 v57, a44
    v_max_u32 v56, v56, v57
    v_cmp_eq_u32 vcc, -1, v56
    s_cmp_ge_u32 s68, 100000
    s_cbranch_scc1 L_xb5
    s_cbranch_vccnz L_xl5
    s_branch L_xb5
L_xs6:
    s_mov_b32 s68, 0
    s_add_u32 s18, s17, 4096
    s_add_u32 s19, s18, 18432
L_xl6:
    buffer_load_dwordx4 a[48:51], v38, s[24:27], s18 offen offset:2048 sc1
    buffer_load_dwordx4 a[52:55], v38, s[24:27], s19 offen offset:2048 sc1
    s_add_u32 s68, s68, 1
    s_waitcnt vmcnt(0)
    v_accvgpr_read_b32 v52, a48
    v_accvgpr_read_b32 v53, a52
    v_max_u32 v52, v52, v53
    v_cmp_eq_u32 vcc, -1, v52
    s_cmp_ge_u32 s68, 100000
    s_cbranch_scc1 L_xb6
    s_cbranch_vccnz L_xl6
    s_branch L_xb6
L_xs7:
    s_mov_b32 s68, 0
    s_add_u32 s18, s17, 4096
    s_add_u32 s19, s18, 18432
L_xl7:
    buffer_load_dwordx4 a[56:59], v38, s[24:27], s18 offen offset:3072 sc1
    buffer_load_dwordx4 a[60:63], v38, s[24:27], s19 offen offset:3072 sc1
    s_add_u32 s68, s68, 1
    s_waitcnt vmcnt(0)
    v_accvgpr_read_b32 v56, a56
    v_accvgpr_read_b32 v57, a60
    v_max_u32 v56, v56, v57
    v_cmp_eq_u32 vcc, -1, v56
    s_cmp_ge_u32 s68, 100000
    s_cbranch_scc1 L_xb7
    s_cbranch_vccnz L_xl7
    s_branch L_xb7
L_xs8:
    s_mov_b32 s68, 0
    s_add_u32 s18, s17, 8192
    s_add_u32 s19, s18, 18432
L_xl8:
    buffer_load_dwordx4 a[64:67], v38, s[24:27], s18 offen offset:0 sc1
    buffer_load_dwordx4 a[68:71], v38, s[24:27], s19 offen offset:0 sc1
    s_add_u32 s68, s68, 1
    s_waitcnt vmcnt(0)
    v_accvgpr_read_b32 v52, a64
    v_accvgpr_read_b32 v53, a68
    v_max_u32 v52, v52, v53
    v_cmp_eq_u32 vcc, -1, v52
    s_cmp_ge_u32 s68, 100000
    s_cbranch_scc1 L_xb8
    s_cbranch_vccnz L_xl8
    s_branch L_xb8
L_xs9:
    s_mov_b32 s68, 0
    s_add_u32 s18, s17, 8192
    s_add_u32 s19, s18, 18432
L_xl9:
    buffer_load_dwordx4 a[72:75], v38, s[24:27], s18 offen offset:1024 sc1
    buffer_load_dwordx4 a[76:79], v38, s[24:27], s19 offen offset:1024 sc1
    s_add_u32 s68, s68, 1
    s_waitcnt vmcnt(0)
    v_accvgpr_read_b32 v56, a72
    v_accvgpr_read_b32 v57, a76
    v_max_u32 v56, v56, v57
    v_cmp_eq_u32 vcc, -1, v56
    s_cmp_ge_u32 s68, 100000
    s_cbranch_scc1 L_xb9
    s_cbranch_vccnz L_xl9
    s_branch L_xb9
L_xs10:
    s_mov_b32 s68, 0
    s_add_u32 s18, s17, 8192
    s_add_u32 s19, s18, 18432
L_xl10:
    buffer_load_dwordx4 a[80:83], v38, s[24:27], s18 offen offset:2048 sc1
    buffer_load_dwordx4 a[84:87], v38, s[24:27], s19 offen offset:2048 sc1
    s_add_u32 s68, s68, 1
    s_waitcnt vmcnt(0)
    v_accvgpr_read_b32 v52, a80
    v_accvgpr_read_b32 v53, a84
    v_max_u32 v52, v52, v53
    v_cmp_eq_u32 vcc, -1, v52
    s_cmp_ge_u32 s68, 100000
    s_cbranch_scc1 L_xb10
    s_cbranch_vccnz L_xl10
    s_branch L_xb10
L_xs11:
    s_mov_b32 s68, 0
    s_add_u32 s18, s17, 8192
    s_add_u32 s19, s18, 18432
L_xl11:
    buffer_load_dwordx4 a[88:91], v38, s[24:27], s18 offen offset:3072 sc1
    buffer_load_dwordx4 a[92:95], v38, s[24:27], s19 offen offset:3072 sc1
    s_add_u32 s68, s68, 1
    s_waitcnt vmcnt(0)
    v_accvgpr_read_b32 v56, a88
    v_accvgpr_read_b32 v57, a92
    v_max_u32 v56, v56, v57
    v_cmp_eq_u32 vcc, -1, v56
    s_cmp_ge_u32 s68, 100000
    s_cbranch_scc1 L_xb11
    s_cbranch_vccnz L_xl11
    s_branch L_xb11
L_xs12:
    s_mov_b32 s68, 0
    s_add_u32 s18, s17, 12288
    s_add_u32 s19, s18, 18432
L_xl12:
    buffer_load_dwordx4 a[96:99], v38, s[24:27], s18 offen offset:0 sc1
    buffer_load_dwordx4 a[100:103], v38, s[24:27], s19 offen offset:0 sc1
    s_add_u32 s68, s68, 1
    s_waitcnt vmcnt(0)
    v_accvgpr_read_b32 v52, a96
    v_accvgpr_read_b32 v53, a100
    v_max_u32 v52, v52, v53
    v_cmp_eq_u32 vcc, -1, v52
    s_cmp_ge_u32 s68, 100000
    s_cbranch_scc1 L_xb12
    s_cbranch_vccnz L_xl12
    s_branch L_xb12
L_xs13:
    s_mov_b32 s68, 0
    s_add_u32 s18, s17, 12288
    s_add_u32 s19, s18, 18432
L_xl13:
    buffer_load_dwordx4 a[104:107], v38, s[24:27], s18 offen offset:1024 sc1
    buffer_load_dwordx4 a[108:111], v38, s[24:27], s19 offen offset:1024 sc1
    s_add_u32 s68, s68, 1
    s_waitcnt vmcnt(0)
    v_accvgpr_read_b32 v56, a104
    v_accvgpr_read_b32 v57, a108
    v_max_u32 v56, v56, v57
    v_cmp_eq_u32 vcc, -1, v56
    s_cmp_ge_u32 s68, 100000
    s_cbranch_scc1 L_xb13
    s_cbranch_vccnz L_xl13
    s_branch L_xb13
L_xs14:
    s_mov_b32 s68, 0
    s_add_u32 s18, s17, 12288
    s_add_u32 s19, s18, 18432
L_xl14:
    buffer_load_dwordx4 a[112:115], v38, s[24:27], s18 offen offset:2048 sc1
    buffer_load_dwordx4 a[116:119], v38, s[24:27], s19 offen offset:2048 sc1
    s_add_u32 s68, s68, 1
    s_waitcnt vmcnt(0)
    v_accvgpr_read_b32 v52, a112
    v_accvgpr_read_b32 v53, a116
    v_max_u32 v52, v52, v53
    v_cmp_eq_u32 vcc, -1, v52
    s_cmp_ge_u32 s68, 100000
    s_cbranch_scc1 L_xb14
    s_cbranch_vccnz L_xl14
    s_branch L_xb14
L_xs15:
    s_mov_b32 s68, 0
    s_add_u32 s18, s17, 12288
    s_add_u32 s19, s18, 18432
L_xl15:
    buffer_load_dwordx4 a[120:123], v38, s[24:27], s18 offen offset:3072 sc1
    buffer_load_dwordx4 a[124:127], v38, s[24:27], s19 offen offset:3072 sc1
    s_add_u32 s68, s68, 1
    s_waitcnt vmcnt(0)
    v_accvgpr_read_b32 v56, a120
    v_accvgpr_read_b32 v57, a124
    v_max_u32 v56, v56, v57
    v_cmp_eq_u32 vcc, -1, v56
    s_cmp_ge_u32 s68, 100000
    s_cbranch_scc1 L_xb15
    s_cbranch_vccnz L_xl15
    s_branch L_xb15
L_xs16:
    s_mov_b32 s68, 0
    s_add_u32 s18, s17, 16384
    s_add_u32 s19, s18, 18432
L_xl16:
    buffer_load_dwordx4 a[128:131], v38, s[24:27], s18 offen offset:0 sc1
    buffer_load_dwordx4 a[132:135], v38, s[24:27], s19 offen offset:0 sc1
    s_add_u32 s68, s68, 1
    s_waitcnt vmcnt(0)
    v_accvgpr_read_b32 v52, a128
    v_accvgpr_read_b32 v53, a132
    v_max_u32 v52, v52, v53
    v_cmp_eq_u32 vcc, -1, v52
    s_cmp_ge_u32 s68, 100000
    s_cbranch_scc1 L_xb16
    s_cbranch_vccnz L_xl16
    s_branch L_xb16
L_xs17:
    s_mov_b32 s68, 0
    s_add_u32 s18, s17, 16384
    s_add_u32 s19, s18, 18432
L_xl17:
    buffer_load_dwordx4 a[136:139], v38, s[24:27], s18 offen offset:1024 sc1
    buffer_load_dwordx4 a[140:143], v38, s[24:27], s19 offen offset:1024 sc1
    s_add_u32 s68, s68, 1
    s_waitcnt vmcnt(0)
    v_accvgpr_read_b32 v56, a136
    v_accvgpr_read_b32 v57, a140
    v_max_u32 v56, v56, v57
    v_cmp_eq_u32 vcc, -1, v56
    s_cmp_ge_u32 s68, 100000
    s_cbranch_scc1 L_xb17
    s_cbranch_vccnz L_xl17
    s_branch L_xb17
L_main_fin:
L_pm_fin:
    s_cbranch_execz L_wret
    v_cvt_pk_bf16_f32 v236, v124, v125
    v_cvt_pk_bf16_f32 v237, v126, v127
    v_cvt_pk_bf16_f32 v238, v128, v129
    v_cvt_pk_bf16_f32 v239, v130, v131
    v_cvt_pk_bf16_f32 v240, v132, v133
    v_cvt_pk_bf16_f32 v241, v134, v135
    v_cvt_pk_bf16_f32 v242, v136, v137
    v_cvt_pk_bf16_f32 v243, v138, v139
    v_cvt_pk_bf16_f32 v244, v140, v141
    v_cvt_pk_bf16_f32 v245, v142, v143
    s_mov_b32 s44, s6
    s_mov_b32 s45, s7
    s_mov_b32 s46, 2359296
    s_mov_b32 s47, 0x20000
    buffer_store_dwordx2 v[236:237], v45, s[44:47], s59 offen offset:0
    buffer_store_dwordx2 v[238:239], v45, s[44:47], s59 offen offset:256
    buffer_store_dwordx2 v[240:241], v45, s[44:47], s59 offen offset:512
    buffer_store_dwordx2 v[242:243], v45, s[44:47], s59 offen offset:768
    buffer_store_dwordx2 v[244:245], v46, s[44:47], s59 offen offset:1024
L_main_end:
    s_endpgm
L_text_end:
.section .rodata,"a"
.p2align 6
.amdhsa_kernel interleave_layers__ssm_conv_h3__geglu_ffn__prompt_kernel
  .amdhsa_next_free_vgpr 476
  .amdhsa_next_free_sgpr 102
  .amdhsa_accum_offset 248
  .amdhsa_group_segment_fixed_size 0
  .amdhsa_kernarg_size 104
  .amdhsa_user_sgpr_count 2
  .amdhsa_user_sgpr_kernarg_segment_ptr 1
  .amdhsa_system_sgpr_workgroup_id_x 1
.end_amdhsa_kernel
```
